```python
import torch

def _softmax(x, axis=-1):
    return torch.softmax(x, dim=axis)
def _gelu(x):
    return torch.nn.functional.gelu(x, approximate="tanh")
def _silu(x):
    return torch.nn.functional.silu(x)
def _sigmoid(x):
    return torch.sigmoid(x)
def _layernorm(x, axis=-1, eps=1e-5):
    m = x.mean(dim=axis, keepdim=True)
    v = x.var(dim=axis, keepdim=True, unbiased=False)
    return (x - m) / torch.sqrt(v + eps)
def _scatter_add(tgt, idx, src, axis=0):
    return tgt.clone().index_add_(axis, idx, src)
def _segment_sum(src, seg, n):
    out = torch.zeros((n,) + src.shape[1:], dtype=src.dtype)
    return out.index_add_(0, seg, src)
def _pad(x, pw):
    flat = tuple(v for pair in reversed(pw) for v in pair)
    return torch.nn.functional.pad(x, flat)

kernel_name = 'recurrent_scan__sliding_block_cached__glu_gated_bilinear__prompt'

def setup_inputs():

    _w = (lambda a: (lambda t: t.to(torch.bfloat16) if t.is_floating_point() else t)(torch.as_tensor(a)))
    def _A_setup():
        B, Sq, D = 1, 2048, 448
        Hq, Hkv, Sk, Dh = 16, 8, 2048, 256
        assert Hq % Hkv == 0, (Hq, Hkv)
        return {
            "x": _w((lambda *s: torch.randn(*s, dtype=torch.bfloat16) * 0.05)(B, Sq, D)),
            "k_cache": _w((lambda *s: torch.randn(*s, dtype=torch.bfloat16) * 1.6)(B, Hkv, Sk, Dh)),
            "v_cache": _w((lambda *s: torch.randn(*s, dtype=torch.bfloat16) * 1.6)(B, Hkv, Sk, Dh)),
            "wq": _w((lambda *s: torch.randn(*s, dtype=torch.bfloat16) * 1.6)(D, Hq * Dh) * (D ** -0.5)),
            "wo": _w((lambda *s: torch.randn(*s, dtype=torch.bfloat16) * 1.6)(Hq * Dh, D) * ((Hq * Dh) ** -0.5)),
        }
    _A_in = _A_setup()

    def _B_setup():
        B, S, D, F = 1, 2048, 448, 1792
        return {
            "x": _w((lambda *s: torch.randn(*s, dtype=torch.bfloat16) * 0.05)(B, S, D)),
            "w_gate": _w((lambda *s: torch.randn(*s, dtype=torch.bfloat16) * 0.2)(D, F) * (D ** -0.5)),
            "w_up": _w((lambda *s: torch.randn(*s, dtype=torch.bfloat16) * 0.2)(D, F) * (D ** -0.5)),
            "w_down": _w((lambda *s: torch.randn(*s, dtype=torch.bfloat16) * 0.2)(F, D) * (F ** -0.5)),
        }
    _B_in = _B_setup()

    return {
        "A_x": _A_in["x"],
        "A_k_cache": _A_in["k_cache"],
        "A_v_cache": _A_in["v_cache"],
        "A_wq": _A_in["wq"],
        "A_wo": _A_in["wo"],
        "B_x": _B_in["x"],
        "B_w_gate": _B_in["w_gate"],
        "B_w_up": _B_in["w_up"],
        "B_w_down": _B_in["w_down"],
    }

def reference(A_x, A_k_cache, A_v_cache, A_wq, A_wo, B_x, B_w_gate, B_w_up, B_w_down):
    def _A_ref(x, k_cache, v_cache, wq, wo):
        B, Sq, D = x.shape
        Hq, Dh = 16, 256
        Hkv, Sk = k_cache.shape[1], k_cache.shape[2]
        W = min(4096, max(256, Sk // 4))
        rep = Hq // Hkv
        q = (lambda x, *d: x.permute(*d))((x @ wq).reshape(B, Sq, Hq, Dh), 0, 2, 1, 3)
        k = (lambda x, n, axis: torch.repeat_interleave(x, n, dim=axis))(k_cache[:, :, Sk - W:, :], rep, axis=1)
        v = (lambda x, n, axis: torch.repeat_interleave(x, n, dim=axis))(v_cache[:, :, Sk - W:, :], rep, axis=1)
        scores = torch.einsum("bhqd,bhkd->bhqk", q, k) * (Dh ** -0.5)
        p = _softmax(scores, axis=-1)
        o = torch.einsum("bhqk,bhkd->bhqd", p, v)
        return (lambda x, *d: x.permute(*d))(o, 0, 2, 1, 3).reshape(B, Sq, Hq * Dh) @ wo

    def _B_ref(x, w_gate, w_up, w_down):
        g = torch.einsum("bsd,df->bsf", x, w_gate)
        u = torch.einsum("bsd,df->bsf", x, w_up)
        h = g * u
        return torch.einsum("bsf,fd->bsd", h, w_down)

    x = A_x
    xn = _layernorm(x, axis=-1)
    s = _A_ref(xn, A_k_cache, A_v_cache, A_wq, A_wo)
    g = _silu(_B_ref(xn, B_w_gate, B_w_up, B_w_down))
    return x + s * g
```

```asm
; @launch grid=(256,1,1) block=(256,1,1) lds=163840
.amdgcn_target "amdgcn-amd-amdhsa--gfx950"
.text
.globl recurrent_scan__sliding_block_cached__glu_gated_bilinear__prompt_kernel
.p2align 8
.type recurrent_scan__sliding_block_cached__glu_gated_bilinear__prompt_kernel,@function
recurrent_scan__sliding_block_cached__glu_gated_bilinear__prompt_kernel:
    s_cmp_ge_u32 s2, 256
    s_cbranch_scc1 L1_end
    s_load_dwordx16 s[4:19], s[0:1], 0
    s_load_dwordx8 s[20:27], s[0:1], 64
    v_lshrrev_b32 v250, 6, v0
    v_and_b32 v240, 63, v0
    v_readfirstlane_b32 s52, v250
    s_and_b32 s61, s2, 7
    s_lshr_b32 s62, s2, 3
    s_and_b32 s63, s61, 7
    s_lshl_b32 s53, s63, 1
    s_and_b32 s63, s62, 1
    s_add_u32 s53, s53, s63
    s_lshr_b32 s63, s61, 3
    s_lshl_b32 s54, s63, 4
    s_lshr_b32 s63, s62, 1
    s_add_u32 s54, s54, s63
    s_lshr_b32 s55, s53, 1
    s_lshl_b32 s60, s52, 13
    s_lshl_b32 s71, s54, 2
    s_add_u32 s71, s71, s52
    s_mul_i32 s72, s71, 28672
    v_lshrrev_b32 v250, 3, v240
    v_and_b32 v251, 7, v240
    v_lshrrev_b32 v252, 4, v240
    v_xor_b32 v251, v251, v252
    v_mul_u32_u24 v250, 896, v250
    v_lshl_add_u32 v103, v251, 4, v250
    v_xor_b32 v251, 64, v103
    v_add_u32 v105, 12288, v103
    v_add_u32 v104, 6144, v251
    v_add_u32 v106, 18432, v251
    s_getpc_b64 s[74:75]
L1_pc:
    s_lshl_b32 s63, s62, 2
    s_add_u32 s63, s63, s52
    s_mul_i32 s63, s63, 640
    v_min_u32 v253, 4, v240
    v_lshlrev_b32 v253, 7, v253
    v_add_u32 v253, s63, v253
    v_min_u32 v253, L1_last-L1_pc, v253
    v_mov_b32 v25, s75
    v_add_co_u32 v24, vcc, s74, v253
    s_nop 1
    v_addc_co_u32 v25, vcc, 0, v25, vcc
    global_load_dword v27, v[24:25], off
    s_waitcnt lgkmcnt(0)
    s_mov_b32 s28, s4
    s_and_b32 s29, s5, 0xffff
    s_mov_b32 s30, 0x1c0000
    s_mov_b32 s31, 0x20000
    s_cmp_eq_u32 s52, 2
    s_cselect_b32 s32, s16, s18
    s_cselect_b32 s33, s17, s19
    s_and_b32 s61, s53, 1
    s_mul_i32 s73, s55, 448
    s_and_b32 s73, s73, 0xffffff80
    s_lshl_b32 s62, s53, 9
    s_mov_b32 s34, 0x188000
    s_mov_b32 s100, 3584
    s_cmp_lt_u32 s52, 2
    s_cselect_b32 s32, s10, s32
    s_cselect_b32 s33, s11, s33
    s_cselect_b32 s34, 0x380000, s34
    s_cselect_b32 s100, 8192, s100
    s_cselect_b32 s73, s62, s73
    s_cselect_b32 s61, s52, s61
    s_and_b32 s33, s33, 0xffff
    s_mov_b32 s35, 0x20000
    s_and_b32 s3, s54, 15
    s_lshl_b32 s101, s3, 1
    s_add_u32 s101, s101, s61
    s_mul_i32 s61, s101, 5
    s_add_u32 s61, s61, 0
    v_min_u32 v250, 19, v240
    v_lshrrev_b32 v251, 2, v250
    v_add_u32 v251, s61, v251
    v_mul_u32_u24 v251, s100, v251
    v_and_b32 v250, 3, v250
    v_lshl_add_u32 v250, v250, 7, v251
    s_nop 0
    buffer_load_dword v26, v250, s[32:35], s73 offen
    s_add_u32 m0, s60, 32768
    s_nop 0
    buffer_load_dwordx4 v103, s[28:31], s72 offen offset:0 lds
    v_and_b32 v241, 31, v240
    v_lshrrev_b32 v242, 5, v240
    v_bfe_u32 v243, v240, 2, 2
    v_and_b32 v244, 3, v240
    v_bfe_u32 v245, v240, 4, 1
    v_lshrrev_b32 v250, 1, v244
    v_and_b32 v251, 1, v244
    v_lshl_or_b32 v249, v251, 1, v250
    buffer_load_dwordx4 v104, s[28:31], s72 offen offset:1024 lds
    v_lshl_add_u32 v252, v242, 3, v243
    v_lshlrev_b32 v253, 9, v252
    v_lshl_add_u32 v253, v245, 5, v253
    v_lshl_add_u32 v253, v249, 3, v253
    v_xor_b32 v254, 0, v243
    v_lshl_add_u32 v52, v254, 6, v253
    v_add_u32 v56, 0x10000, v52
    v_add_u32 v60, 0x20000, v52
    buffer_load_dwordx4 v105, s[28:31], s72 offen offset:2048 lds
    v_xor_b32 v254, 1, v243
    v_lshl_add_u32 v53, v254, 6, v253
    v_add_u32 v57, 0x10000, v53
    v_add_u32 v61, 0x20000, v53
    v_xor_b32 v254, 2, v243
    v_lshl_add_u32 v54, v254, 6, v253
    v_add_u32 v58, 0x10000, v54
    v_add_u32 v62, 0x20000, v54
    buffer_load_dwordx4 v106, s[28:31], s72 offen offset:3072 lds
    v_xor_b32 v254, 3, v243
    v_lshl_add_u32 v55, v254, 6, v253
    v_add_u32 v59, 0x10000, v55
    v_add_u32 v63, 0x20000, v55
    v_mul_u32_u24 v253, 224, v252
    v_mul_u32_u24 v254, 8320, v245
    v_add_u32 v253, v253, v254
    v_lshl_add_u32 v64, v249, 3, v253
    s_add_u32 s72, s72, 128
    s_add_u32 m0, s60, 36864
    s_nop 0
    buffer_load_dwordx4 v103, s[28:31], s72 offen offset:0 lds
    v_add_u32 v65, 0x10000, v64
    v_add_u32 v66, 0x20000, v64
    v_lshl_add_u32 v250, v245, 1, v250
    v_lshl_add_u32 v250, v251, 2, v250
    v_lshlrev_b32 v250, 3, v250
    v_lshl_add_u32 v250, v252, 7, v250
    v_lshrrev_b32 v251, 1, v243
    v_xor_b32 v254, 0, v251
    buffer_load_dwordx4 v104, s[28:31], s72 offen offset:1024 lds
    v_lshl_add_u32 v67, v254, 6, v250
    v_add_u32 v69, 0x10000, v67
    v_add_u32 v71, 0x20000, v67
    v_xor_b32 v254, 1, v251
    v_lshl_add_u32 v68, v254, 6, v250
    v_add_u32 v70, 0x10000, v68
    v_add_u32 v72, 0x20000, v68
    v_and_b32 v250, 0x13, v241
    buffer_load_dwordx4 v105, s[28:31], s72 offen offset:2048 lds
    v_bfe_u32 v251, v241, 2, 1
    v_lshl_or_b32 v250, v251, 3, v250
    v_bfe_u32 v251, v241, 3, 1
    v_lshl_or_b32 v250, v251, 2, v250
    v_and_b32 v251, 15, v250
    v_xor_b32 v251, v251, v242
    v_lshlrev_b32 v250, 9, v250
    v_xor_b32 v254, 0, v251
    buffer_load_dwordx4 v106, s[28:31], s72 offen offset:3072 lds
    v_lshl_add_u32 v73, v254, 4, v250
    v_add_u32 v81, 0x10000, v73
    v_add_u32 v89, 0x20000, v73
    v_xor_b32 v254, 2, v251
    v_lshl_add_u32 v74, v254, 4, v250
    v_add_u32 v82, 0x10000, v74
    v_add_u32 v90, 0x20000, v74
    v_xor_b32 v254, 4, v251
    s_add_u32 s72, s72, 128
    s_add_u32 m0, s60, 65536
    s_nop 0
    buffer_load_dwordx4 v103, s[28:31], s72 offen offset:0 lds
    v_lshl_add_u32 v75, v254, 4, v250
    v_add_u32 v83, 0x10000, v75
    v_add_u32 v91, 0x20000, v75
    v_xor_b32 v254, 6, v251
    v_lshl_add_u32 v76, v254, 4, v250
    v_add_u32 v84, 0x10000, v76
    v_add_u32 v92, 0x20000, v76
    v_xor_b32 v254, 8, v251
    buffer_load_dwordx4 v104, s[28:31], s72 offen offset:1024 lds
    v_lshl_add_u32 v77, v254, 4, v250
    v_add_u32 v85, 0x10000, v77
    v_add_u32 v93, 0x20000, v77
    v_xor_b32 v254, 10, v251
    v_lshl_add_u32 v78, v254, 4, v250
    v_add_u32 v86, 0x10000, v78
    v_add_u32 v94, 0x20000, v78
    v_xor_b32 v254, 12, v251
    buffer_load_dwordx4 v105, s[28:31], s72 offen offset:2048 lds
    v_lshl_add_u32 v79, v254, 4, v250
    v_add_u32 v87, 0x10000, v79
    v_add_u32 v95, 0x20000, v79
    v_xor_b32 v254, 14, v251
    v_lshl_add_u32 v80, v254, 4, v250
    v_add_u32 v88, 0x10000, v80
    v_add_u32 v96, 0x20000, v80
    v_lshlrev_b32 v97, 4, v240
    buffer_load_dwordx4 v106, s[28:31], s72 offen offset:3072 lds
    v_mov_b32 v98, 0
    v_bfe_u32 v250, v241, 1, 3
    v_xor_b32 v250, v250, v242
    v_lshlrev_b32 v251, 7, v241
    v_add_u32 v251, s60, v251
    v_add_u32 v251, 0x8000, v251
    v_xor_b32 v254, 0, v250
    v_lshl_add_u32 v112, v254, 4, v251
    s_add_u32 s72, s72, 128
    s_add_u32 m0, s60, 69632
    s_nop 0
    buffer_load_dwordx4 v103, s[28:31], s72 offen offset:0 lds
    v_add_u32 v116, 0x10000, v112
    v_xor_b32 v254, 2, v250
    v_lshl_add_u32 v113, v254, 4, v251
    v_add_u32 v117, 0x10000, v113
    v_xor_b32 v254, 4, v250
    v_lshl_add_u32 v114, v254, 4, v251
    v_add_u32 v118, 0x10000, v114
    v_xor_b32 v254, 6, v250
    buffer_load_dwordx4 v104, s[28:31], s72 offen offset:1024 lds
    v_lshl_add_u32 v115, v254, 4, v251
    v_add_u32 v119, 0x10000, v115
    v_and_b32 v250, 7, v240
    v_lshlrev_b32 v251, 2, v245
    v_xor_b32 v250, v250, v251
    v_lshlrev_b32 v250, 4, v250
    v_lshrrev_b32 v251, 3, v240
    v_mul_u32_u24 v251, 896, v251
    buffer_load_dwordx4 v105, s[28:31], s72 offen offset:2048 lds
    v_add_u32 v250, v250, v251
    s_mul_i32 s59, s53, 229376
    s_mul_i32 s63, s52, 57344
    s_add_u32 s59, s59, s63
    v_add_u32 v44, 0, v250
    v_add_u32 v45, 6144, v250
    v_add_u32 v46, 12288, v250
    v_add_u32 v47, 18432, v250
    buffer_load_dwordx4 v106, s[28:31], s72 offen offset:3072 lds
    v_add_u32 v48, 28672, v250
    v_add_u32 v49, 34816, v250
    v_add_u32 v50, 40960, v250
    v_add_u32 v51, 47104, v250
    v_mov_b32 v107, 0
    v_mov_b32 v108, 0
    v_mov_b32 v109, 0
    v_mov_b32 v110, 0
    s_add_u32 s72, s72, 128
    s_cmp_lt_u32 s52, 2
    s_cbranch_scc0 L1_w23
    s_mov_b32 s36, s6
    s_and_b32 s37, s7, 0xffff
    s_mov_b32 s38, 0x800000
    s_mov_b32 s39, 0x20000
    s_mov_b32 s57, 262144
    s_lshl_b32 s58, s55, 20
    s_add_u32 s38, s58, 1048576
    s_add_u32 s58, s58, 786432
    s_lshl_b32 s56, s53, 9
    s_lshl_b32 s63, s52, 4
    v_add_u32 v250, s63, v242
    v_add_u32 v251, 0, v242
    v_lshlrev_b32 v251, 2, v251
    v_xor_b32 v251, v251, v241
    v_lshlrev_b32 v251, 4, v251
    v_lshl_add_u32 v251, v250, 13, v251
    v_add_u32 v28, 0, v251
    v_add_u32 v30, 30720, v251
    v_add_u32 v32, 65536, v251
    v_add_u32 v34, 96256, v251
    v_add_u32 v251, 2, v242
    v_lshlrev_b32 v251, 2, v251
    v_xor_b32 v251, v251, v241
    v_lshlrev_b32 v251, 4, v251
    v_lshl_add_u32 v251, v250, 13, v251
    v_add_u32 v29, 15360, v251
    v_add_u32 v31, 46080, v251
    v_add_u32 v33, 80896, v251
    v_add_u32 v35, 111616, v251
    v_xor_b32 v252, v242, v241
    v_lshlrev_b32 v250, 9, v250
    v_xor_b32 v251, 0, v252
    v_lshl_add_u32 v251, v251, 4, v250
    v_add_u32 v36, 0, v251
    v_xor_b32 v251, 2, v252
    v_lshl_add_u32 v251, v251, 4, v250
    v_add_u32 v37, 0, v251
    v_xor_b32 v251, 4, v252
    v_lshl_add_u32 v251, v251, 4, v250
    v_add_u32 v38, 0, v251
    v_xor_b32 v251, 6, v252
    v_lshl_add_u32 v251, v251, 4, v250
    v_add_u32 v39, 0, v251
    v_xor_b32 v251, 8, v252
    v_lshl_add_u32 v251, v251, 4, v250
    v_add_u32 v40, 4096, v251
    v_xor_b32 v251, 10, v252
    v_lshl_add_u32 v251, v251, 4, v250
    v_add_u32 v41, 4096, v251
    v_xor_b32 v251, 12, v252
    v_lshl_add_u32 v251, v251, 4, v250
    v_add_u32 v42, 4096, v251
    v_xor_b32 v251, 14, v252
    v_lshl_add_u32 v251, v251, 4, v250
    v_add_u32 v43, 4096, v251
    s_branch L1_wj
L1_w23:
    s_cmp_eq_u32 s52, 2
    s_cselect_b32 s61, 0, 8
    s_mov_b32 s36, s8
    s_and_b32 s37, s9, 0xffff
    s_mov_b32 s38, 0x800000
    s_mov_b32 s39, 0x20000
    s_mov_b32 s57, 114688
    s_lshl_b32 s58, s55, 20
    s_add_u32 s58, s58, 770048
    s_mul_i32 s56, s53, 224
    s_and_b32 s63, s52, 1
    s_lshl_b32 s63, s63, 4
    s_mov_b32 s67, 4682
    v_mov_b32 v254, 0x40000000
    v_subrev_u32 v253, s61, v240
    v_add_u32 v250, 0, v253
    v_cmp_gt_u32 vcc, 448, v250
    v_mul_u32_u24 v251, s67, v250
    v_lshrrev_b32 v251, 16, v251
    v_mul_u32_u24 v251, 3360, v251
    v_lshl_add_u32 v251, v250, 4, v251
    v_subrev_u32 v251, 0, v251
    v_cndmask_b32 v28, v254, v251, vcc
    v_add_u32 v250, 64, v253
    v_cmp_gt_u32 vcc, 448, v250
    v_mul_u32_u24 v251, s67, v250
    v_lshrrev_b32 v251, 16, v251
    v_mul_u32_u24 v251, 3360, v251
    v_lshl_add_u32 v251, v250, 4, v251
    v_subrev_u32 v251, 1024, v251
    v_cndmask_b32 v29, v254, v251, vcc
    v_add_u32 v250, 128, v253
    v_cmp_gt_u32 vcc, 448, v250
    v_mul_u32_u24 v251, s67, v250
    v_lshrrev_b32 v251, 16, v251
    v_mul_u32_u24 v251, 3360, v251
    v_lshl_add_u32 v251, v250, 4, v251
    v_subrev_u32 v251, 2048, v251
    v_cndmask_b32 v30, v254, v251, vcc
    v_add_u32 v250, 192, v253
    v_cmp_gt_u32 vcc, 448, v250
    v_mul_u32_u24 v251, s67, v250
    v_lshrrev_b32 v251, 16, v251
    v_mul_u32_u24 v251, 3360, v251
    v_lshl_add_u32 v251, v250, 4, v251
    v_subrev_u32 v251, 3072, v251
    v_cndmask_b32 v31, v254, v251, vcc
    v_add_u32 v250, 256, v253
    v_cmp_gt_u32 vcc, 448, v250
    v_mul_u32_u24 v251, s67, v250
    v_lshrrev_b32 v251, 16, v251
    v_mul_u32_u24 v251, 3360, v251
    v_lshl_add_u32 v251, v250, 4, v251
    v_subrev_u32 v251, 0, v251
    v_cndmask_b32 v32, v254, v251, vcc
    v_add_u32 v250, 320, v253
    v_cmp_gt_u32 vcc, 448, v250
    v_mul_u32_u24 v251, s67, v250
    v_lshrrev_b32 v251, 16, v251
    v_mul_u32_u24 v251, 3360, v251
    v_lshl_add_u32 v251, v250, 4, v251
    v_subrev_u32 v251, 1024, v251
    v_cndmask_b32 v33, v254, v251, vcc
    v_add_u32 v250, 384, v253
    v_cmp_gt_u32 vcc, 448, v250
    v_mul_u32_u24 v251, s67, v250
    v_lshrrev_b32 v251, 16, v251
    v_mul_u32_u24 v251, 3360, v251
    v_lshl_add_u32 v251, v250, 4, v251
    v_subrev_u32 v251, 2048, v251
    v_cndmask_b32 v34, v254, v251, vcc
    v_add_u32 v250, 448, v253
    v_cmp_gt_u32 vcc, 448, v250
    v_mul_u32_u24 v251, s67, v250
    v_lshrrev_b32 v251, 16, v251
    v_mul_u32_u24 v251, 3360, v251
    v_lshl_add_u32 v251, v250, 4, v251
    v_subrev_u32 v251, 3072, v251
    v_cndmask_b32 v35, v254, v251, vcc
    v_add_u32 v250, s63, v242
    v_add_u32 v251, 0, v242
    v_lshlrev_b32 v251, 2, v251
    v_xor_b32 v251, v251, v241
    v_lshlrev_b32 v251, 4, v251
    v_lshl_add_u32 v251, v250, 9, v251
    v_add_u32 v36, 0, v251
    v_add_u32 v38, 0, v251
    v_add_u32 v40, 4096, v251
    v_add_u32 v42, 4096, v251
    v_add_u32 v251, 2, v242
    v_lshlrev_b32 v251, 2, v251
    v_xor_b32 v251, v251, v241
    v_lshlrev_b32 v251, 4, v251
    v_lshl_add_u32 v251, v250, 9, v251
    v_add_u32 v37, 0, v251
    v_add_u32 v39, 0, v251
    v_add_u32 v41, 4096, v251
    v_add_u32 v43, 4096, v251
L1_wj:
    s_nop 1
    s_mov_b32 s40, s12
    s_and_b32 s41, s13, 0xffff
    s_mov_b32 s42, 0x380000
    s_mov_b32 s43, 0x20000
    s_mov_b32 s44, s20
    s_and_b32 s45, s21, 0xffff
    s_mov_b32 s46, 0x188000
    s_mov_b32 s47, 0x20000
    s_mov_b32 s48, s26
    s_and_b32 s49, s27, 0xffff
    s_mov_b32 s50, 0x10000000
    s_mov_b32 s51, 0x20000
    s_mov_b32 s4, s24
    s_and_b32 s5, s25, 0xffff
    s_mov_b32 s6, 0x100
    s_mov_b32 s7, 0x20000
    s_mov_b32 s8, s22
    s_and_b32 s9, s23, 0xffff
    s_mov_b32 s10, 0x1c0000
    s_mov_b32 s11, 0x20000
    s_or_b32 s61, s2, s52
    s_cmp_lg_u32 s61, 0
    s_cbranch_scc1 L1_non
    s_memrealtime s[74:75]
    v_mov_b32 v251, 0
    s_waitcnt lgkmcnt(0)
    s_or_b32 s74, s74, 1
    v_mov_b32 v250, s74
    buffer_store_dword v250, v251, s[4:7], 0 offen sc1
L1_non:
    s_mov_b32 s64, 0x3f803f80
    s_mov_b32 s65, 0xffff0000
    s_mov_b32 s66, 0x41c00000
    s_lshl_b32 s68, s53, 6
    s_add_u32 s68, s68, s71
    s_mul_i32 s68, s68, 28672
    s_add_u32 s24, s68, 28672
    s_add_u32 s69, s68, 0x1c00000
    s_add_u32 s23, s59, 896
    s_mul_i32 s61, s53, 37
    s_lshr_b32 s61, s61, 8
    s_mul_i32 s61, s61, 7
    s_sub_u32 s61, s53, s61
    s_lshl_b32 s62, s61, 7
    s_add_u32 s59, s59, s62
    s_lshl_b32 s62, s61, 12
    s_add_u32 s68, s68, s62
    s_mul_i32 s15, s53, 100352
    s_add_u32 s46, s15, 100352
    s_and_b32 s62, s52, 1
    s_mul_i32 s62, s62, 57344
    s_add_u32 s15, s15, s62
    s_lshr_b32 s62, s52, 1
    s_lshl_b32 s70, s62, 29
    s_add_u32 s70, s70, 256
    s_lshl_b32 s62, s62, 7
    s_add_u32 s15, s15, s62
    s_lshl_b32 s16, s71, 4
    s_add_u32 s16, s16, s53
    s_mul_i32 s16, s16, 256
    s_add_u32 s16, s16, 0x3800000
    s_lshr_b32 s12, s2, 3
    s_sub_i32 s13, s12, 4
    s_max_i32 s13, s13, 0
    s_mul_i32 s61, s13, 4682
    s_lshr_b32 s61, s61, 16
    s_mul_i32 s62, s61, 14
    s_sub_u32 s13, s13, s62
    s_and_b32 s61, s61, 1
    s_and_b32 s62, s2, 7
    s_lshl_b32 s62, s62, 1
    s_add_u32 s61, s61, s62
    s_lshl_b32 s14, s61, 2
    s_add_u32 s14, s14, s52
    s_mul_i32 s17, s14, 4096
    s_add_u32 s17, s17, 0x3800000
    s_mul_i32 s19, s14, 14
    s_add_u32 s19, s19, s13
    s_lshl_b32 s19, s19, 11
    s_mov_b32 s25, 0xffff
    s_mov_b32 s22, 0
    s_mul_i32 s20, s14, 28672
    s_lshl_b32 s61, s13, 6
    s_add_u32 s20, s20, s61
    s_add_u32 s18, s19, 0x1c00000
    s_add_u32 m0, s60, 98304
    s_nop 0
    buffer_load_dwordx4 v103, s[28:31], s72 offen offset:0 lds
    buffer_load_dwordx4 v104, s[28:31], s72 offen offset:1024 lds
    buffer_load_dwordx4 v105, s[28:31], s72 offen offset:2048 lds
    buffer_load_dwordx4 v106, s[28:31], s72 offen offset:3072 lds
    s_add_u32 s72, s72, 128
    s_waitcnt vmcnt(16)
    ds_read_b128 v[128:131], v112 offset:0
    ds_read_b128 v[132:135], v113 offset:0
    ds_read_b128 v[136:139], v114 offset:0
    ds_read_b128 v[140:143], v115 offset:0
    s_add_u32 m0, s60, 102400
    s_nop 0
    buffer_load_dwordx4 v103, s[28:31], s72 offen offset:0 lds
    buffer_load_dwordx4 v104, s[28:31], s72 offen offset:1024 lds
    buffer_load_dwordx4 v105, s[28:31], s72 offen offset:2048 lds
    buffer_load_dwordx4 v106, s[28:31], s72 offen offset:3072 lds
    s_add_u32 s72, s72, 128
    s_waitcnt vmcnt(16)
    ds_read_b128 v[144:147], v112 offset:4096
    ds_read_b128 v[148:151], v113 offset:4096
    ds_read_b128 v[152:155], v114 offset:4096
    ds_read_b128 v[156:159], v115 offset:4096
    s_waitcnt lgkmcnt(7)
    v_dot2c_f32_bf16 v107, s64, v128
    v_dot2c_f32_bf16 v109, v128, v128
    v_dot2c_f32_bf16 v108, s64, v129
    v_dot2c_f32_bf16 v110, v129, v129
    v_dot2c_f32_bf16 v107, s64, v130
    v_dot2c_f32_bf16 v109, v130, v130
    v_dot2c_f32_bf16 v108, s64, v131
    v_dot2c_f32_bf16 v110, v131, v131
    s_waitcnt lgkmcnt(6)
    v_dot2c_f32_bf16 v107, s64, v132
    v_dot2c_f32_bf16 v109, v132, v132
    v_dot2c_f32_bf16 v108, s64, v133
    v_dot2c_f32_bf16 v110, v133, v133
    v_dot2c_f32_bf16 v107, s64, v134
    v_dot2c_f32_bf16 v109, v134, v134
    v_dot2c_f32_bf16 v108, s64, v135
    v_dot2c_f32_bf16 v110, v135, v135
    s_waitcnt lgkmcnt(5)
    v_dot2c_f32_bf16 v107, s64, v136
    v_dot2c_f32_bf16 v109, v136, v136
    v_dot2c_f32_bf16 v108, s64, v137
    v_dot2c_f32_bf16 v110, v137, v137
    v_dot2c_f32_bf16 v107, s64, v138
    v_dot2c_f32_bf16 v109, v138, v138
    v_dot2c_f32_bf16 v108, s64, v139
    v_dot2c_f32_bf16 v110, v139, v139
    s_waitcnt lgkmcnt(4)
    v_dot2c_f32_bf16 v107, s64, v140
    v_dot2c_f32_bf16 v109, v140, v140
    v_dot2c_f32_bf16 v108, s64, v141
    v_dot2c_f32_bf16 v110, v141, v141
    v_dot2c_f32_bf16 v107, s64, v142
    v_dot2c_f32_bf16 v109, v142, v142
    v_dot2c_f32_bf16 v108, s64, v143
    v_dot2c_f32_bf16 v110, v143, v143
    s_add_u32 m0, s60, 131072
    s_nop 0
    buffer_load_dwordx4 v103, s[28:31], s72 offen offset:0 lds
    buffer_load_dwordx4 v104, s[28:31], s72 offen offset:1024 lds
    buffer_load_dwordx4 v105, s[28:31], s72 offen offset:2048 lds
    buffer_load_dwordx4 v106, s[28:31], s72 offen offset:3072 lds
    s_add_u32 s72, s72, 128
    s_add_u32 m0, s60, 0
    s_nop 0
    buffer_load_dwordx4 v28, s[32:35], s56 offen offset:0 lds
    buffer_load_dwordx4 v29, s[32:35], s56 offen offset:1024 lds
    buffer_load_dwordx4 v30, s[32:35], s56 offen offset:2048 lds
    buffer_load_dwordx4 v31, s[32:35], s56 offen offset:3072 lds
    s_add_u32 m0, s60, 4096
    s_nop 0
    buffer_load_dwordx4 v32, s[32:35], s56 offen offset:0 lds
    buffer_load_dwordx4 v33, s[32:35], s56 offen offset:1024 lds
    buffer_load_dwordx4 v34, s[32:35], s56 offen offset:2048 lds
    buffer_load_dwordx4 v35, s[32:35], s56 offen offset:3072 lds
    s_add_u32 s56, s56, s57
    s_waitcnt vmcnt(24)
    ds_read_b128 v[160:163], v112 offset:32768
    ds_read_b128 v[164:167], v113 offset:32768
    ds_read_b128 v[168:171], v114 offset:32768
    ds_read_b128 v[172:175], v115 offset:32768
    s_waitcnt lgkmcnt(7)
    v_dot2c_f32_bf16 v107, s64, v144
    v_dot2c_f32_bf16 v109, v144, v144
    v_dot2c_f32_bf16 v108, s64, v145
    v_dot2c_f32_bf16 v110, v145, v145
    v_dot2c_f32_bf16 v107, s64, v146
    v_dot2c_f32_bf16 v109, v146, v146
    v_dot2c_f32_bf16 v108, s64, v147
    v_dot2c_f32_bf16 v110, v147, v147
    s_waitcnt lgkmcnt(6)
    v_dot2c_f32_bf16 v107, s64, v148
    v_dot2c_f32_bf16 v109, v148, v148
    v_dot2c_f32_bf16 v108, s64, v149
    v_dot2c_f32_bf16 v110, v149, v149
    v_dot2c_f32_bf16 v107, s64, v150
    v_dot2c_f32_bf16 v109, v150, v150
    v_dot2c_f32_bf16 v108, s64, v151
    v_dot2c_f32_bf16 v110, v151, v151
    s_waitcnt lgkmcnt(5)
    v_dot2c_f32_bf16 v107, s64, v152
    v_dot2c_f32_bf16 v109, v152, v152
    v_dot2c_f32_bf16 v108, s64, v153
    v_dot2c_f32_bf16 v110, v153, v153
    v_dot2c_f32_bf16 v107, s64, v154
    v_dot2c_f32_bf16 v109, v154, v154
    v_dot2c_f32_bf16 v108, s64, v155
    v_dot2c_f32_bf16 v110, v155, v155
    s_waitcnt lgkmcnt(4)
    v_dot2c_f32_bf16 v107, s64, v156
    v_dot2c_f32_bf16 v109, v156, v156
    v_dot2c_f32_bf16 v108, s64, v157
    v_dot2c_f32_bf16 v110, v157, v157
    v_dot2c_f32_bf16 v107, s64, v158
    v_dot2c_f32_bf16 v109, v158, v158
    v_dot2c_f32_bf16 v108, s64, v159
    v_dot2c_f32_bf16 v110, v159, v159
    s_add_u32 m0, s60, 32768
    s_nop 0
    buffer_load_dwordx4 v28, s[32:35], s56 offen offset:0 lds
    buffer_load_dwordx4 v29, s[32:35], s56 offen offset:1024 lds
    buffer_load_dwordx4 v30, s[32:35], s56 offen offset:2048 lds
    buffer_load_dwordx4 v31, s[32:35], s56 offen offset:3072 lds
    s_add_u32 m0, s60, 36864
    s_nop 0
    buffer_load_dwordx4 v32, s[32:35], s56 offen offset:0 lds
    buffer_load_dwordx4 v33, s[32:35], s56 offen offset:1024 lds
    buffer_load_dwordx4 v34, s[32:35], s56 offen offset:2048 lds
    buffer_load_dwordx4 v35, s[32:35], s56 offen offset:3072 lds
    s_add_u32 s56, s56, s57
    s_waitcnt vmcnt(28)
    ds_read_b128 v[176:179], v112 offset:36864
    ds_read_b128 v[180:183], v113 offset:36864
    ds_read_b128 v[184:187], v114 offset:36864
    ds_read_b128 v[188:191], v115 offset:36864
    s_waitcnt lgkmcnt(7)
    v_dot2c_f32_bf16 v107, s64, v160
    v_dot2c_f32_bf16 v109, v160, v160
    v_dot2c_f32_bf16 v108, s64, v161
    v_dot2c_f32_bf16 v110, v161, v161
    v_dot2c_f32_bf16 v107, s64, v162
    v_dot2c_f32_bf16 v109, v162, v162
    v_dot2c_f32_bf16 v108, s64, v163
    v_dot2c_f32_bf16 v110, v163, v163
    s_waitcnt lgkmcnt(6)
    v_dot2c_f32_bf16 v107, s64, v164
    v_dot2c_f32_bf16 v109, v164, v164
    v_dot2c_f32_bf16 v108, s64, v165
    v_dot2c_f32_bf16 v110, v165, v165
    v_dot2c_f32_bf16 v107, s64, v166
    v_dot2c_f32_bf16 v109, v166, v166
    v_dot2c_f32_bf16 v108, s64, v167
    v_dot2c_f32_bf16 v110, v167, v167
    s_waitcnt lgkmcnt(5)
    v_dot2c_f32_bf16 v107, s64, v168
    v_dot2c_f32_bf16 v109, v168, v168
    v_dot2c_f32_bf16 v108, s64, v169
    v_dot2c_f32_bf16 v110, v169, v169
    v_dot2c_f32_bf16 v107, s64, v170
    v_dot2c_f32_bf16 v109, v170, v170
    v_dot2c_f32_bf16 v108, s64, v171
    v_dot2c_f32_bf16 v110, v171, v171
    s_waitcnt lgkmcnt(4)
    v_dot2c_f32_bf16 v107, s64, v172
    v_dot2c_f32_bf16 v109, v172, v172
    v_dot2c_f32_bf16 v108, s64, v173
    v_dot2c_f32_bf16 v110, v173, v173
    v_dot2c_f32_bf16 v107, s64, v174
    v_dot2c_f32_bf16 v109, v174, v174
    v_dot2c_f32_bf16 v108, s64, v175
    v_dot2c_f32_bf16 v110, v175, v175
    s_waitcnt vmcnt(24)
    ds_read_b128 v[192:195], v116 offset:0
    ds_read_b128 v[196:199], v117 offset:0
    ds_read_b128 v[200:203], v118 offset:0
    ds_read_b128 v[204:207], v119 offset:0
    s_waitcnt lgkmcnt(7)
    v_dot2c_f32_bf16 v107, s64, v176
    v_dot2c_f32_bf16 v109, v176, v176
    v_dot2c_f32_bf16 v108, s64, v177
    v_dot2c_f32_bf16 v110, v177, v177
    v_dot2c_f32_bf16 v107, s64, v178
    v_dot2c_f32_bf16 v109, v178, v178
    v_dot2c_f32_bf16 v108, s64, v179
    v_dot2c_f32_bf16 v110, v179, v179
    s_waitcnt lgkmcnt(6)
    v_dot2c_f32_bf16 v107, s64, v180
    v_dot2c_f32_bf16 v109, v180, v180
    v_dot2c_f32_bf16 v108, s64, v181
    v_dot2c_f32_bf16 v110, v181, v181
    v_dot2c_f32_bf16 v107, s64, v182
    v_dot2c_f32_bf16 v109, v182, v182
    v_dot2c_f32_bf16 v108, s64, v183
    v_dot2c_f32_bf16 v110, v183, v183
    s_waitcnt lgkmcnt(5)
    v_dot2c_f32_bf16 v107, s64, v184
    v_dot2c_f32_bf16 v109, v184, v184
    v_dot2c_f32_bf16 v108, s64, v185
    v_dot2c_f32_bf16 v110, v185, v185
    v_dot2c_f32_bf16 v107, s64, v186
    v_dot2c_f32_bf16 v109, v186, v186
    v_dot2c_f32_bf16 v108, s64, v187
    v_dot2c_f32_bf16 v110, v187, v187
    s_waitcnt lgkmcnt(4)
    v_dot2c_f32_bf16 v107, s64, v188
    v_dot2c_f32_bf16 v109, v188, v188
    v_dot2c_f32_bf16 v108, s64, v189
    v_dot2c_f32_bf16 v110, v189, v189
    v_dot2c_f32_bf16 v107, s64, v190
    v_dot2c_f32_bf16 v109, v190, v190
    v_dot2c_f32_bf16 v108, s64, v191
    v_dot2c_f32_bf16 v110, v191, v191
    s_add_u32 m0, s60, 65536
    s_nop 0
    buffer_load_dwordx4 v28, s[32:35], s56 offen offset:0 lds
    buffer_load_dwordx4 v29, s[32:35], s56 offen offset:1024 lds
    buffer_load_dwordx4 v30, s[32:35], s56 offen offset:2048 lds
    buffer_load_dwordx4 v31, s[32:35], s56 offen offset:3072 lds
    s_add_u32 m0, s60, 69632
    s_nop 0
    buffer_load_dwordx4 v32, s[32:35], s56 offen offset:0 lds
    buffer_load_dwordx4 v33, s[32:35], s56 offen offset:1024 lds
    buffer_load_dwordx4 v34, s[32:35], s56 offen offset:2048 lds
    buffer_load_dwordx4 v35, s[32:35], s56 offen offset:3072 lds
    s_add_u32 s56, s56, s57
    s_waitcnt vmcnt(28)
    ds_read_b128 v[208:211], v116 offset:4096
    ds_read_b128 v[212:215], v117 offset:4096
    ds_read_b128 v[216:219], v118 offset:4096
    ds_read_b128 v[220:223], v119 offset:4096
    s_waitcnt lgkmcnt(7)
    v_dot2c_f32_bf16 v107, s64, v192
    v_dot2c_f32_bf16 v109, v192, v192
    v_dot2c_f32_bf16 v108, s64, v193
    v_dot2c_f32_bf16 v110, v193, v193
    v_dot2c_f32_bf16 v107, s64, v194
    v_dot2c_f32_bf16 v109, v194, v194
    v_dot2c_f32_bf16 v108, s64, v195
    v_dot2c_f32_bf16 v110, v195, v195
    s_waitcnt lgkmcnt(6)
    v_dot2c_f32_bf16 v107, s64, v196
    v_dot2c_f32_bf16 v109, v196, v196
    v_dot2c_f32_bf16 v108, s64, v197
    v_dot2c_f32_bf16 v110, v197, v197
    v_dot2c_f32_bf16 v107, s64, v198
    v_dot2c_f32_bf16 v109, v198, v198
    v_dot2c_f32_bf16 v108, s64, v199
    v_dot2c_f32_bf16 v110, v199, v199
    s_waitcnt lgkmcnt(5)
    v_dot2c_f32_bf16 v107, s64, v200
    v_dot2c_f32_bf16 v109, v200, v200
    v_dot2c_f32_bf16 v108, s64, v201
    v_dot2c_f32_bf16 v110, v201, v201
    v_dot2c_f32_bf16 v107, s64, v202
    v_dot2c_f32_bf16 v109, v202, v202
    v_dot2c_f32_bf16 v108, s64, v203
    v_dot2c_f32_bf16 v110, v203, v203
    s_waitcnt lgkmcnt(4)
    v_dot2c_f32_bf16 v107, s64, v204
    v_dot2c_f32_bf16 v109, v204, v204
    v_dot2c_f32_bf16 v108, s64, v205
    v_dot2c_f32_bf16 v110, v205, v205
    v_dot2c_f32_bf16 v107, s64, v206
    v_dot2c_f32_bf16 v109, v206, v206
    v_dot2c_f32_bf16 v108, s64, v207
    v_dot2c_f32_bf16 v110, v207, v207
    s_waitcnt vmcnt(24)
    ds_read_b128 v[224:227], v116 offset:32768
    ds_read_b128 v[228:231], v117 offset:32768
    ds_read_b128 v[232:235], v118 offset:32768
    ds_read_b128 v[236:239], v119 offset:32768
    s_waitcnt lgkmcnt(7)
    v_dot2c_f32_bf16 v107, s64, v208
    v_dot2c_f32_bf16 v109, v208, v208
    v_dot2c_f32_bf16 v108, s64, v209
    v_dot2c_f32_bf16 v110, v209, v209
    v_dot2c_f32_bf16 v107, s64, v210
    v_dot2c_f32_bf16 v109, v210, v210
    v_dot2c_f32_bf16 v108, s64, v211
    v_dot2c_f32_bf16 v110, v211, v211
    s_waitcnt lgkmcnt(6)
    v_dot2c_f32_bf16 v107, s64, v212
    v_dot2c_f32_bf16 v109, v212, v212
    v_dot2c_f32_bf16 v108, s64, v213
    v_dot2c_f32_bf16 v110, v213, v213
    v_dot2c_f32_bf16 v107, s64, v214
    v_dot2c_f32_bf16 v109, v214, v214
    v_dot2c_f32_bf16 v108, s64, v215
    v_dot2c_f32_bf16 v110, v215, v215
    s_waitcnt lgkmcnt(5)
    v_dot2c_f32_bf16 v107, s64, v216
    v_dot2c_f32_bf16 v109, v216, v216
    v_dot2c_f32_bf16 v108, s64, v217
    v_dot2c_f32_bf16 v110, v217, v217
    v_dot2c_f32_bf16 v107, s64, v218
    v_dot2c_f32_bf16 v109, v218, v218
    v_dot2c_f32_bf16 v108, s64, v219
    v_dot2c_f32_bf16 v110, v219, v219
    s_waitcnt lgkmcnt(4)
    v_dot2c_f32_bf16 v107, s64, v220
    v_dot2c_f32_bf16 v109, v220, v220
    v_dot2c_f32_bf16 v108, s64, v221
    v_dot2c_f32_bf16 v110, v221, v221
    v_dot2c_f32_bf16 v107, s64, v222
    v_dot2c_f32_bf16 v109, v222, v222
    v_dot2c_f32_bf16 v108, s64, v223
    v_dot2c_f32_bf16 v110, v223, v223
    s_add_u32 m0, s60, 98304
    s_nop 0
    buffer_load_dwordx4 v28, s[32:35], s56 offen offset:0 lds
    buffer_load_dwordx4 v29, s[32:35], s56 offen offset:1024 lds
    buffer_load_dwordx4 v30, s[32:35], s56 offen offset:2048 lds
    buffer_load_dwordx4 v31, s[32:35], s56 offen offset:3072 lds
    s_add_u32 m0, s60, 102400
    s_nop 0
    buffer_load_dwordx4 v32, s[32:35], s56 offen offset:0 lds
    buffer_load_dwordx4 v33, s[32:35], s56 offen offset:1024 lds
    buffer_load_dwordx4 v34, s[32:35], s56 offen offset:2048 lds
    buffer_load_dwordx4 v35, s[32:35], s56 offen offset:3072 lds
    s_add_u32 s56, s56, s57
    s_waitcnt lgkmcnt(3)
    v_dot2c_f32_bf16 v107, s64, v224
    v_dot2c_f32_bf16 v109, v224, v224
    v_dot2c_f32_bf16 v108, s64, v225
    v_dot2c_f32_bf16 v110, v225, v225
    v_dot2c_f32_bf16 v107, s64, v226
    v_dot2c_f32_bf16 v109, v226, v226
    v_dot2c_f32_bf16 v108, s64, v227
    v_dot2c_f32_bf16 v110, v227, v227
    s_waitcnt lgkmcnt(2)
    v_dot2c_f32_bf16 v107, s64, v228
    v_dot2c_f32_bf16 v109, v228, v228
    v_dot2c_f32_bf16 v108, s64, v229
    v_dot2c_f32_bf16 v110, v229, v229
    v_dot2c_f32_bf16 v107, s64, v230
    v_dot2c_f32_bf16 v109, v230, v230
    v_dot2c_f32_bf16 v108, s64, v231
    v_dot2c_f32_bf16 v110, v231, v231
    s_waitcnt lgkmcnt(1)
    v_dot2c_f32_bf16 v107, s64, v232
    v_dot2c_f32_bf16 v109, v232, v232
    v_dot2c_f32_bf16 v108, s64, v233
    v_dot2c_f32_bf16 v110, v233, v233
    v_dot2c_f32_bf16 v107, s64, v234
    v_dot2c_f32_bf16 v109, v234, v234
    v_dot2c_f32_bf16 v108, s64, v235
    v_dot2c_f32_bf16 v110, v235, v235
    s_waitcnt lgkmcnt(0)
    v_dot2c_f32_bf16 v107, s64, v236
    v_dot2c_f32_bf16 v109, v236, v236
    v_dot2c_f32_bf16 v108, s64, v237
    v_dot2c_f32_bf16 v110, v237, v237
    v_dot2c_f32_bf16 v107, s64, v238
    v_dot2c_f32_bf16 v109, v238, v238
    v_dot2c_f32_bf16 v108, s64, v239
    v_dot2c_f32_bf16 v110, v239, v239
    s_nop 1
    v_add_f32 v107, v107, v108
    v_add_f32 v109, v109, v110
    v_mov_b32 v108, v107
    v_mov_b32 v110, v109
    s_nop 0
    v_permlane32_swap_b32 v107, v108
    v_permlane32_swap_b32 v109, v110
    v_add_f32 v107, v107, v108
    v_add_f32 v109, v109, v110
    v_mul_f32 v107, 0x3b124925, v107
    v_mul_f32 v109, 0x3b124925, v109
    v_fma_f32 v109, -v107, v107, v109
    v_max_f32 v109, 0, v109
    v_add_f32 v109, 0x3727c5ac, v109
    v_rsq_f32 v109, v109
    s_nop 0
    v_mul_f32 v99, 0x3db8aa3b, v109
    v_mul_f32 v100, -v107, v99
    s_waitcnt vmcnt(24)
    s_barrier
    ds_read_b64_tr_b16 v[0:1], v52 offset:0
    ds_read_b64_tr_b16 v[2:3], v52 offset:2048
    ds_read_b64_tr_b16 v[4:5], v53 offset:0
    ds_read_b64_tr_b16 v[6:7], v53 offset:2048
    ds_read_b64_tr_b16 v[8:9], v54 offset:0
    ds_read_b64_tr_b16 v[10:11], v54 offset:2048
    ds_read_b64_tr_b16 v[12:13], v55 offset:0
    ds_read_b64_tr_b16 v[14:15], v55 offset:2048
    ds_read_b64_tr_b16 v[16:17], v52 offset:256
    ds_read_b64_tr_b16 v[18:19], v52 offset:2304
    ds_read_b64_tr_b16 v[20:21], v53 offset:256
    ds_read_b64_tr_b16 v[22:23], v53 offset:2304
    v_lshlrev_b32 v103, 16, v128
    v_and_b32 v104, s65, v128
    v_fma_f32 v103, v103, v99, v100
    v_fma_f32 v104, v104, v99, v100
    v_cvt_pk_bf16_f32 v128, v103, v104
    v_lshlrev_b32 v105, 16, v129
    v_and_b32 v106, s65, v129
    v_fma_f32 v105, v105, v99, v100
    v_fma_f32 v106, v106, v99, v100
    v_cvt_pk_bf16_f32 v129, v105, v106
    v_lshlrev_b32 v103, 16, v130
    v_and_b32 v104, s65, v130
    v_fma_f32 v103, v103, v99, v100
    v_fma_f32 v104, v104, v99, v100
    v_cvt_pk_bf16_f32 v130, v103, v104
    v_lshlrev_b32 v105, 16, v131
    v_and_b32 v106, s65, v131
    v_fma_f32 v105, v105, v99, v100
    v_fma_f32 v106, v106, v99, v100
    v_cvt_pk_bf16_f32 v131, v105, v106
    s_waitcnt lgkmcnt(8)
    s_nop 0
    v_mfma_f32_32x32x16_bf16 a[0:15], v[0:3], v[128:131], 0
    ds_read_b64_tr_b16 v[0:1], v54 offset:256
    ds_read_b64_tr_b16 v[2:3], v54 offset:2304
    v_lshlrev_b32 v103, 16, v132
    v_and_b32 v104, s65, v132
    v_mfma_f32_32x32x16_bf16 a[16:31], v[4:7], v[128:131], 0
    ds_read_b64_tr_b16 v[4:5], v55 offset:256
    ds_read_b64_tr_b16 v[6:7], v55 offset:2304
    v_fma_f32 v103, v103, v99, v100
    s_mul_i32 s61, s101, 9
    s_add_u32 s61, s61, 160
    v_min_u32 v250, 35, v240
    v_lshrrev_b32 v251, 2, v250
    v_add_u32 v251, s61, v251
    v_mul_u32_u24 v251, s100, v251
    v_and_b32 v250, 3, v250
    v_lshl_add_u32 v250, v250, 7, v251
    s_nop 0
    buffer_load_dword v26, v250, s[32:35], s73 offen
    s_waitcnt lgkmcnt(8)
    v_mfma_f32_32x32x16_bf16 a[32:47], v[8:11], v[128:131], 0
    ds_read_b64_tr_b16 v[8:9], v64 offset:16384
    ds_read_b64_tr_b16 v[10:11], v64 offset:17280
    v_fma_f32 v104, v104, v99, v100
    v_cvt_pk_bf16_f32 v132, v103, v104
    v_mfma_f32_32x32x16_bf16 a[48:63], v[12:15], v[128:131], 0
    ds_read_b64_tr_b16 v[12:13], v64 offset:16416
    ds_read_b64_tr_b16 v[14:15], v64 offset:17312
    v_lshlrev_b32 v105, 16, v133
    s_waitcnt lgkmcnt(8)
    v_mfma_f32_32x32x16_bf16 a[64:79], v[16:19], v[128:131], 0
    ds_read_b64_tr_b16 v[16:17], v64 offset:16448
    ds_read_b64_tr_b16 v[18:19], v64 offset:17344
    v_and_b32 v106, s65, v133
    v_fma_f32 v105, v105, v99, v100
    v_mfma_f32_32x32x16_bf16 a[80:95], v[20:23], v[128:131], 0
    ds_read_b64_tr_b16 v[20:21], v64 offset:16480
    ds_read_b64_tr_b16 v[22:23], v64 offset:17376
    v_fma_f32 v106, v106, v99, v100
    s_waitcnt lgkmcnt(8)
    v_mfma_f32_32x32x16_bf16 a[96:111], v[0:3], v[128:131], 0
    ds_read_b64_tr_b16 v[0:1], v64 offset:16512
    ds_read_b64_tr_b16 v[2:3], v64 offset:17408
    v_cvt_pk_bf16_f32 v133, v105, v106
    v_mfma_f32_32x32x16_bf16 a[112:127], v[4:7], v[128:131], 0
    ds_read_b64_tr_b16 v[4:5], v64 offset:16544
    ds_read_b64_tr_b16 v[6:7], v64 offset:17440
    v_lshlrev_b32 v103, 16, v134
    v_and_b32 v104, s65, v134
    s_waitcnt lgkmcnt(8)
    v_mfma_f32_32x32x16_bf16 a[128:143], v[8:11], v[128:131], 0
    ds_read_b64_tr_b16 v[8:9], v64 offset:16576
    ds_read_b64_tr_b16 v[10:11], v64 offset:17472
    v_fma_f32 v103, v103, v99, v100
    v_mfma_f32_32x32x16_bf16 a[144:159], v[12:15], v[128:131], 0
    ds_read_b64_tr_b16 v[12:13], v52 offset:8192
    ds_read_b64_tr_b16 v[14:15], v52 offset:10240
    v_fma_f32 v104, v104, v99, v100
    v_cvt_pk_bf16_f32 v134, v103, v104
    s_waitcnt lgkmcnt(8)
    v_mfma_f32_32x32x16_bf16 a[160:175], v[16:19], v[128:131], 0
    ds_read_b64_tr_b16 v[16:17], v53 offset:8192
    ds_read_b64_tr_b16 v[18:19], v53 offset:10240
    v_lshlrev_b32 v105, 16, v135
    v_mfma_f32_32x32x16_bf16 a[176:191], v[20:23], v[128:131], 0
    ds_read_b64_tr_b16 v[20:21], v54 offset:8192
    ds_read_b64_tr_b16 v[22:23], v54 offset:10240
    v_and_b32 v106, s65, v135
    v_fma_f32 v105, v105, v99, v100
    s_waitcnt lgkmcnt(8)
    v_mfma_f32_32x32x16_bf16 a[192:207], v[0:3], v[128:131], 0
    ds_read_b64_tr_b16 v[0:1], v55 offset:8192
    ds_read_b64_tr_b16 v[2:3], v55 offset:10240
    v_fma_f32 v106, v106, v99, v100
    v_mfma_f32_32x32x16_bf16 a[208:223], v[4:7], v[128:131], 0
    ds_read_b64_tr_b16 v[4:5], v52 offset:8448
    ds_read_b64_tr_b16 v[6:7], v52 offset:10496
    v_cvt_pk_bf16_f32 v135, v105, v106
    s_waitcnt lgkmcnt(8)
    v_mfma_f32_32x32x16_bf16 a[224:239], v[8:11], v[128:131], 0
    ds_read_b64_tr_b16 v[8:9], v53 offset:8448
    ds_read_b64_tr_b16 v[10:11], v53 offset:10496
    v_mfma_f32_32x32x16_bf16 a[0:15], v[12:15], v[132:135], a[0:15]
    ds_read_b64_tr_b16 v[12:13], v54 offset:8448
    ds_read_b64_tr_b16 v[14:15], v54 offset:10496
    v_lshlrev_b32 v103, 16, v136
    v_and_b32 v104, s65, v136
    s_waitcnt lgkmcnt(8)
    v_mfma_f32_32x32x16_bf16 a[16:31], v[16:19], v[132:135], a[16:31]
    ds_read_b64_tr_b16 v[16:17], v55 offset:8448
    ds_read_b64_tr_b16 v[18:19], v55 offset:10496
    v_fma_f32 v103, v103, v99, v100
    v_mfma_f32_32x32x16_bf16 a[32:47], v[20:23], v[132:135], a[32:47]
    ds_read_b64_tr_b16 v[20:21], v64 offset:19968
    ds_read_b64_tr_b16 v[22:23], v64 offset:20864
    v_fma_f32 v104, v104, v99, v100
    v_cvt_pk_bf16_f32 v136, v103, v104
    s_waitcnt lgkmcnt(8)
    v_mfma_f32_32x32x16_bf16 a[48:63], v[0:3], v[132:135], a[48:63]
    ds_read_b64_tr_b16 v[0:1], v64 offset:20000
    ds_read_b64_tr_b16 v[2:3], v64 offset:20896
    v_lshlrev_b32 v105, 16, v137
    v_mfma_f32_32x32x16_bf16 a[64:79], v[4:7], v[132:135], a[64:79]
    ds_read_b64_tr_b16 v[4:5], v64 offset:20032
    ds_read_b64_tr_b16 v[6:7], v64 offset:20928
    v_and_b32 v106, s65, v137
    v_fma_f32 v105, v105, v99, v100
    s_waitcnt lgkmcnt(8)
    v_mfma_f32_32x32x16_bf16 a[80:95], v[8:11], v[132:135], a[80:95]
    ds_read_b64_tr_b16 v[8:9], v64 offset:20064
    ds_read_b64_tr_b16 v[10:11], v64 offset:20960
    v_fma_f32 v106, v106, v99, v100
    v_mfma_f32_32x32x16_bf16 a[96:111], v[12:15], v[132:135], a[96:111]
    ds_read_b64_tr_b16 v[12:13], v64 offset:20096
    ds_read_b64_tr_b16 v[14:15], v64 offset:20992
    v_cvt_pk_bf16_f32 v137, v105, v106
    s_waitcnt lgkmcnt(8)
    v_mfma_f32_32x32x16_bf16 a[112:127], v[16:19], v[132:135], a[112:127]
    s_waitcnt vmcnt(17)
    s_barrier
    s_add_u32 m0, s60, 131072
    ds_read_b64_tr_b16 v[16:17], v64 offset:20128
    ds_read_b64_tr_b16 v[18:19], v64 offset:21024
    buffer_load_dwordx4 v28, s[32:35], s56 offen offset:0 lds
    v_lshlrev_b32 v103, 16, v138
    v_and_b32 v104, s65, v138
    v_mfma_f32_32x32x16_bf16 a[128:143], v[20:23], v[132:135], a[128:143]
    ds_read_b64_tr_b16 v[20:21], v64 offset:20160
    ds_read_b64_tr_b16 v[22:23], v64 offset:21056
    v_fma_f32 v103, v103, v99, v100
    s_waitcnt lgkmcnt(8)
    v_mfma_f32_32x32x16_bf16 a[144:159], v[0:3], v[132:135], a[144:159]
    ds_read_b64_tr_b16 v[0:1], v52 offset:32768
    ds_read_b64_tr_b16 v[2:3], v52 offset:34816
    v_fma_f32 v104, v104, v99, v100
    v_cvt_pk_bf16_f32 v138, v103, v104
    v_mfma_f32_32x32x16_bf16 a[160:175], v[4:7], v[132:135], a[160:175]
    ds_read_b64_tr_b16 v[4:5], v53 offset:32768
    ds_read_b64_tr_b16 v[6:7], v53 offset:34816
    buffer_load_dwordx4 v29, s[32:35], s56 offen offset:1024 lds
    v_lshlrev_b32 v105, 16, v139
    s_waitcnt lgkmcnt(8)
    v_mfma_f32_32x32x16_bf16 a[176:191], v[8:11], v[132:135], a[176:191]
    ds_read_b64_tr_b16 v[8:9], v54 offset:32768
    ds_read_b64_tr_b16 v[10:11], v54 offset:34816
    v_and_b32 v106, s65, v139
    v_fma_f32 v105, v105, v99, v100
    v_mfma_f32_32x32x16_bf16 a[192:207], v[12:15], v[132:135], a[192:207]
    ds_read_b64_tr_b16 v[12:13], v55 offset:32768
    ds_read_b64_tr_b16 v[14:15], v55 offset:34816
    v_fma_f32 v106, v106, v99, v100
    s_waitcnt lgkmcnt(8)
    v_mfma_f32_32x32x16_bf16 a[208:223], v[16:19], v[132:135], a[208:223]
    ds_read_b64_tr_b16 v[16:17], v52 offset:33024
    ds_read_b64_tr_b16 v[18:19], v52 offset:35072
    buffer_load_dwordx4 v30, s[32:35], s56 offen offset:2048 lds
    v_cvt_pk_bf16_f32 v139, v105, v106
    v_mfma_f32_32x32x16_bf16 a[224:239], v[20:23], v[132:135], a[224:239]
    ds_read_b64_tr_b16 v[20:21], v53 offset:33024
    ds_read_b64_tr_b16 v[22:23], v53 offset:35072
    s_waitcnt lgkmcnt(8)
    v_mfma_f32_32x32x16_bf16 a[0:15], v[0:3], v[136:139], a[0:15]
    ds_read_b64_tr_b16 v[0:1], v54 offset:33024
    ds_read_b64_tr_b16 v[2:3], v54 offset:35072
    v_lshlrev_b32 v103, 16, v140
    v_and_b32 v104, s65, v140
    v_mfma_f32_32x32x16_bf16 a[16:31], v[4:7], v[136:139], a[16:31]
    ds_read_b64_tr_b16 v[4:5], v55 offset:33024
    ds_read_b64_tr_b16 v[6:7], v55 offset:35072
    buffer_load_dwordx4 v31, s[32:35], s56 offen offset:3072 lds
    v_fma_f32 v103, v103, v99, v100
    s_waitcnt lgkmcnt(8)
    v_mfma_f32_32x32x16_bf16 a[32:47], v[8:11], v[136:139], a[32:47]
    ds_read_b64_tr_b16 v[8:9], v64 offset:49152
    ds_read_b64_tr_b16 v[10:11], v64 offset:50048
    v_fma_f32 v104, v104, v99, v100
    v_cvt_pk_bf16_f32 v140, v103, v104
    v_mfma_f32_32x32x16_bf16 a[48:63], v[12:15], v[136:139], a[48:63]
    ds_read_b64_tr_b16 v[12:13], v64 offset:49184
    ds_read_b64_tr_b16 v[14:15], v64 offset:50080
    v_lshlrev_b32 v105, 16, v141
    s_waitcnt lgkmcnt(8)
    v_mfma_f32_32x32x16_bf16 a[64:79], v[16:19], v[136:139], a[64:79]
    s_add_u32 m0, s60, 135168
    ds_read_b64_tr_b16 v[16:17], v64 offset:49216
    ds_read_b64_tr_b16 v[18:19], v64 offset:50112
    buffer_load_dwordx4 v32, s[32:35], s56 offen offset:0 lds
    v_and_b32 v106, s65, v141
    v_fma_f32 v105, v105, v99, v100
    v_mfma_f32_32x32x16_bf16 a[80:95], v[20:23], v[136:139], a[80:95]
    ds_read_b64_tr_b16 v[20:21], v64 offset:49248
    ds_read_b64_tr_b16 v[22:23], v64 offset:50144
    v_fma_f32 v106, v106, v99, v100
    s_waitcnt lgkmcnt(8)
    v_mfma_f32_32x32x16_bf16 a[96:111], v[0:3], v[136:139], a[96:111]
    ds_read_b64_tr_b16 v[0:1], v64 offset:49280
    ds_read_b64_tr_b16 v[2:3], v64 offset:50176
    v_cvt_pk_bf16_f32 v141, v105, v106
    v_mfma_f32_32x32x16_bf16 a[112:127], v[4:7], v[136:139], a[112:127]
    ds_read_b64_tr_b16 v[4:5], v64 offset:49312
    ds_read_b64_tr_b16 v[6:7], v64 offset:50208
    buffer_load_dwordx4 v33, s[32:35], s56 offen offset:1024 lds
    v_lshlrev_b32 v103, 16, v142
    v_and_b32 v104, s65, v142
    s_waitcnt lgkmcnt(8)
    v_mfma_f32_32x32x16_bf16 a[128:143], v[8:11], v[136:139], a[128:143]
    ds_read_b64_tr_b16 v[8:9], v64 offset:49344
    ds_read_b64_tr_b16 v[10:11], v64 offset:50240
    v_fma_f32 v103, v103, v99, v100
    v_mfma_f32_32x32x16_bf16 a[144:159], v[12:15], v[136:139], a[144:159]
    ds_read_b64_tr_b16 v[12:13], v52 offset:40960
    ds_read_b64_tr_b16 v[14:15], v52 offset:43008
    v_fma_f32 v104, v104, v99, v100
    v_cvt_pk_bf16_f32 v142, v103, v104
    s_waitcnt lgkmcnt(8)
    v_mfma_f32_32x32x16_bf16 a[160:175], v[16:19], v[136:139], a[160:175]
    ds_read_b64_tr_b16 v[16:17], v53 offset:40960
    ds_read_b64_tr_b16 v[18:19], v53 offset:43008
    buffer_load_dwordx4 v34, s[32:35], s56 offen offset:2048 lds
    v_lshlrev_b32 v105, 16, v143
    v_mfma_f32_32x32x16_bf16 a[176:191], v[20:23], v[136:139], a[176:191]
    ds_read_b64_tr_b16 v[20:21], v54 offset:40960
    ds_read_b64_tr_b16 v[22:23], v54 offset:43008
    v_and_b32 v106, s65, v143
    v_fma_f32 v105, v105, v99, v100
    s_waitcnt lgkmcnt(8)
    v_mfma_f32_32x32x16_bf16 a[192:207], v[0:3], v[136:139], a[192:207]
    ds_read_b64_tr_b16 v[0:1], v55 offset:40960
    ds_read_b64_tr_b16 v[2:3], v55 offset:43008
    v_fma_f32 v106, v106, v99, v100
    v_mfma_f32_32x32x16_bf16 a[208:223], v[4:7], v[136:139], a[208:223]
    ds_read_b64_tr_b16 v[4:5], v52 offset:41216
    ds_read_b64_tr_b16 v[6:7], v52 offset:43264
    buffer_load_dwordx4 v35, s[32:35], s56 offen offset:3072 lds
    s_add_u32 s56, s56, s57
    v_cvt_pk_bf16_f32 v143, v105, v106
    s_waitcnt lgkmcnt(8)
    v_mfma_f32_32x32x16_bf16 a[224:239], v[8:11], v[136:139], a[224:239]
    ds_read_b64_tr_b16 v[8:9], v53 offset:41216
    ds_read_b64_tr_b16 v[10:11], v53 offset:43264
    v_mfma_f32_32x32x16_bf16 a[0:15], v[12:15], v[140:143], a[0:15]
    ds_read_b64_tr_b16 v[12:13], v54 offset:41216
    ds_read_b64_tr_b16 v[14:15], v54 offset:43264
    v_lshlrev_b32 v103, 16, v144
    v_and_b32 v104, s65, v144
    s_waitcnt lgkmcnt(8)
    v_mfma_f32_32x32x16_bf16 a[16:31], v[16:19], v[140:143], a[16:31]
    ds_read_b64_tr_b16 v[16:17], v55 offset:41216
    ds_read_b64_tr_b16 v[18:19], v55 offset:43264
    v_fma_f32 v103, v103, v99, v100
    v_mfma_f32_32x32x16_bf16 a[32:47], v[20:23], v[140:143], a[32:47]
    ds_read_b64_tr_b16 v[20:21], v64 offset:52736
    ds_read_b64_tr_b16 v[22:23], v64 offset:53632
    v_fma_f32 v104, v104, v99, v100
    v_cvt_pk_bf16_f32 v144, v103, v104
    s_waitcnt lgkmcnt(8)
    v_mfma_f32_32x32x16_bf16 a[48:63], v[0:3], v[140:143], a[48:63]
    ds_read_b64_tr_b16 v[0:1], v64 offset:52768
    ds_read_b64_tr_b16 v[2:3], v64 offset:53664
    v_lshlrev_b32 v105, 16, v145
    v_mfma_f32_32x32x16_bf16 a[64:79], v[4:7], v[140:143], a[64:79]
    ds_read_b64_tr_b16 v[4:5], v64 offset:52800
    ds_read_b64_tr_b16 v[6:7], v64 offset:53696
    v_and_b32 v106, s65, v145
    v_fma_f32 v105, v105, v99, v100
    s_waitcnt lgkmcnt(8)
    v_mfma_f32_32x32x16_bf16 a[80:95], v[8:11], v[140:143], a[80:95]
    ds_read_b64_tr_b16 v[8:9], v64 offset:52832
    ds_read_b64_tr_b16 v[10:11], v64 offset:53728
    v_fma_f32 v106, v106, v99, v100
    v_mfma_f32_32x32x16_bf16 a[96:111], v[12:15], v[140:143], a[96:111]
    ds_read_b64_tr_b16 v[12:13], v64 offset:52864
    ds_read_b64_tr_b16 v[14:15], v64 offset:53760
    v_cvt_pk_bf16_f32 v145, v105, v106
    s_waitcnt lgkmcnt(8)
    v_mfma_f32_32x32x16_bf16 a[112:127], v[16:19], v[140:143], a[112:127]
    s_waitcnt vmcnt(17)
    s_barrier
    s_add_u32 m0, s60, 0
    ds_read_b64_tr_b16 v[16:17], v64 offset:52896
    ds_read_b64_tr_b16 v[18:19], v64 offset:53792
    buffer_load_dwordx4 v28, s[32:35], s56 offen offset:0 lds
    v_lshlrev_b32 v103, 16, v146
    v_and_b32 v104, s65, v146
    v_mfma_f32_32x32x16_bf16 a[128:143], v[20:23], v[140:143], a[128:143]
    ds_read_b64_tr_b16 v[20:21], v64 offset:52928
    ds_read_b64_tr_b16 v[22:23], v64 offset:53824
    v_fma_f32 v103, v103, v99, v100
    s_waitcnt lgkmcnt(8)
    v_mfma_f32_32x32x16_bf16 a[144:159], v[0:3], v[140:143], a[144:159]
    ds_read_b64_tr_b16 v[0:1], v56 offset:0
    ds_read_b64_tr_b16 v[2:3], v56 offset:2048
    v_fma_f32 v104, v104, v99, v100
    v_cvt_pk_bf16_f32 v146, v103, v104
    v_mfma_f32_32x32x16_bf16 a[160:175], v[4:7], v[140:143], a[160:175]
    ds_read_b64_tr_b16 v[4:5], v57 offset:0
    ds_read_b64_tr_b16 v[6:7], v57 offset:2048
    buffer_load_dwordx4 v29, s[32:35], s56 offen offset:1024 lds
    v_lshlrev_b32 v105, 16, v147
    s_waitcnt lgkmcnt(8)
    v_mfma_f32_32x32x16_bf16 a[176:191], v[8:11], v[140:143], a[176:191]
    ds_read_b64_tr_b16 v[8:9], v58 offset:0
    ds_read_b64_tr_b16 v[10:11], v58 offset:2048
    v_and_b32 v106, s65, v147
    v_fma_f32 v105, v105, v99, v100
    v_mfma_f32_32x32x16_bf16 a[192:207], v[12:15], v[140:143], a[192:207]
    ds_read_b64_tr_b16 v[12:13], v59 offset:0
    ds_read_b64_tr_b16 v[14:15], v59 offset:2048
    v_fma_f32 v106, v106, v99, v100
    s_waitcnt lgkmcnt(8)
    v_mfma_f32_32x32x16_bf16 a[208:223], v[16:19], v[140:143], a[208:223]
    ds_read_b64_tr_b16 v[16:17], v56 offset:256
    ds_read_b64_tr_b16 v[18:19], v56 offset:2304
    buffer_load_dwordx4 v30, s[32:35], s56 offen offset:2048 lds
    v_cvt_pk_bf16_f32 v147, v105, v106
    v_mfma_f32_32x32x16_bf16 a[224:239], v[20:23], v[140:143], a[224:239]
    ds_read_b64_tr_b16 v[20:21], v57 offset:256
    ds_read_b64_tr_b16 v[22:23], v57 offset:2304
    s_waitcnt lgkmcnt(8)
    v_mfma_f32_32x32x16_bf16 a[0:15], v[0:3], v[144:147], a[0:15]
    ds_read_b64_tr_b16 v[0:1], v58 offset:256
    ds_read_b64_tr_b16 v[2:3], v58 offset:2304
    v_lshlrev_b32 v103, 16, v148
    v_and_b32 v104, s65, v148
    v_mfma_f32_32x32x16_bf16 a[16:31], v[4:7], v[144:147], a[16:31]
    ds_read_b64_tr_b16 v[4:5], v59 offset:256
    ds_read_b64_tr_b16 v[6:7], v59 offset:2304
    buffer_load_dwordx4 v31, s[32:35], s56 offen offset:3072 lds
    v_fma_f32 v103, v103, v99, v100
    s_waitcnt lgkmcnt(8)
    v_mfma_f32_32x32x16_bf16 a[32:47], v[8:11], v[144:147], a[32:47]
    ds_read_b64_tr_b16 v[8:9], v65 offset:16384
    ds_read_b64_tr_b16 v[10:11], v65 offset:17280
    v_fma_f32 v104, v104, v99, v100
    v_cvt_pk_bf16_f32 v148, v103, v104
    v_mfma_f32_32x32x16_bf16 a[48:63], v[12:15], v[144:147], a[48:63]
    ds_read_b64_tr_b16 v[12:13], v65 offset:16416
    ds_read_b64_tr_b16 v[14:15], v65 offset:17312
    v_lshlrev_b32 v105, 16, v149
    s_waitcnt lgkmcnt(8)
    v_mfma_f32_32x32x16_bf16 a[64:79], v[16:19], v[144:147], a[64:79]
    s_add_u32 m0, s60, 4096
    ds_read_b64_tr_b16 v[16:17], v65 offset:16448
    ds_read_b64_tr_b16 v[18:19], v65 offset:17344
    buffer_load_dwordx4 v32, s[32:35], s56 offen offset:0 lds
    v_and_b32 v106, s65, v149
    v_fma_f32 v105, v105, v99, v100
    v_mfma_f32_32x32x16_bf16 a[80:95], v[20:23], v[144:147], a[80:95]
    ds_read_b64_tr_b16 v[20:21], v65 offset:16480
    ds_read_b64_tr_b16 v[22:23], v65 offset:17376
    v_fma_f32 v106, v106, v99, v100
    s_waitcnt lgkmcnt(8)
    v_mfma_f32_32x32x16_bf16 a[96:111], v[0:3], v[144:147], a[96:111]
    ds_read_b64_tr_b16 v[0:1], v65 offset:16512
    ds_read_b64_tr_b16 v[2:3], v65 offset:17408
    v_cvt_pk_bf16_f32 v149, v105, v106
    v_mfma_f32_32x32x16_bf16 a[112:127], v[4:7], v[144:147], a[112:127]
    ds_read_b64_tr_b16 v[4:5], v65 offset:16544
    ds_read_b64_tr_b16 v[6:7], v65 offset:17440
    buffer_load_dwordx4 v33, s[32:35], s56 offen offset:1024 lds
    v_lshlrev_b32 v103, 16, v150
    v_and_b32 v104, s65, v150
    s_waitcnt lgkmcnt(8)
    v_mfma_f32_32x32x16_bf16 a[128:143], v[8:11], v[144:147], a[128:143]
    ds_read_b64_tr_b16 v[8:9], v65 offset:16576
    ds_read_b64_tr_b16 v[10:11], v65 offset:17472
    v_fma_f32 v103, v103, v99, v100
    v_mfma_f32_32x32x16_bf16 a[144:159], v[12:15], v[144:147], a[144:159]
    ds_read_b64_tr_b16 v[12:13], v56 offset:8192
    ds_read_b64_tr_b16 v[14:15], v56 offset:10240
    v_fma_f32 v104, v104, v99, v100
    v_cvt_pk_bf16_f32 v150, v103, v104
    s_waitcnt lgkmcnt(8)
    v_mfma_f32_32x32x16_bf16 a[160:175], v[16:19], v[144:147], a[160:175]
    ds_read_b64_tr_b16 v[16:17], v57 offset:8192
    ds_read_b64_tr_b16 v[18:19], v57 offset:10240
    buffer_load_dwordx4 v34, s[32:35], s56 offen offset:2048 lds
    v_lshlrev_b32 v105, 16, v151
    v_mfma_f32_32x32x16_bf16 a[176:191], v[20:23], v[144:147], a[176:191]
    ds_read_b64_tr_b16 v[20:21], v58 offset:8192
    ds_read_b64_tr_b16 v[22:23], v58 offset:10240
    v_and_b32 v106, s65, v151
    v_fma_f32 v105, v105, v99, v100
    s_waitcnt lgkmcnt(8)
    v_mfma_f32_32x32x16_bf16 a[192:207], v[0:3], v[144:147], a[192:207]
    ds_read_b64_tr_b16 v[0:1], v59 offset:8192
    ds_read_b64_tr_b16 v[2:3], v59 offset:10240
    v_fma_f32 v106, v106, v99, v100
    v_mfma_f32_32x32x16_bf16 a[208:223], v[4:7], v[144:147], a[208:223]
    ds_read_b64_tr_b16 v[4:5], v56 offset:8448
    ds_read_b64_tr_b16 v[6:7], v56 offset:10496
    buffer_load_dwordx4 v35, s[32:35], s56 offen offset:3072 lds
    s_add_u32 s56, s56, s57
    v_cvt_pk_bf16_f32 v151, v105, v106
    s_waitcnt lgkmcnt(8)
    v_mfma_f32_32x32x16_bf16 a[224:239], v[8:11], v[144:147], a[224:239]
    ds_read_b64_tr_b16 v[8:9], v57 offset:8448
    ds_read_b64_tr_b16 v[10:11], v57 offset:10496
    v_mfma_f32_32x32x16_bf16 a[0:15], v[12:15], v[148:151], a[0:15]
    ds_read_b64_tr_b16 v[12:13], v58 offset:8448
    ds_read_b64_tr_b16 v[14:15], v58 offset:10496
    v_lshlrev_b32 v103, 16, v152
    v_and_b32 v104, s65, v152
    s_waitcnt lgkmcnt(8)
    v_mfma_f32_32x32x16_bf16 a[16:31], v[16:19], v[148:151], a[16:31]
    ds_read_b64_tr_b16 v[16:17], v59 offset:8448
    ds_read_b64_tr_b16 v[18:19], v59 offset:10496
    v_fma_f32 v103, v103, v99, v100
    v_mfma_f32_32x32x16_bf16 a[32:47], v[20:23], v[148:151], a[32:47]
    ds_read_b64_tr_b16 v[20:21], v65 offset:19968
    ds_read_b64_tr_b16 v[22:23], v65 offset:20864
    v_fma_f32 v104, v104, v99, v100
    v_cvt_pk_bf16_f32 v152, v103, v104
    s_waitcnt lgkmcnt(8)
    v_mfma_f32_32x32x16_bf16 a[48:63], v[0:3], v[148:151], a[48:63]
    ds_read_b64_tr_b16 v[0:1], v65 offset:20000
    ds_read_b64_tr_b16 v[2:3], v65 offset:20896
    v_lshlrev_b32 v105, 16, v153
    v_mfma_f32_32x32x16_bf16 a[64:79], v[4:7], v[148:151], a[64:79]
    ds_read_b64_tr_b16 v[4:5], v65 offset:20032
    ds_read_b64_tr_b16 v[6:7], v65 offset:20928
    v_and_b32 v106, s65, v153
    v_fma_f32 v105, v105, v99, v100
    s_waitcnt lgkmcnt(8)
    v_mfma_f32_32x32x16_bf16 a[80:95], v[8:11], v[148:151], a[80:95]
    ds_read_b64_tr_b16 v[8:9], v65 offset:20064
    ds_read_b64_tr_b16 v[10:11], v65 offset:20960
    v_fma_f32 v106, v106, v99, v100
    v_mfma_f32_32x32x16_bf16 a[96:111], v[12:15], v[148:151], a[96:111]
    ds_read_b64_tr_b16 v[12:13], v65 offset:20096
    ds_read_b64_tr_b16 v[14:15], v65 offset:20992
    v_cvt_pk_bf16_f32 v153, v105, v106
    s_waitcnt lgkmcnt(8)
    v_mfma_f32_32x32x16_bf16 a[112:127], v[16:19], v[148:151], a[112:127]
    s_waitcnt vmcnt(17)
    s_barrier
    s_add_u32 m0, s60, 32768
    ds_read_b64_tr_b16 v[16:17], v65 offset:20128
    ds_read_b64_tr_b16 v[18:19], v65 offset:21024
    buffer_load_dwordx4 v28, s[32:35], s56 offen offset:0 lds
    v_lshlrev_b32 v103, 16, v154
    v_and_b32 v104, s65, v154
    v_mfma_f32_32x32x16_bf16 a[128:143], v[20:23], v[148:151], a[128:143]
    ds_read_b64_tr_b16 v[20:21], v65 offset:20160
    ds_read_b64_tr_b16 v[22:23], v65 offset:21056
    v_fma_f32 v103, v103, v99, v100
    s_waitcnt lgkmcnt(8)
    v_mfma_f32_32x32x16_bf16 a[144:159], v[0:3], v[148:151], a[144:159]
    ds_read_b64_tr_b16 v[0:1], v56 offset:32768
    ds_read_b64_tr_b16 v[2:3], v56 offset:34816
    v_fma_f32 v104, v104, v99, v100
    v_cvt_pk_bf16_f32 v154, v103, v104
    v_mfma_f32_32x32x16_bf16 a[160:175], v[4:7], v[148:151], a[160:175]
    ds_read_b64_tr_b16 v[4:5], v57 offset:32768
    ds_read_b64_tr_b16 v[6:7], v57 offset:34816
    buffer_load_dwordx4 v29, s[32:35], s56 offen offset:1024 lds
    v_lshlrev_b32 v105, 16, v155
    s_waitcnt lgkmcnt(8)
    v_mfma_f32_32x32x16_bf16 a[176:191], v[8:11], v[148:151], a[176:191]
    ds_read_b64_tr_b16 v[8:9], v58 offset:32768
    ds_read_b64_tr_b16 v[10:11], v58 offset:34816
    v_and_b32 v106, s65, v155
    v_fma_f32 v105, v105, v99, v100
    v_mfma_f32_32x32x16_bf16 a[192:207], v[12:15], v[148:151], a[192:207]
    ds_read_b64_tr_b16 v[12:13], v59 offset:32768
    ds_read_b64_tr_b16 v[14:15], v59 offset:34816
    v_fma_f32 v106, v106, v99, v100
    s_waitcnt lgkmcnt(8)
    v_mfma_f32_32x32x16_bf16 a[208:223], v[16:19], v[148:151], a[208:223]
    ds_read_b64_tr_b16 v[16:17], v56 offset:33024
    ds_read_b64_tr_b16 v[18:19], v56 offset:35072
    buffer_load_dwordx4 v30, s[32:35], s56 offen offset:2048 lds
    v_cvt_pk_bf16_f32 v155, v105, v106
    v_mfma_f32_32x32x16_bf16 a[224:239], v[20:23], v[148:151], a[224:239]
    ds_read_b64_tr_b16 v[20:21], v57 offset:33024
    ds_read_b64_tr_b16 v[22:23], v57 offset:35072
    s_waitcnt lgkmcnt(8)
    v_mfma_f32_32x32x16_bf16 a[0:15], v[0:3], v[152:155], a[0:15]
    ds_read_b64_tr_b16 v[0:1], v58 offset:33024
    ds_read_b64_tr_b16 v[2:3], v58 offset:35072
    v_lshlrev_b32 v103, 16, v156
    v_and_b32 v104, s65, v156
    v_mfma_f32_32x32x16_bf16 a[16:31], v[4:7], v[152:155], a[16:31]
    ds_read_b64_tr_b16 v[4:5], v59 offset:33024
    ds_read_b64_tr_b16 v[6:7], v59 offset:35072
    buffer_load_dwordx4 v31, s[32:35], s56 offen offset:3072 lds
    v_fma_f32 v103, v103, v99, v100
    s_waitcnt lgkmcnt(8)
    v_mfma_f32_32x32x16_bf16 a[32:47], v[8:11], v[152:155], a[32:47]
    ds_read_b64_tr_b16 v[8:9], v65 offset:49152
    ds_read_b64_tr_b16 v[10:11], v65 offset:50048
    v_fma_f32 v104, v104, v99, v100
    v_cvt_pk_bf16_f32 v156, v103, v104
    v_mfma_f32_32x32x16_bf16 a[48:63], v[12:15], v[152:155], a[48:63]
    ds_read_b64_tr_b16 v[12:13], v65 offset:49184
    ds_read_b64_tr_b16 v[14:15], v65 offset:50080
    v_lshlrev_b32 v105, 16, v157
    s_lshl_b32 s61, s3, 2
    s_add_u32 s61, s61, s52
    s_mul_i32 s61, s61, 1568
    s_mul_i32 s62, s53, 100352
    s_add_u32 s61, s61, s62
    v_mov_b32 v25, 0
    v_min_u32 v24, 192, v97
    v_lshl_add_u32 v24, v24, 3, v25
    s_nop 0
    buffer_load_dword v26, v24, s[44:47], s61 offen
    s_waitcnt lgkmcnt(8)
    v_mfma_f32_32x32x16_bf16 a[64:79], v[16:19], v[152:155], a[64:79]
    s_add_u32 m0, s60, 36864
    ds_read_b64_tr_b16 v[16:17], v65 offset:49216
    ds_read_b64_tr_b16 v[18:19], v65 offset:50112
    buffer_load_dwordx4 v32, s[32:35], s56 offen offset:0 lds
    v_and_b32 v106, s65, v157
    v_fma_f32 v105, v105, v99, v100
    v_mfma_f32_32x32x16_bf16 a[80:95], v[20:23], v[152:155], a[80:95]
    ds_read_b64_tr_b16 v[20:21], v65 offset:49248
    ds_read_b64_tr_b16 v[22:23], v65 offset:50144
    v_fma_f32 v106, v106, v99, v100
    s_waitcnt lgkmcnt(8)
    v_mfma_f32_32x32x16_bf16 a[96:111], v[0:3], v[152:155], a[96:111]
    ds_read_b64_tr_b16 v[0:1], v65 offset:49280
    ds_read_b64_tr_b16 v[2:3], v65 offset:50176
    v_cvt_pk_bf16_f32 v157, v105, v106
    v_mfma_f32_32x32x16_bf16 a[112:127], v[4:7], v[152:155], a[112:127]
    ds_read_b64_tr_b16 v[4:5], v65 offset:49312
    ds_read_b64_tr_b16 v[6:7], v65 offset:50208
    buffer_load_dwordx4 v33, s[32:35], s56 offen offset:1024 lds
    v_lshlrev_b32 v103, 16, v158
    v_and_b32 v104, s65, v158
    s_waitcnt lgkmcnt(8)
    v_mfma_f32_32x32x16_bf16 a[128:143], v[8:11], v[152:155], a[128:143]
    ds_read_b64_tr_b16 v[8:9], v65 offset:49344
    ds_read_b64_tr_b16 v[10:11], v65 offset:50240
    v_fma_f32 v103, v103, v99, v100
    v_mfma_f32_32x32x16_bf16 a[144:159], v[12:15], v[152:155], a[144:159]
    ds_read_b64_tr_b16 v[12:13], v56 offset:40960
    ds_read_b64_tr_b16 v[14:15], v56 offset:43008
    v_fma_f32 v104, v104, v99, v100
    v_cvt_pk_bf16_f32 v158, v103, v104
    s_waitcnt lgkmcnt(8)
    v_mfma_f32_32x32x16_bf16 a[160:175], v[16:19], v[152:155], a[160:175]
    ds_read_b64_tr_b16 v[16:17], v57 offset:40960
    ds_read_b64_tr_b16 v[18:19], v57 offset:43008
    buffer_load_dwordx4 v34, s[32:35], s56 offen offset:2048 lds
    v_lshlrev_b32 v105, 16, v159
    v_mfma_f32_32x32x16_bf16 a[176:191], v[20:23], v[152:155], a[176:191]
    ds_read_b64_tr_b16 v[20:21], v58 offset:40960
    ds_read_b64_tr_b16 v[22:23], v58 offset:43008
    v_and_b32 v106, s65, v159
    v_fma_f32 v105, v105, v99, v100
    s_waitcnt lgkmcnt(8)
    v_mfma_f32_32x32x16_bf16 a[192:207], v[0:3], v[152:155], a[192:207]
    ds_read_b64_tr_b16 v[0:1], v59 offset:40960
    ds_read_b64_tr_b16 v[2:3], v59 offset:43008
    v_fma_f32 v106, v106, v99, v100
    v_mfma_f32_32x32x16_bf16 a[208:223], v[4:7], v[152:155], a[208:223]
    ds_read_b64_tr_b16 v[4:5], v56 offset:41216
    ds_read_b64_tr_b16 v[6:7], v56 offset:43264
    buffer_load_dwordx4 v35, s[32:35], s56 offen offset:3072 lds
    s_add_u32 s56, s56, s57
    v_cvt_pk_bf16_f32 v159, v105, v106
    s_waitcnt lgkmcnt(8)
    v_mfma_f32_32x32x16_bf16 a[224:239], v[8:11], v[152:155], a[224:239]
    ds_read_b64_tr_b16 v[8:9], v57 offset:41216
    ds_read_b64_tr_b16 v[10:11], v57 offset:43264
    v_mfma_f32_32x32x16_bf16 a[0:15], v[12:15], v[156:159], a[0:15]
    ds_read_b64_tr_b16 v[12:13], v58 offset:41216
    ds_read_b64_tr_b16 v[14:15], v58 offset:43264
    v_lshlrev_b32 v103, 16, v160
    v_and_b32 v104, s65, v160
    s_waitcnt lgkmcnt(8)
    v_mfma_f32_32x32x16_bf16 a[16:31], v[16:19], v[156:159], a[16:31]
    ds_read_b64_tr_b16 v[16:17], v59 offset:41216
    ds_read_b64_tr_b16 v[18:19], v59 offset:43264
    v_fma_f32 v103, v103, v99, v100
    v_mfma_f32_32x32x16_bf16 a[32:47], v[20:23], v[156:159], a[32:47]
    ds_read_b64_tr_b16 v[20:21], v65 offset:52736
    ds_read_b64_tr_b16 v[22:23], v65 offset:53632
    v_fma_f32 v104, v104, v99, v100
    v_cvt_pk_bf16_f32 v160, v103, v104
    s_waitcnt lgkmcnt(8)
    v_mfma_f32_32x32x16_bf16 a[48:63], v[0:3], v[156:159], a[48:63]
    ds_read_b64_tr_b16 v[0:1], v65 offset:52768
    ds_read_b64_tr_b16 v[2:3], v65 offset:53664
    v_lshlrev_b32 v105, 16, v161
    v_mfma_f32_32x32x16_bf16 a[64:79], v[4:7], v[156:159], a[64:79]
    ds_read_b64_tr_b16 v[4:5], v65 offset:52800
    ds_read_b64_tr_b16 v[6:7], v65 offset:53696
    v_and_b32 v106, s65, v161
    v_fma_f32 v105, v105, v99, v100
    s_waitcnt lgkmcnt(8)
    v_mfma_f32_32x32x16_bf16 a[80:95], v[8:11], v[156:159], a[80:95]
    ds_read_b64_tr_b16 v[8:9], v65 offset:52832
    ds_read_b64_tr_b16 v[10:11], v65 offset:53728
    v_fma_f32 v106, v106, v99, v100
    v_mfma_f32_32x32x16_bf16 a[96:111], v[12:15], v[156:159], a[96:111]
    ds_read_b64_tr_b16 v[12:13], v65 offset:52864
    ds_read_b64_tr_b16 v[14:15], v65 offset:53760
    v_cvt_pk_bf16_f32 v161, v105, v106
    s_waitcnt lgkmcnt(8)
    v_mfma_f32_32x32x16_bf16 a[112:127], v[16:19], v[156:159], a[112:127]
    s_waitcnt vmcnt(17)
    s_barrier
    s_add_u32 m0, s60, 65536
    ds_read_b64_tr_b16 v[16:17], v65 offset:52896
    ds_read_b64_tr_b16 v[18:19], v65 offset:53792
    buffer_load_dwordx4 v28, s[32:35], s56 offen offset:0 lds
    v_lshlrev_b32 v103, 16, v162
    v_and_b32 v104, s65, v162
    v_mfma_f32_32x32x16_bf16 a[128:143], v[20:23], v[156:159], a[128:143]
    ds_read_b64_tr_b16 v[20:21], v65 offset:52928
    ds_read_b64_tr_b16 v[22:23], v65 offset:53824
    v_fma_f32 v103, v103, v99, v100
    s_waitcnt lgkmcnt(8)
    v_mfma_f32_32x32x16_bf16 a[144:159], v[0:3], v[156:159], a[144:159]
    ds_read_b64_tr_b16 v[0:1], v60 offset:0
    ds_read_b64_tr_b16 v[2:3], v60 offset:2048
    v_fma_f32 v104, v104, v99, v100
    v_cvt_pk_bf16_f32 v162, v103, v104
    v_mfma_f32_32x32x16_bf16 a[160:175], v[4:7], v[156:159], a[160:175]
    ds_read_b64_tr_b16 v[4:5], v61 offset:0
    ds_read_b64_tr_b16 v[6:7], v61 offset:2048
    buffer_load_dwordx4 v29, s[32:35], s56 offen offset:1024 lds
    v_lshlrev_b32 v105, 16, v163
    s_waitcnt lgkmcnt(8)
    v_mfma_f32_32x32x16_bf16 a[176:191], v[8:11], v[156:159], a[176:191]
    ds_read_b64_tr_b16 v[8:9], v62 offset:0
    ds_read_b64_tr_b16 v[10:11], v62 offset:2048
    v_and_b32 v106, s65, v163
    v_fma_f32 v105, v105, v99, v100
    v_mfma_f32_32x32x16_bf16 a[192:207], v[12:15], v[156:159], a[192:207]
    ds_read_b64_tr_b16 v[12:13], v63 offset:0
    ds_read_b64_tr_b16 v[14:15], v63 offset:2048
    v_fma_f32 v106, v106, v99, v100
    s_waitcnt lgkmcnt(8)
    v_mfma_f32_32x32x16_bf16 a[208:223], v[16:19], v[156:159], a[208:223]
    ds_read_b64_tr_b16 v[16:17], v60 offset:256
    ds_read_b64_tr_b16 v[18:19], v60 offset:2304
    buffer_load_dwordx4 v30, s[32:35], s56 offen offset:2048 lds
    v_cvt_pk_bf16_f32 v163, v105, v106
    v_mfma_f32_32x32x16_bf16 a[224:239], v[20:23], v[156:159], a[224:239]
    ds_read_b64_tr_b16 v[20:21], v61 offset:256
    ds_read_b64_tr_b16 v[22:23], v61 offset:2304
    s_waitcnt lgkmcnt(8)
    v_mfma_f32_32x32x16_bf16 a[0:15], v[0:3], v[160:163], a[0:15]
    ds_read_b64_tr_b16 v[0:1], v62 offset:256
    ds_read_b64_tr_b16 v[2:3], v62 offset:2304
    v_lshlrev_b32 v103, 16, v164
    v_and_b32 v104, s65, v164
    v_mfma_f32_32x32x16_bf16 a[16:31], v[4:7], v[160:163], a[16:31]
    ds_read_b64_tr_b16 v[4:5], v63 offset:256
    ds_read_b64_tr_b16 v[6:7], v63 offset:2304
    buffer_load_dwordx4 v31, s[32:35], s56 offen offset:3072 lds
    v_fma_f32 v103, v103, v99, v100
    s_waitcnt lgkmcnt(8)
    v_mfma_f32_32x32x16_bf16 a[32:47], v[8:11], v[160:163], a[32:47]
    ds_read_b64_tr_b16 v[8:9], v66 offset:16384
    ds_read_b64_tr_b16 v[10:11], v66 offset:17280
    v_fma_f32 v104, v104, v99, v100
    v_cvt_pk_bf16_f32 v164, v103, v104
    v_mfma_f32_32x32x16_bf16 a[48:63], v[12:15], v[160:163], a[48:63]
    ds_read_b64_tr_b16 v[12:13], v66 offset:16416
    ds_read_b64_tr_b16 v[14:15], v66 offset:17312
    v_lshlrev_b32 v105, 16, v165
    s_waitcnt lgkmcnt(8)
    v_mfma_f32_32x32x16_bf16 a[64:79], v[16:19], v[160:163], a[64:79]
    s_add_u32 m0, s60, 69632
    ds_read_b64_tr_b16 v[16:17], v66 offset:16448
    ds_read_b64_tr_b16 v[18:19], v66 offset:17344
    buffer_load_dwordx4 v32, s[32:35], s56 offen offset:0 lds
    v_and_b32 v106, s65, v165
    v_fma_f32 v105, v105, v99, v100
    v_mfma_f32_32x32x16_bf16 a[80:95], v[20:23], v[160:163], a[80:95]
    ds_read_b64_tr_b16 v[20:21], v66 offset:16480
    ds_read_b64_tr_b16 v[22:23], v66 offset:17376
    v_fma_f32 v106, v106, v99, v100
    s_waitcnt lgkmcnt(8)
    v_mfma_f32_32x32x16_bf16 a[96:111], v[0:3], v[160:163], a[96:111]
    ds_read_b64_tr_b16 v[0:1], v66 offset:16512
    ds_read_b64_tr_b16 v[2:3], v66 offset:17408
    v_cvt_pk_bf16_f32 v165, v105, v106
    v_mfma_f32_32x32x16_bf16 a[112:127], v[4:7], v[160:163], a[112:127]
    ds_read_b64_tr_b16 v[4:5], v66 offset:16544
    ds_read_b64_tr_b16 v[6:7], v66 offset:17440
    buffer_load_dwordx4 v33, s[32:35], s56 offen offset:1024 lds
    v_lshlrev_b32 v103, 16, v166
    v_and_b32 v104, s65, v166
    s_waitcnt lgkmcnt(8)
    v_mfma_f32_32x32x16_bf16 a[128:143], v[8:11], v[160:163], a[128:143]
    ds_read_b64_tr_b16 v[8:9], v66 offset:16576
    ds_read_b64_tr_b16 v[10:11], v66 offset:17472
    v_fma_f32 v103, v103, v99, v100
    v_mfma_f32_32x32x16_bf16 a[144:159], v[12:15], v[160:163], a[144:159]
    ds_read_b64_tr_b16 v[12:13], v60 offset:8192
    ds_read_b64_tr_b16 v[14:15], v60 offset:10240
    v_fma_f32 v104, v104, v99, v100
    v_cvt_pk_bf16_f32 v166, v103, v104
    s_waitcnt lgkmcnt(8)
    v_mfma_f32_32x32x16_bf16 a[160:175], v[16:19], v[160:163], a[160:175]
    ds_read_b64_tr_b16 v[16:17], v61 offset:8192
    ds_read_b64_tr_b16 v[18:19], v61 offset:10240
    buffer_load_dwordx4 v34, s[32:35], s56 offen offset:2048 lds
    v_lshlrev_b32 v105, 16, v167
    v_mfma_f32_32x32x16_bf16 a[176:191], v[20:23], v[160:163], a[176:191]
    ds_read_b64_tr_b16 v[20:21], v62 offset:8192
    ds_read_b64_tr_b16 v[22:23], v62 offset:10240
    v_and_b32 v106, s65, v167
    v_fma_f32 v105, v105, v99, v100
    s_waitcnt lgkmcnt(8)
    v_mfma_f32_32x32x16_bf16 a[192:207], v[0:3], v[160:163], a[192:207]
    ds_read_b64_tr_b16 v[0:1], v63 offset:8192
    ds_read_b64_tr_b16 v[2:3], v63 offset:10240
    v_fma_f32 v106, v106, v99, v100
    v_mfma_f32_32x32x16_bf16 a[208:223], v[4:7], v[160:163], a[208:223]
    ds_read_b64_tr_b16 v[4:5], v60 offset:8448
    ds_read_b64_tr_b16 v[6:7], v60 offset:10496
    buffer_load_dwordx4 v35, s[32:35], s56 offen offset:3072 lds
    s_add_u32 s56, s56, s57
    v_cvt_pk_bf16_f32 v167, v105, v106
    s_waitcnt lgkmcnt(8)
    v_mfma_f32_32x32x16_bf16 a[224:239], v[8:11], v[160:163], a[224:239]
    ds_read_b64_tr_b16 v[8:9], v61 offset:8448
    ds_read_b64_tr_b16 v[10:11], v61 offset:10496
    v_mfma_f32_32x32x16_bf16 a[0:15], v[12:15], v[164:167], a[0:15]
    ds_read_b64_tr_b16 v[12:13], v62 offset:8448
    ds_read_b64_tr_b16 v[14:15], v62 offset:10496
    v_lshlrev_b32 v103, 16, v168
    v_and_b32 v104, s65, v168
    s_waitcnt lgkmcnt(8)
    v_mfma_f32_32x32x16_bf16 a[16:31], v[16:19], v[164:167], a[16:31]
    ds_read_b64_tr_b16 v[16:17], v63 offset:8448
    ds_read_b64_tr_b16 v[18:19], v63 offset:10496
    v_fma_f32 v103, v103, v99, v100
    v_mfma_f32_32x32x16_bf16 a[32:47], v[20:23], v[164:167], a[32:47]
    ds_read_b64_tr_b16 v[20:21], v66 offset:19968
    ds_read_b64_tr_b16 v[22:23], v66 offset:20864
    v_fma_f32 v104, v104, v99, v100
    v_cvt_pk_bf16_f32 v168, v103, v104
    s_waitcnt lgkmcnt(8)
    v_mfma_f32_32x32x16_bf16 a[48:63], v[0:3], v[164:167], a[48:63]
    ds_read_b64_tr_b16 v[0:1], v66 offset:20000
    ds_read_b64_tr_b16 v[2:3], v66 offset:20896
    v_lshlrev_b32 v105, 16, v169
    v_mfma_f32_32x32x16_bf16 a[64:79], v[4:7], v[164:167], a[64:79]
    ds_read_b64_tr_b16 v[4:5], v66 offset:20032
    ds_read_b64_tr_b16 v[6:7], v66 offset:20928
    v_and_b32 v106, s65, v169
    v_fma_f32 v105, v105, v99, v100
    s_waitcnt lgkmcnt(8)
    v_mfma_f32_32x32x16_bf16 a[80:95], v[8:11], v[164:167], a[80:95]
    ds_read_b64_tr_b16 v[8:9], v66 offset:20064
    ds_read_b64_tr_b16 v[10:11], v66 offset:20960
    v_fma_f32 v106, v106, v99, v100
    v_mfma_f32_32x32x16_bf16 a[96:111], v[12:15], v[164:167], a[96:111]
    ds_read_b64_tr_b16 v[12:13], v66 offset:20096
    ds_read_b64_tr_b16 v[14:15], v66 offset:20992
    v_cvt_pk_bf16_f32 v169, v105, v106
    s_waitcnt lgkmcnt(8)
    v_mfma_f32_32x32x16_bf16 a[112:127], v[16:19], v[164:167], a[112:127]
    s_waitcnt vmcnt(17)
    s_barrier
    s_add_u32 m0, s60, 98304
    ds_read_b64_tr_b16 v[16:17], v66 offset:20128
    ds_read_b64_tr_b16 v[18:19], v66 offset:21024
    buffer_load_dwordx4 v28, s[32:35], s56 offen offset:0 lds
    v_lshlrev_b32 v103, 16, v170
    v_and_b32 v104, s65, v170
    v_mfma_f32_32x32x16_bf16 a[128:143], v[20:23], v[164:167], a[128:143]
    ds_read_b64_tr_b16 v[20:21], v66 offset:20160
    ds_read_b64_tr_b16 v[22:23], v66 offset:21056
    v_fma_f32 v103, v103, v99, v100
    s_waitcnt lgkmcnt(8)
    v_mfma_f32_32x32x16_bf16 a[144:159], v[0:3], v[164:167], a[144:159]
    ds_read_b64_tr_b16 v[0:1], v52 offset:0
    ds_read_b64_tr_b16 v[2:3], v52 offset:2048
    v_fma_f32 v104, v104, v99, v100
    v_cvt_pk_bf16_f32 v170, v103, v104
    v_mfma_f32_32x32x16_bf16 a[160:175], v[4:7], v[164:167], a[160:175]
    ds_read_b64_tr_b16 v[4:5], v53 offset:0
    ds_read_b64_tr_b16 v[6:7], v53 offset:2048
    buffer_load_dwordx4 v29, s[32:35], s56 offen offset:1024 lds
    v_lshlrev_b32 v105, 16, v171
    s_waitcnt lgkmcnt(8)
    v_mfma_f32_32x32x16_bf16 a[176:191], v[8:11], v[164:167], a[176:191]
    ds_read_b64_tr_b16 v[8:9], v54 offset:0
    ds_read_b64_tr_b16 v[10:11], v54 offset:2048
    v_and_b32 v106, s65, v171
    v_fma_f32 v105, v105, v99, v100
    v_mfma_f32_32x32x16_bf16 a[192:207], v[12:15], v[164:167], a[192:207]
    ds_read_b64_tr_b16 v[12:13], v55 offset:0
    ds_read_b64_tr_b16 v[14:15], v55 offset:2048
    v_fma_f32 v106, v106, v99, v100
    s_waitcnt lgkmcnt(8)
    v_mfma_f32_32x32x16_bf16 a[208:223], v[16:19], v[164:167], a[208:223]
    ds_read_b64_tr_b16 v[16:17], v52 offset:256
    ds_read_b64_tr_b16 v[18:19], v52 offset:2304
    buffer_load_dwordx4 v30, s[32:35], s56 offen offset:2048 lds
    v_cvt_pk_bf16_f32 v171, v105, v106
    v_mfma_f32_32x32x16_bf16 a[224:239], v[20:23], v[164:167], a[224:239]
    ds_read_b64_tr_b16 v[20:21], v53 offset:256
    ds_read_b64_tr_b16 v[22:23], v53 offset:2304
    s_waitcnt lgkmcnt(8)
    v_mfma_f32_32x32x16_bf16 a[0:15], v[0:3], v[168:171], a[0:15]
    ds_read_b64_tr_b16 v[0:1], v54 offset:256
    ds_read_b64_tr_b16 v[2:3], v54 offset:2304
    v_lshlrev_b32 v103, 16, v172
    v_and_b32 v104, s65, v172
    v_mfma_f32_32x32x16_bf16 a[16:31], v[4:7], v[168:171], a[16:31]
    ds_read_b64_tr_b16 v[4:5], v55 offset:256
    ds_read_b64_tr_b16 v[6:7], v55 offset:2304
    buffer_load_dwordx4 v31, s[32:35], s56 offen offset:3072 lds
    v_fma_f32 v103, v103, v99, v100
    s_waitcnt lgkmcnt(8)
    v_mfma_f32_32x32x16_bf16 a[32:47], v[8:11], v[168:171], a[32:47]
    ds_read_b64_tr_b16 v[8:9], v64 offset:16384
    ds_read_b64_tr_b16 v[10:11], v64 offset:17280
    v_fma_f32 v104, v104, v99, v100
    v_cvt_pk_bf16_f32 v172, v103, v104
    v_mfma_f32_32x32x16_bf16 a[48:63], v[12:15], v[168:171], a[48:63]
    ds_read_b64_tr_b16 v[12:13], v64 offset:16416
    ds_read_b64_tr_b16 v[14:15], v64 offset:17312
    v_lshlrev_b32 v105, 16, v173
    s_waitcnt lgkmcnt(8)
    v_mfma_f32_32x32x16_bf16 a[64:79], v[16:19], v[168:171], a[64:79]
    s_add_u32 m0, s60, 102400
    ds_read_b64_tr_b16 v[16:17], v64 offset:16448
    ds_read_b64_tr_b16 v[18:19], v64 offset:17344
    buffer_load_dwordx4 v32, s[32:35], s56 offen offset:0 lds
    v_and_b32 v106, s65, v173
    v_fma_f32 v105, v105, v99, v100
    v_mfma_f32_32x32x16_bf16 a[80:95], v[20:23], v[168:171], a[80:95]
    ds_read_b64_tr_b16 v[20:21], v64 offset:16480
    ds_read_b64_tr_b16 v[22:23], v64 offset:17376
    v_fma_f32 v106, v106, v99, v100
    s_waitcnt lgkmcnt(8)
    v_mfma_f32_32x32x16_bf16 a[96:111], v[0:3], v[168:171], a[96:111]
    ds_read_b64_tr_b16 v[0:1], v64 offset:16512
    ds_read_b64_tr_b16 v[2:3], v64 offset:17408
    v_cvt_pk_bf16_f32 v173, v105, v106
    v_mfma_f32_32x32x16_bf16 a[112:127], v[4:7], v[168:171], a[112:127]
    ds_read_b64_tr_b16 v[4:5], v64 offset:16544
    ds_read_b64_tr_b16 v[6:7], v64 offset:17440
    buffer_load_dwordx4 v33, s[32:35], s56 offen offset:1024 lds
    v_lshlrev_b32 v103, 16, v174
    v_and_b32 v104, s65, v174
    s_waitcnt lgkmcnt(8)
    v_mfma_f32_32x32x16_bf16 a[128:143], v[8:11], v[168:171], a[128:143]
    ds_read_b64_tr_b16 v[8:9], v64 offset:16576
    ds_read_b64_tr_b16 v[10:11], v64 offset:17472
    v_fma_f32 v103, v103, v99, v100
    v_mfma_f32_32x32x16_bf16 a[144:159], v[12:15], v[168:171], a[144:159]
    ds_read_b64_tr_b16 v[12:13], v52 offset:8192
    ds_read_b64_tr_b16 v[14:15], v52 offset:10240
    v_fma_f32 v104, v104, v99, v100
    v_cvt_pk_bf16_f32 v174, v103, v104
    s_waitcnt lgkmcnt(8)
    v_mfma_f32_32x32x16_bf16 a[160:175], v[16:19], v[168:171], a[160:175]
    ds_read_b64_tr_b16 v[16:17], v53 offset:8192
    ds_read_b64_tr_b16 v[18:19], v53 offset:10240
    buffer_load_dwordx4 v34, s[32:35], s56 offen offset:2048 lds
    v_lshlrev_b32 v105, 16, v175
    v_mfma_f32_32x32x16_bf16 a[176:191], v[20:23], v[168:171], a[176:191]
    ds_read_b64_tr_b16 v[20:21], v54 offset:8192
    ds_read_b64_tr_b16 v[22:23], v54 offset:10240
    v_and_b32 v106, s65, v175
    v_fma_f32 v105, v105, v99, v100
    s_waitcnt lgkmcnt(8)
    v_mfma_f32_32x32x16_bf16 a[192:207], v[0:3], v[168:171], a[192:207]
    ds_read_b64_tr_b16 v[0:1], v55 offset:8192
    ds_read_b64_tr_b16 v[2:3], v55 offset:10240
    v_fma_f32 v106, v106, v99, v100
    v_mfma_f32_32x32x16_bf16 a[208:223], v[4:7], v[168:171], a[208:223]
    ds_read_b64_tr_b16 v[4:5], v52 offset:8448
    ds_read_b64_tr_b16 v[6:7], v52 offset:10496
    buffer_load_dwordx4 v35, s[32:35], s56 offen offset:3072 lds
    s_add_u32 s56, s56, s57
    v_cvt_pk_bf16_f32 v175, v105, v106
    s_waitcnt lgkmcnt(8)
    v_mfma_f32_32x32x16_bf16 a[224:239], v[8:11], v[168:171], a[224:239]
    ds_read_b64_tr_b16 v[8:9], v53 offset:8448
    ds_read_b64_tr_b16 v[10:11], v53 offset:10496
    v_mfma_f32_32x32x16_bf16 a[0:15], v[12:15], v[172:175], a[0:15]
    ds_read_b64_tr_b16 v[12:13], v54 offset:8448
    ds_read_b64_tr_b16 v[14:15], v54 offset:10496
    v_lshlrev_b32 v103, 16, v176
    v_and_b32 v104, s65, v176
    s_waitcnt lgkmcnt(8)
    v_mfma_f32_32x32x16_bf16 a[16:31], v[16:19], v[172:175], a[16:31]
    ds_read_b64_tr_b16 v[16:17], v55 offset:8448
    ds_read_b64_tr_b16 v[18:19], v55 offset:10496
    v_fma_f32 v103, v103, v99, v100
    v_mfma_f32_32x32x16_bf16 a[32:47], v[20:23], v[172:175], a[32:47]
    ds_read_b64_tr_b16 v[20:21], v64 offset:19968
    ds_read_b64_tr_b16 v[22:23], v64 offset:20864
    v_fma_f32 v104, v104, v99, v100
    v_cvt_pk_bf16_f32 v176, v103, v104
    s_waitcnt lgkmcnt(8)
    v_mfma_f32_32x32x16_bf16 a[48:63], v[0:3], v[172:175], a[48:63]
    ds_read_b64_tr_b16 v[0:1], v64 offset:20000
    ds_read_b64_tr_b16 v[2:3], v64 offset:20896
    v_lshlrev_b32 v105, 16, v177
    v_mfma_f32_32x32x16_bf16 a[64:79], v[4:7], v[172:175], a[64:79]
    ds_read_b64_tr_b16 v[4:5], v64 offset:20032
    ds_read_b64_tr_b16 v[6:7], v64 offset:20928
    v_and_b32 v106, s65, v177
    v_fma_f32 v105, v105, v99, v100
    s_waitcnt lgkmcnt(8)
    v_mfma_f32_32x32x16_bf16 a[80:95], v[8:11], v[172:175], a[80:95]
    ds_read_b64_tr_b16 v[8:9], v64 offset:20064
    ds_read_b64_tr_b16 v[10:11], v64 offset:20960
    v_fma_f32 v106, v106, v99, v100
    v_mfma_f32_32x32x16_bf16 a[96:111], v[12:15], v[172:175], a[96:111]
    ds_read_b64_tr_b16 v[12:13], v64 offset:20096
    ds_read_b64_tr_b16 v[14:15], v64 offset:20992
    v_cvt_pk_bf16_f32 v177, v105, v106
    s_waitcnt lgkmcnt(8)
    v_mfma_f32_32x32x16_bf16 a[112:127], v[16:19], v[172:175], a[112:127]
    s_waitcnt vmcnt(16)
    s_barrier
    s_add_u32 m0, s60, 131072
    ds_read_b64_tr_b16 v[16:17], v64 offset:20128
    ds_read_b64_tr_b16 v[18:19], v64 offset:21024
    buffer_load_dwordx4 v28, s[32:35], s56 offen offset:0 lds
    v_lshlrev_b32 v103, 16, v178
    v_and_b32 v104, s65, v178
    v_mfma_f32_32x32x16_bf16 a[128:143], v[20:23], v[172:175], a[128:143]
    ds_read_b64_tr_b16 v[20:21], v64 offset:20160
    ds_read_b64_tr_b16 v[22:23], v64 offset:21056
    v_fma_f32 v103, v103, v99, v100
    s_waitcnt lgkmcnt(8)
    v_mfma_f32_32x32x16_bf16 a[144:159], v[0:3], v[172:175], a[144:159]
    ds_read_b64_tr_b16 v[0:1], v52 offset:32768
    ds_read_b64_tr_b16 v[2:3], v52 offset:34816
    v_fma_f32 v104, v104, v99, v100
    v_cvt_pk_bf16_f32 v178, v103, v104
    v_mfma_f32_32x32x16_bf16 a[160:175], v[4:7], v[172:175], a[160:175]
    ds_read_b64_tr_b16 v[4:5], v53 offset:32768
    ds_read_b64_tr_b16 v[6:7], v53 offset:34816
    buffer_load_dwordx4 v29, s[32:35], s56 offen offset:1024 lds
    v_lshlrev_b32 v105, 16, v179
    s_waitcnt lgkmcnt(8)
    v_mfma_f32_32x32x16_bf16 a[176:191], v[8:11], v[172:175], a[176:191]
    ds_read_b64_tr_b16 v[8:9], v54 offset:32768
    ds_read_b64_tr_b16 v[10:11], v54 offset:34816
    v_and_b32 v106, s65, v179
    v_fma_f32 v105, v105, v99, v100
    v_mfma_f32_32x32x16_bf16 a[192:207], v[12:15], v[172:175], a[192:207]
    ds_read_b64_tr_b16 v[12:13], v55 offset:32768
    ds_read_b64_tr_b16 v[14:15], v55 offset:34816
    v_fma_f32 v106, v106, v99, v100
    s_waitcnt lgkmcnt(8)
    v_mfma_f32_32x32x16_bf16 a[208:223], v[16:19], v[172:175], a[208:223]
    ds_read_b64_tr_b16 v[16:17], v52 offset:33024
    ds_read_b64_tr_b16 v[18:19], v52 offset:35072
    buffer_load_dwordx4 v30, s[32:35], s56 offen offset:2048 lds
    v_cvt_pk_bf16_f32 v179, v105, v106
    v_mfma_f32_32x32x16_bf16 a[224:239], v[20:23], v[172:175], a[224:239]
    ds_read_b64_tr_b16 v[20:21], v53 offset:33024
    ds_read_b64_tr_b16 v[22:23], v53 offset:35072
    s_waitcnt lgkmcnt(8)
    v_mfma_f32_32x32x16_bf16 a[0:15], v[0:3], v[176:179], a[0:15]
    ds_read_b64_tr_b16 v[0:1], v54 offset:33024
    ds_read_b64_tr_b16 v[2:3], v54 offset:35072
    v_lshlrev_b32 v103, 16, v180
    v_and_b32 v104, s65, v180
    v_mfma_f32_32x32x16_bf16 a[16:31], v[4:7], v[176:179], a[16:31]
    ds_read_b64_tr_b16 v[4:5], v55 offset:33024
    ds_read_b64_tr_b16 v[6:7], v55 offset:35072
    buffer_load_dwordx4 v31, s[32:35], s56 offen offset:3072 lds
    v_fma_f32 v103, v103, v99, v100
    s_waitcnt lgkmcnt(8)
    v_mfma_f32_32x32x16_bf16 a[32:47], v[8:11], v[176:179], a[32:47]
    ds_read_b64_tr_b16 v[8:9], v64 offset:49152
    ds_read_b64_tr_b16 v[10:11], v64 offset:50048
    v_fma_f32 v104, v104, v99, v100
    v_cvt_pk_bf16_f32 v180, v103, v104
    v_mfma_f32_32x32x16_bf16 a[48:63], v[12:15], v[176:179], a[48:63]
    ds_read_b64_tr_b16 v[12:13], v64 offset:49184
    ds_read_b64_tr_b16 v[14:15], v64 offset:50080
    v_lshlrev_b32 v105, 16, v181
    s_waitcnt lgkmcnt(8)
    v_mfma_f32_32x32x16_bf16 a[64:79], v[16:19], v[176:179], a[64:79]
    s_add_u32 m0, s60, 135168
    ds_read_b64_tr_b16 v[16:17], v64 offset:49216
    ds_read_b64_tr_b16 v[18:19], v64 offset:50112
    buffer_load_dwordx4 v32, s[32:35], s56 offen offset:0 lds
    v_and_b32 v106, s65, v181
    v_fma_f32 v105, v105, v99, v100
    v_mfma_f32_32x32x16_bf16 a[80:95], v[20:23], v[176:179], a[80:95]
    ds_read_b64_tr_b16 v[20:21], v64 offset:49248
    ds_read_b64_tr_b16 v[22:23], v64 offset:50144
    v_fma_f32 v106, v106, v99, v100
    s_waitcnt lgkmcnt(8)
    v_mfma_f32_32x32x16_bf16 a[96:111], v[0:3], v[176:179], a[96:111]
    ds_read_b64_tr_b16 v[0:1], v64 offset:49280
    ds_read_b64_tr_b16 v[2:3], v64 offset:50176
    v_cvt_pk_bf16_f32 v181, v105, v106
    v_mfma_f32_32x32x16_bf16 a[112:127], v[4:7], v[176:179], a[112:127]
    ds_read_b64_tr_b16 v[4:5], v64 offset:49312
    ds_read_b64_tr_b16 v[6:7], v64 offset:50208
    buffer_load_dwordx4 v33, s[32:35], s56 offen offset:1024 lds
    v_lshlrev_b32 v103, 16, v182
    v_and_b32 v104, s65, v182
    s_waitcnt lgkmcnt(8)
    v_mfma_f32_32x32x16_bf16 a[128:143], v[8:11], v[176:179], a[128:143]
    ds_read_b64_tr_b16 v[8:9], v64 offset:49344
    ds_read_b64_tr_b16 v[10:11], v64 offset:50240
    v_fma_f32 v103, v103, v99, v100
    v_mfma_f32_32x32x16_bf16 a[144:159], v[12:15], v[176:179], a[144:159]
    ds_read_b64_tr_b16 v[12:13], v52 offset:40960
    ds_read_b64_tr_b16 v[14:15], v52 offset:43008
    v_fma_f32 v104, v104, v99, v100
    v_cvt_pk_bf16_f32 v182, v103, v104
    s_waitcnt lgkmcnt(8)
    v_mfma_f32_32x32x16_bf16 a[160:175], v[16:19], v[176:179], a[160:175]
    ds_read_b64_tr_b16 v[16:17], v53 offset:40960
    ds_read_b64_tr_b16 v[18:19], v53 offset:43008
    buffer_load_dwordx4 v34, s[32:35], s56 offen offset:2048 lds
    v_lshlrev_b32 v105, 16, v183
    v_mfma_f32_32x32x16_bf16 a[176:191], v[20:23], v[176:179], a[176:191]
    ds_read_b64_tr_b16 v[20:21], v54 offset:40960
    ds_read_b64_tr_b16 v[22:23], v54 offset:43008
    v_and_b32 v106, s65, v183
    v_fma_f32 v105, v105, v99, v100
    s_waitcnt lgkmcnt(8)
    v_mfma_f32_32x32x16_bf16 a[192:207], v[0:3], v[176:179], a[192:207]
    ds_read_b64_tr_b16 v[0:1], v55 offset:40960
    ds_read_b64_tr_b16 v[2:3], v55 offset:43008
    v_fma_f32 v106, v106, v99, v100
    v_mfma_f32_32x32x16_bf16 a[208:223], v[4:7], v[176:179], a[208:223]
    ds_read_b64_tr_b16 v[4:5], v52 offset:41216
    ds_read_b64_tr_b16 v[6:7], v52 offset:43264
    buffer_load_dwordx4 v35, s[32:35], s56 offen offset:3072 lds
    s_add_u32 s56, s56, s57
    v_cvt_pk_bf16_f32 v183, v105, v106
    s_waitcnt lgkmcnt(8)
    v_mfma_f32_32x32x16_bf16 a[224:239], v[8:11], v[176:179], a[224:239]
    ds_read_b64_tr_b16 v[8:9], v53 offset:41216
    ds_read_b64_tr_b16 v[10:11], v53 offset:43264
    v_mfma_f32_32x32x16_bf16 a[0:15], v[12:15], v[180:183], a[0:15]
    ds_read_b64_tr_b16 v[12:13], v54 offset:41216
    ds_read_b64_tr_b16 v[14:15], v54 offset:43264
    v_lshlrev_b32 v103, 16, v184
    v_and_b32 v104, s65, v184
    s_waitcnt lgkmcnt(8)
    v_mfma_f32_32x32x16_bf16 a[16:31], v[16:19], v[180:183], a[16:31]
    ds_read_b64_tr_b16 v[16:17], v55 offset:41216
    ds_read_b64_tr_b16 v[18:19], v55 offset:43264
    v_fma_f32 v103, v103, v99, v100
    v_mfma_f32_32x32x16_bf16 a[32:47], v[20:23], v[180:183], a[32:47]
    ds_read_b64_tr_b16 v[20:21], v64 offset:52736
    ds_read_b64_tr_b16 v[22:23], v64 offset:53632
    v_fma_f32 v104, v104, v99, v100
    v_cvt_pk_bf16_f32 v184, v103, v104
    s_waitcnt lgkmcnt(8)
    v_mfma_f32_32x32x16_bf16 a[48:63], v[0:3], v[180:183], a[48:63]
    ds_read_b64_tr_b16 v[0:1], v64 offset:52768
    ds_read_b64_tr_b16 v[2:3], v64 offset:53664
    v_lshlrev_b32 v105, 16, v185
    v_mfma_f32_32x32x16_bf16 a[64:79], v[4:7], v[180:183], a[64:79]
    ds_read_b64_tr_b16 v[4:5], v64 offset:52800
    ds_read_b64_tr_b16 v[6:7], v64 offset:53696
    v_and_b32 v106, s65, v185
    v_fma_f32 v105, v105, v99, v100
    s_waitcnt lgkmcnt(8)
    v_mfma_f32_32x32x16_bf16 a[80:95], v[8:11], v[180:183], a[80:95]
    ds_read_b64_tr_b16 v[8:9], v64 offset:52832
    ds_read_b64_tr_b16 v[10:11], v64 offset:53728
    v_fma_f32 v106, v106, v99, v100
    v_mfma_f32_32x32x16_bf16 a[96:111], v[12:15], v[180:183], a[96:111]
    ds_read_b64_tr_b16 v[12:13], v64 offset:52864
    ds_read_b64_tr_b16 v[14:15], v64 offset:53760
    v_cvt_pk_bf16_f32 v185, v105, v106
    s_waitcnt lgkmcnt(8)
    v_mfma_f32_32x32x16_bf16 a[112:127], v[16:19], v[180:183], a[112:127]
    s_waitcnt vmcnt(16)
    s_barrier
    s_add_u32 m0, s60, 0
    ds_read_b64_tr_b16 v[16:17], v64 offset:52896
    ds_read_b64_tr_b16 v[18:19], v64 offset:53792
    buffer_load_dwordx4 v28, s[32:35], s56 offen offset:0 lds
    v_lshlrev_b32 v103, 16, v186
    v_and_b32 v104, s65, v186
    v_mfma_f32_32x32x16_bf16 a[128:143], v[20:23], v[180:183], a[128:143]
    ds_read_b64_tr_b16 v[20:21], v64 offset:52928
    ds_read_b64_tr_b16 v[22:23], v64 offset:53824
    v_fma_f32 v103, v103, v99, v100
    s_waitcnt lgkmcnt(8)
    v_mfma_f32_32x32x16_bf16 a[144:159], v[0:3], v[180:183], a[144:159]
    ds_read_b64_tr_b16 v[0:1], v56 offset:0
    ds_read_b64_tr_b16 v[2:3], v56 offset:2048
    v_fma_f32 v104, v104, v99, v100
    v_cvt_pk_bf16_f32 v186, v103, v104
    v_mfma_f32_32x32x16_bf16 a[160:175], v[4:7], v[180:183], a[160:175]
    ds_read_b64_tr_b16 v[4:5], v57 offset:0
    ds_read_b64_tr_b16 v[6:7], v57 offset:2048
    buffer_load_dwordx4 v29, s[32:35], s56 offen offset:1024 lds
    v_lshlrev_b32 v105, 16, v187
    s_waitcnt lgkmcnt(8)
    v_mfma_f32_32x32x16_bf16 a[176:191], v[8:11], v[180:183], a[176:191]
    ds_read_b64_tr_b16 v[8:9], v58 offset:0
    ds_read_b64_tr_b16 v[10:11], v58 offset:2048
    v_and_b32 v106, s65, v187
    v_fma_f32 v105, v105, v99, v100
    v_mfma_f32_32x32x16_bf16 a[192:207], v[12:15], v[180:183], a[192:207]
    ds_read_b64_tr_b16 v[12:13], v59 offset:0
    ds_read_b64_tr_b16 v[14:15], v59 offset:2048
    v_fma_f32 v106, v106, v99, v100
    s_waitcnt lgkmcnt(8)
    v_mfma_f32_32x32x16_bf16 a[208:223], v[16:19], v[180:183], a[208:223]
    ds_read_b64_tr_b16 v[16:17], v56 offset:256
    ds_read_b64_tr_b16 v[18:19], v56 offset:2304
    buffer_load_dwordx4 v30, s[32:35], s56 offen offset:2048 lds
    v_cvt_pk_bf16_f32 v187, v105, v106
    v_mfma_f32_32x32x16_bf16 a[224:239], v[20:23], v[180:183], a[224:239]
    ds_read_b64_tr_b16 v[20:21], v57 offset:256
    ds_read_b64_tr_b16 v[22:23], v57 offset:2304
    s_waitcnt lgkmcnt(8)
    v_mfma_f32_32x32x16_bf16 a[0:15], v[0:3], v[184:187], a[0:15]
    ds_read_b64_tr_b16 v[0:1], v58 offset:256
    ds_read_b64_tr_b16 v[2:3], v58 offset:2304
    v_lshlrev_b32 v103, 16, v188
    v_and_b32 v104, s65, v188
    v_mfma_f32_32x32x16_bf16 a[16:31], v[4:7], v[184:187], a[16:31]
    ds_read_b64_tr_b16 v[4:5], v59 offset:256
    ds_read_b64_tr_b16 v[6:7], v59 offset:2304
    buffer_load_dwordx4 v31, s[32:35], s56 offen offset:3072 lds
    v_fma_f32 v103, v103, v99, v100
    s_waitcnt lgkmcnt(8)
    v_mfma_f32_32x32x16_bf16 a[32:47], v[8:11], v[184:187], a[32:47]
    ds_read_b64_tr_b16 v[8:9], v65 offset:16384
    ds_read_b64_tr_b16 v[10:11], v65 offset:17280
    v_fma_f32 v104, v104, v99, v100
    v_cvt_pk_bf16_f32 v188, v103, v104
    v_mfma_f32_32x32x16_bf16 a[48:63], v[12:15], v[184:187], a[48:63]
    ds_read_b64_tr_b16 v[12:13], v65 offset:16416
    ds_read_b64_tr_b16 v[14:15], v65 offset:17312
    v_lshlrev_b32 v105, 16, v189
    s_waitcnt lgkmcnt(8)
    v_mfma_f32_32x32x16_bf16 a[64:79], v[16:19], v[184:187], a[64:79]
    s_add_u32 m0, s60, 4096
    ds_read_b64_tr_b16 v[16:17], v65 offset:16448
    ds_read_b64_tr_b16 v[18:19], v65 offset:17344
    buffer_load_dwordx4 v32, s[32:35], s56 offen offset:0 lds
    v_and_b32 v106, s65, v189
    v_fma_f32 v105, v105, v99, v100
    v_mfma_f32_32x32x16_bf16 a[80:95], v[20:23], v[184:187], a[80:95]
    ds_read_b64_tr_b16 v[20:21], v65 offset:16480
    ds_read_b64_tr_b16 v[22:23], v65 offset:17376
    v_fma_f32 v106, v106, v99, v100
    s_waitcnt lgkmcnt(8)
    v_mfma_f32_32x32x16_bf16 a[96:111], v[0:3], v[184:187], a[96:111]
    ds_read_b64_tr_b16 v[0:1], v65 offset:16512
    ds_read_b64_tr_b16 v[2:3], v65 offset:17408
    v_cvt_pk_bf16_f32 v189, v105, v106
    v_mfma_f32_32x32x16_bf16 a[112:127], v[4:7], v[184:187], a[112:127]
    ds_read_b64_tr_b16 v[4:5], v65 offset:16544
    ds_read_b64_tr_b16 v[6:7], v65 offset:17440
    buffer_load_dwordx4 v33, s[32:35], s56 offen offset:1024 lds
    v_lshlrev_b32 v103, 16, v190
    v_and_b32 v104, s65, v190
    s_waitcnt lgkmcnt(8)
    v_mfma_f32_32x32x16_bf16 a[128:143], v[8:11], v[184:187], a[128:143]
    ds_read_b64_tr_b16 v[8:9], v65 offset:16576
    ds_read_b64_tr_b16 v[10:11], v65 offset:17472
    v_fma_f32 v103, v103, v99, v100
    v_mfma_f32_32x32x16_bf16 a[144:159], v[12:15], v[184:187], a[144:159]
    ds_read_b64_tr_b16 v[12:13], v56 offset:8192
    ds_read_b64_tr_b16 v[14:15], v56 offset:10240
    v_fma_f32 v104, v104, v99, v100
    v_cvt_pk_bf16_f32 v190, v103, v104
    s_waitcnt lgkmcnt(8)
    v_mfma_f32_32x32x16_bf16 a[160:175], v[16:19], v[184:187], a[160:175]
    ds_read_b64_tr_b16 v[16:17], v57 offset:8192
    ds_read_b64_tr_b16 v[18:19], v57 offset:10240
    buffer_load_dwordx4 v34, s[32:35], s56 offen offset:2048 lds
    v_lshlrev_b32 v105, 16, v191
    v_mfma_f32_32x32x16_bf16 a[176:191], v[20:23], v[184:187], a[176:191]
    ds_read_b64_tr_b16 v[20:21], v58 offset:8192
    ds_read_b64_tr_b16 v[22:23], v58 offset:10240
    v_and_b32 v106, s65, v191
    v_fma_f32 v105, v105, v99, v100
    s_waitcnt lgkmcnt(8)
    v_mfma_f32_32x32x16_bf16 a[192:207], v[0:3], v[184:187], a[192:207]
    ds_read_b64_tr_b16 v[0:1], v59 offset:8192
    ds_read_b64_tr_b16 v[2:3], v59 offset:10240
    v_fma_f32 v106, v106, v99, v100
    v_mfma_f32_32x32x16_bf16 a[208:223], v[4:7], v[184:187], a[208:223]
    ds_read_b64_tr_b16 v[4:5], v56 offset:8448
    ds_read_b64_tr_b16 v[6:7], v56 offset:10496
    buffer_load_dwordx4 v35, s[32:35], s56 offen offset:3072 lds
    s_add_u32 s56, s56, s57
    v_cvt_pk_bf16_f32 v191, v105, v106
    s_waitcnt lgkmcnt(8)
    v_mfma_f32_32x32x16_bf16 a[224:239], v[8:11], v[184:187], a[224:239]
    ds_read_b64_tr_b16 v[8:9], v57 offset:8448
    ds_read_b64_tr_b16 v[10:11], v57 offset:10496
    v_mfma_f32_32x32x16_bf16 a[0:15], v[12:15], v[188:191], a[0:15]
    ds_read_b64_tr_b16 v[12:13], v58 offset:8448
    ds_read_b64_tr_b16 v[14:15], v58 offset:10496
    v_lshlrev_b32 v103, 16, v192
    v_and_b32 v104, s65, v192
    s_waitcnt lgkmcnt(8)
    v_mfma_f32_32x32x16_bf16 a[16:31], v[16:19], v[188:191], a[16:31]
    ds_read_b64_tr_b16 v[16:17], v59 offset:8448
    ds_read_b64_tr_b16 v[18:19], v59 offset:10496
    v_fma_f32 v103, v103, v99, v100
    v_mfma_f32_32x32x16_bf16 a[32:47], v[20:23], v[188:191], a[32:47]
    ds_read_b64_tr_b16 v[20:21], v65 offset:19968
    ds_read_b64_tr_b16 v[22:23], v65 offset:20864
    v_fma_f32 v104, v104, v99, v100
    v_cvt_pk_bf16_f32 v192, v103, v104
    s_waitcnt lgkmcnt(8)
    v_mfma_f32_32x32x16_bf16 a[48:63], v[0:3], v[188:191], a[48:63]
    ds_read_b64_tr_b16 v[0:1], v65 offset:20000
    ds_read_b64_tr_b16 v[2:3], v65 offset:20896
    v_lshlrev_b32 v105, 16, v193
    v_mfma_f32_32x32x16_bf16 a[64:79], v[4:7], v[188:191], a[64:79]
    ds_read_b64_tr_b16 v[4:5], v65 offset:20032
    ds_read_b64_tr_b16 v[6:7], v65 offset:20928
    v_and_b32 v106, s65, v193
    v_fma_f32 v105, v105, v99, v100
    s_waitcnt lgkmcnt(8)
    v_mfma_f32_32x32x16_bf16 a[80:95], v[8:11], v[188:191], a[80:95]
    ds_read_b64_tr_b16 v[8:9], v65 offset:20064
    ds_read_b64_tr_b16 v[10:11], v65 offset:20960
    v_fma_f32 v106, v106, v99, v100
    v_mfma_f32_32x32x16_bf16 a[96:111], v[12:15], v[188:191], a[96:111]
    ds_read_b64_tr_b16 v[12:13], v65 offset:20096
    ds_read_b64_tr_b16 v[14:15], v65 offset:20992
    v_cvt_pk_bf16_f32 v193, v105, v106
    s_waitcnt lgkmcnt(8)
    v_mfma_f32_32x32x16_bf16 a[112:127], v[16:19], v[188:191], a[112:127]
    s_waitcnt vmcnt(16)
    s_barrier
    s_add_u32 m0, s60, 32768
    ds_read_b64_tr_b16 v[16:17], v65 offset:20128
    ds_read_b64_tr_b16 v[18:19], v65 offset:21024
    buffer_load_dwordx4 v28, s[32:35], s56 offen offset:0 lds
    v_lshlrev_b32 v103, 16, v194
    v_and_b32 v104, s65, v194
    v_mfma_f32_32x32x16_bf16 a[128:143], v[20:23], v[188:191], a[128:143]
    ds_read_b64_tr_b16 v[20:21], v65 offset:20160
    ds_read_b64_tr_b16 v[22:23], v65 offset:21056
    v_fma_f32 v103, v103, v99, v100
    s_waitcnt lgkmcnt(8)
    v_mfma_f32_32x32x16_bf16 a[144:159], v[0:3], v[188:191], a[144:159]
    ds_read_b64_tr_b16 v[0:1], v56 offset:32768
    ds_read_b64_tr_b16 v[2:3], v56 offset:34816
    v_fma_f32 v104, v104, v99, v100
    v_cvt_pk_bf16_f32 v194, v103, v104
    v_mfma_f32_32x32x16_bf16 a[160:175], v[4:7], v[188:191], a[160:175]
    ds_read_b64_tr_b16 v[4:5], v57 offset:32768
    ds_read_b64_tr_b16 v[6:7], v57 offset:34816
    buffer_load_dwordx4 v29, s[32:35], s56 offen offset:1024 lds
    v_lshlrev_b32 v105, 16, v195
    s_waitcnt lgkmcnt(8)
    v_mfma_f32_32x32x16_bf16 a[176:191], v[8:11], v[188:191], a[176:191]
    ds_read_b64_tr_b16 v[8:9], v58 offset:32768
    ds_read_b64_tr_b16 v[10:11], v58 offset:34816
    v_and_b32 v106, s65, v195
    v_fma_f32 v105, v105, v99, v100
    v_mfma_f32_32x32x16_bf16 a[192:207], v[12:15], v[188:191], a[192:207]
    ds_read_b64_tr_b16 v[12:13], v59 offset:32768
    ds_read_b64_tr_b16 v[14:15], v59 offset:34816
    v_fma_f32 v106, v106, v99, v100
    s_waitcnt lgkmcnt(8)
    v_mfma_f32_32x32x16_bf16 a[208:223], v[16:19], v[188:191], a[208:223]
    ds_read_b64_tr_b16 v[16:17], v56 offset:33024
    ds_read_b64_tr_b16 v[18:19], v56 offset:35072
    buffer_load_dwordx4 v30, s[32:35], s56 offen offset:2048 lds
    v_cvt_pk_bf16_f32 v195, v105, v106
    v_mfma_f32_32x32x16_bf16 a[224:239], v[20:23], v[188:191], a[224:239]
    ds_read_b64_tr_b16 v[20:21], v57 offset:33024
    ds_read_b64_tr_b16 v[22:23], v57 offset:35072
    s_waitcnt lgkmcnt(8)
    v_mfma_f32_32x32x16_bf16 a[0:15], v[0:3], v[192:195], a[0:15]
    ds_read_b64_tr_b16 v[0:1], v58 offset:33024
    ds_read_b64_tr_b16 v[2:3], v58 offset:35072
    v_lshlrev_b32 v103, 16, v196
    v_and_b32 v104, s65, v196
    v_mfma_f32_32x32x16_bf16 a[16:31], v[4:7], v[192:195], a[16:31]
    ds_read_b64_tr_b16 v[4:5], v59 offset:33024
    ds_read_b64_tr_b16 v[6:7], v59 offset:35072
    buffer_load_dwordx4 v31, s[32:35], s56 offen offset:3072 lds
    v_fma_f32 v103, v103, v99, v100
    s_waitcnt lgkmcnt(8)
    v_mfma_f32_32x32x16_bf16 a[32:47], v[8:11], v[192:195], a[32:47]
    ds_read_b64_tr_b16 v[8:9], v65 offset:49152
    ds_read_b64_tr_b16 v[10:11], v65 offset:50048
    v_fma_f32 v104, v104, v99, v100
    v_cvt_pk_bf16_f32 v196, v103, v104
    v_mfma_f32_32x32x16_bf16 a[48:63], v[12:15], v[192:195], a[48:63]
    ds_read_b64_tr_b16 v[12:13], v65 offset:49184
    ds_read_b64_tr_b16 v[14:15], v65 offset:50080
    v_lshlrev_b32 v105, 16, v197
    s_lshl_b32 s61, s3, 1
    s_and_b32 s62, s53, 1
    s_add_u32 s61, s61, s62
    s_lshl_b32 s61, s61, 1
    s_and_b32 s62, s52, 1
    s_add_u32 s61, s61, s62
    s_mul_i32 s61, s61, 4096
    s_lshl_b32 s62, s55, 20
    s_add_u32 s61, s61, s62
    v_mov_b32 v25, 0xc0000
    v_min_u32 v24, 496, v97
    v_lshl_add_u32 v24, v24, 3, v25
    s_nop 0
    buffer_load_dword v26, v24, s[36:39], s61 offen
    s_waitcnt lgkmcnt(8)
    v_mfma_f32_32x32x16_bf16 a[64:79], v[16:19], v[192:195], a[64:79]
    s_add_u32 m0, s60, 36864
    ds_read_b64_tr_b16 v[16:17], v65 offset:49216
    ds_read_b64_tr_b16 v[18:19], v65 offset:50112
    buffer_load_dwordx4 v32, s[32:35], s56 offen offset:0 lds
    v_and_b32 v106, s65, v197
    v_fma_f32 v105, v105, v99, v100
    v_mfma_f32_32x32x16_bf16 a[80:95], v[20:23], v[192:195], a[80:95]
    ds_read_b64_tr_b16 v[20:21], v65 offset:49248
    ds_read_b64_tr_b16 v[22:23], v65 offset:50144
    v_fma_f32 v106, v106, v99, v100
    s_waitcnt lgkmcnt(8)
    v_mfma_f32_32x32x16_bf16 a[96:111], v[0:3], v[192:195], a[96:111]
    ds_read_b64_tr_b16 v[0:1], v65 offset:49280
    ds_read_b64_tr_b16 v[2:3], v65 offset:50176
    v_cvt_pk_bf16_f32 v197, v105, v106
    v_mfma_f32_32x32x16_bf16 a[112:127], v[4:7], v[192:195], a[112:127]
    ds_read_b64_tr_b16 v[4:5], v65 offset:49312
    ds_read_b64_tr_b16 v[6:7], v65 offset:50208
    buffer_load_dwordx4 v33, s[32:35], s56 offen offset:1024 lds
    v_lshlrev_b32 v103, 16, v198
    v_and_b32 v104, s65, v198
    s_waitcnt lgkmcnt(8)
    v_mfma_f32_32x32x16_bf16 a[128:143], v[8:11], v[192:195], a[128:143]
    ds_read_b64_tr_b16 v[8:9], v65 offset:49344
    ds_read_b64_tr_b16 v[10:11], v65 offset:50240
    v_fma_f32 v103, v103, v99, v100
    v_mfma_f32_32x32x16_bf16 a[144:159], v[12:15], v[192:195], a[144:159]
    ds_read_b64_tr_b16 v[12:13], v56 offset:40960
    ds_read_b64_tr_b16 v[14:15], v56 offset:43008
    v_fma_f32 v104, v104, v99, v100
    v_cvt_pk_bf16_f32 v198, v103, v104
    s_waitcnt lgkmcnt(8)
    v_mfma_f32_32x32x16_bf16 a[160:175], v[16:19], v[192:195], a[160:175]
    ds_read_b64_tr_b16 v[16:17], v57 offset:40960
    ds_read_b64_tr_b16 v[18:19], v57 offset:43008
    buffer_load_dwordx4 v34, s[32:35], s56 offen offset:2048 lds
    v_lshlrev_b32 v105, 16, v199
    v_mfma_f32_32x32x16_bf16 a[176:191], v[20:23], v[192:195], a[176:191]
    ds_read_b64_tr_b16 v[20:21], v58 offset:40960
    ds_read_b64_tr_b16 v[22:23], v58 offset:43008
    v_and_b32 v106, s65, v199
    v_fma_f32 v105, v105, v99, v100
    s_waitcnt lgkmcnt(8)
    v_mfma_f32_32x32x16_bf16 a[192:207], v[0:3], v[192:195], a[192:207]
    ds_read_b64_tr_b16 v[0:1], v59 offset:40960
    ds_read_b64_tr_b16 v[2:3], v59 offset:43008
    v_fma_f32 v106, v106, v99, v100
    v_mfma_f32_32x32x16_bf16 a[208:223], v[4:7], v[192:195], a[208:223]
    ds_read_b64_tr_b16 v[4:5], v56 offset:41216
    ds_read_b64_tr_b16 v[6:7], v56 offset:43264
    buffer_load_dwordx4 v35, s[32:35], s56 offen offset:3072 lds
    s_add_u32 s56, s56, s57
    v_cvt_pk_bf16_f32 v199, v105, v106
    s_waitcnt lgkmcnt(8)
    v_mfma_f32_32x32x16_bf16 a[224:239], v[8:11], v[192:195], a[224:239]
    ds_read_b64_tr_b16 v[8:9], v57 offset:41216
    ds_read_b64_tr_b16 v[10:11], v57 offset:43264
    v_mfma_f32_32x32x16_bf16 a[0:15], v[12:15], v[196:199], a[0:15]
    ds_read_b64_tr_b16 v[12:13], v58 offset:41216
    ds_read_b64_tr_b16 v[14:15], v58 offset:43264
    v_lshlrev_b32 v103, 16, v200
    v_and_b32 v104, s65, v200
    s_waitcnt lgkmcnt(8)
    v_mfma_f32_32x32x16_bf16 a[16:31], v[16:19], v[196:199], a[16:31]
    ds_read_b64_tr_b16 v[16:17], v59 offset:41216
    ds_read_b64_tr_b16 v[18:19], v59 offset:43264
    v_fma_f32 v103, v103, v99, v100
    v_mfma_f32_32x32x16_bf16 a[32:47], v[20:23], v[196:199], a[32:47]
    ds_read_b64_tr_b16 v[20:21], v65 offset:52736
    ds_read_b64_tr_b16 v[22:23], v65 offset:53632
    v_fma_f32 v104, v104, v99, v100
    v_cvt_pk_bf16_f32 v200, v103, v104
    s_waitcnt lgkmcnt(8)
    v_mfma_f32_32x32x16_bf16 a[48:63], v[0:3], v[196:199], a[48:63]
    ds_read_b64_tr_b16 v[0:1], v65 offset:52768
    ds_read_b64_tr_b16 v[2:3], v65 offset:53664
    v_lshlrev_b32 v105, 16, v201
    v_mfma_f32_32x32x16_bf16 a[64:79], v[4:7], v[196:199], a[64:79]
    ds_read_b64_tr_b16 v[4:5], v65 offset:52800
    ds_read_b64_tr_b16 v[6:7], v65 offset:53696
    v_and_b32 v106, s65, v201
    v_fma_f32 v105, v105, v99, v100
    s_waitcnt lgkmcnt(8)
    v_mfma_f32_32x32x16_bf16 a[80:95], v[8:11], v[196:199], a[80:95]
    ds_read_b64_tr_b16 v[8:9], v65 offset:52832
    ds_read_b64_tr_b16 v[10:11], v65 offset:53728
    v_fma_f32 v106, v106, v99, v100
    v_mfma_f32_32x32x16_bf16 a[96:111], v[12:15], v[196:199], a[96:111]
    ds_read_b64_tr_b16 v[12:13], v65 offset:52864
    ds_read_b64_tr_b16 v[14:15], v65 offset:53760
    v_cvt_pk_bf16_f32 v201, v105, v106
    s_waitcnt lgkmcnt(8)
    v_mfma_f32_32x32x16_bf16 a[112:127], v[16:19], v[196:199], a[112:127]
    s_waitcnt vmcnt(17)
    s_barrier
    s_add_u32 m0, s60, 65536
    ds_read_b64_tr_b16 v[16:17], v65 offset:52896
    ds_read_b64_tr_b16 v[18:19], v65 offset:53792
    buffer_load_dwordx4 v28, s[32:35], s56 offen offset:0 lds
    v_lshlrev_b32 v103, 16, v202
    v_and_b32 v104, s65, v202
    v_mfma_f32_32x32x16_bf16 a[128:143], v[20:23], v[196:199], a[128:143]
    ds_read_b64_tr_b16 v[20:21], v65 offset:52928
    ds_read_b64_tr_b16 v[22:23], v65 offset:53824
    v_fma_f32 v103, v103, v99, v100
    s_waitcnt lgkmcnt(8)
    v_mfma_f32_32x32x16_bf16 a[144:159], v[0:3], v[196:199], a[144:159]
    ds_read_b64_tr_b16 v[0:1], v60 offset:0
    ds_read_b64_tr_b16 v[2:3], v60 offset:2048
    v_fma_f32 v104, v104, v99, v100
    v_cvt_pk_bf16_f32 v202, v103, v104
    v_mfma_f32_32x32x16_bf16 a[160:175], v[4:7], v[196:199], a[160:175]
    ds_read_b64_tr_b16 v[4:5], v61 offset:0
    ds_read_b64_tr_b16 v[6:7], v61 offset:2048
    buffer_load_dwordx4 v29, s[32:35], s56 offen offset:1024 lds
    v_lshlrev_b32 v105, 16, v203
    s_waitcnt lgkmcnt(8)
    v_mfma_f32_32x32x16_bf16 a[176:191], v[8:11], v[196:199], a[176:191]
    ds_read_b64_tr_b16 v[8:9], v62 offset:0
    ds_read_b64_tr_b16 v[10:11], v62 offset:2048
    v_and_b32 v106, s65, v203
    v_fma_f32 v105, v105, v99, v100
    v_mfma_f32_32x32x16_bf16 a[192:207], v[12:15], v[196:199], a[192:207]
    ds_read_b64_tr_b16 v[12:13], v63 offset:0
    ds_read_b64_tr_b16 v[14:15], v63 offset:2048
    v_fma_f32 v106, v106, v99, v100
    s_waitcnt lgkmcnt(8)
    v_mfma_f32_32x32x16_bf16 a[208:223], v[16:19], v[196:199], a[208:223]
    ds_read_b64_tr_b16 v[16:17], v60 offset:256
    ds_read_b64_tr_b16 v[18:19], v60 offset:2304
    buffer_load_dwordx4 v30, s[32:35], s56 offen offset:2048 lds
    v_cvt_pk_bf16_f32 v203, v105, v106
    v_mfma_f32_32x32x16_bf16 a[224:239], v[20:23], v[196:199], a[224:239]
    ds_read_b64_tr_b16 v[20:21], v61 offset:256
    ds_read_b64_tr_b16 v[22:23], v61 offset:2304
    s_waitcnt lgkmcnt(8)
    v_mfma_f32_32x32x16_bf16 a[0:15], v[0:3], v[200:203], a[0:15]
    ds_read_b64_tr_b16 v[0:1], v62 offset:256
    ds_read_b64_tr_b16 v[2:3], v62 offset:2304
    v_lshlrev_b32 v103, 16, v204
    v_and_b32 v104, s65, v204
    v_mfma_f32_32x32x16_bf16 a[16:31], v[4:7], v[200:203], a[16:31]
    ds_read_b64_tr_b16 v[4:5], v63 offset:256
    ds_read_b64_tr_b16 v[6:7], v63 offset:2304
    buffer_load_dwordx4 v31, s[32:35], s56 offen offset:3072 lds
    v_fma_f32 v103, v103, v99, v100
    s_waitcnt lgkmcnt(8)
    v_mfma_f32_32x32x16_bf16 a[32:47], v[8:11], v[200:203], a[32:47]
    ds_read_b64_tr_b16 v[8:9], v66 offset:16384
    ds_read_b64_tr_b16 v[10:11], v66 offset:17280
    v_fma_f32 v104, v104, v99, v100
    v_cvt_pk_bf16_f32 v204, v103, v104
    v_mfma_f32_32x32x16_bf16 a[48:63], v[12:15], v[200:203], a[48:63]
    ds_read_b64_tr_b16 v[12:13], v66 offset:16416
    ds_read_b64_tr_b16 v[14:15], v66 offset:17312
    v_lshlrev_b32 v105, 16, v205
    s_waitcnt lgkmcnt(8)
    v_mfma_f32_32x32x16_bf16 a[64:79], v[16:19], v[200:203], a[64:79]
    s_add_u32 m0, s60, 69632
    ds_read_b64_tr_b16 v[16:17], v66 offset:16448
    ds_read_b64_tr_b16 v[18:19], v66 offset:17344
    buffer_load_dwordx4 v32, s[32:35], s56 offen offset:0 lds
    v_and_b32 v106, s65, v205
    v_fma_f32 v105, v105, v99, v100
    v_mfma_f32_32x32x16_bf16 a[80:95], v[20:23], v[200:203], a[80:95]
    ds_read_b64_tr_b16 v[20:21], v66 offset:16480
    ds_read_b64_tr_b16 v[22:23], v66 offset:17376
    v_fma_f32 v106, v106, v99, v100
    s_waitcnt lgkmcnt(8)
    v_mfma_f32_32x32x16_bf16 a[96:111], v[0:3], v[200:203], a[96:111]
    ds_read_b64_tr_b16 v[0:1], v66 offset:16512
    ds_read_b64_tr_b16 v[2:3], v66 offset:17408
    v_cvt_pk_bf16_f32 v205, v105, v106
    v_mfma_f32_32x32x16_bf16 a[112:127], v[4:7], v[200:203], a[112:127]
    ds_read_b64_tr_b16 v[4:5], v66 offset:16544
    ds_read_b64_tr_b16 v[6:7], v66 offset:17440
    buffer_load_dwordx4 v33, s[32:35], s56 offen offset:1024 lds
    v_lshlrev_b32 v103, 16, v206
    v_and_b32 v104, s65, v206
    s_waitcnt lgkmcnt(8)
    v_mfma_f32_32x32x16_bf16 a[128:143], v[8:11], v[200:203], a[128:143]
    ds_read_b64_tr_b16 v[8:9], v66 offset:16576
    ds_read_b64_tr_b16 v[10:11], v66 offset:17472
    v_fma_f32 v103, v103, v99, v100
    v_mfma_f32_32x32x16_bf16 a[144:159], v[12:15], v[200:203], a[144:159]
    ds_read_b64_tr_b16 v[12:13], v60 offset:8192
    ds_read_b64_tr_b16 v[14:15], v60 offset:10240
    v_fma_f32 v104, v104, v99, v100
    v_cvt_pk_bf16_f32 v206, v103, v104
    s_waitcnt lgkmcnt(8)
    v_mfma_f32_32x32x16_bf16 a[160:175], v[16:19], v[200:203], a[160:175]
    ds_read_b64_tr_b16 v[16:17], v61 offset:8192
    ds_read_b64_tr_b16 v[18:19], v61 offset:10240
    buffer_load_dwordx4 v34, s[32:35], s56 offen offset:2048 lds
    v_lshlrev_b32 v105, 16, v207
    v_mfma_f32_32x32x16_bf16 a[176:191], v[20:23], v[200:203], a[176:191]
    ds_read_b64_tr_b16 v[20:21], v62 offset:8192
    ds_read_b64_tr_b16 v[22:23], v62 offset:10240
    v_and_b32 v106, s65, v207
    v_fma_f32 v105, v105, v99, v100
    s_waitcnt lgkmcnt(8)
    v_mfma_f32_32x32x16_bf16 a[192:207], v[0:3], v[200:203], a[192:207]
    ds_read_b64_tr_b16 v[0:1], v63 offset:8192
    ds_read_b64_tr_b16 v[2:3], v63 offset:10240
    v_fma_f32 v106, v106, v99, v100
    v_mfma_f32_32x32x16_bf16 a[208:223], v[4:7], v[200:203], a[208:223]
    ds_read_b64_tr_b16 v[4:5], v60 offset:8448
    ds_read_b64_tr_b16 v[6:7], v60 offset:10496
    buffer_load_dwordx4 v35, s[32:35], s56 offen offset:3072 lds
    s_add_u32 s56, s56, s57
    v_cvt_pk_bf16_f32 v207, v105, v106
    s_waitcnt lgkmcnt(8)
    v_mfma_f32_32x32x16_bf16 a[224:239], v[8:11], v[200:203], a[224:239]
    ds_read_b64_tr_b16 v[8:9], v61 offset:8448
    ds_read_b64_tr_b16 v[10:11], v61 offset:10496
    v_mfma_f32_32x32x16_bf16 a[0:15], v[12:15], v[204:207], a[0:15]
    ds_read_b64_tr_b16 v[12:13], v62 offset:8448
    ds_read_b64_tr_b16 v[14:15], v62 offset:10496
    v_lshlrev_b32 v103, 16, v208
    v_and_b32 v104, s65, v208
    s_waitcnt lgkmcnt(8)
    v_mfma_f32_32x32x16_bf16 a[16:31], v[16:19], v[204:207], a[16:31]
    ds_read_b64_tr_b16 v[16:17], v63 offset:8448
    ds_read_b64_tr_b16 v[18:19], v63 offset:10496
    v_fma_f32 v103, v103, v99, v100
    v_mfma_f32_32x32x16_bf16 a[32:47], v[20:23], v[204:207], a[32:47]
    ds_read_b64_tr_b16 v[20:21], v66 offset:19968
    ds_read_b64_tr_b16 v[22:23], v66 offset:20864
    v_fma_f32 v104, v104, v99, v100
    v_cvt_pk_bf16_f32 v208, v103, v104
    s_waitcnt lgkmcnt(8)
    v_mfma_f32_32x32x16_bf16 a[48:63], v[0:3], v[204:207], a[48:63]
    ds_read_b64_tr_b16 v[0:1], v66 offset:20000
    ds_read_b64_tr_b16 v[2:3], v66 offset:20896
    v_lshlrev_b32 v105, 16, v209
    v_mfma_f32_32x32x16_bf16 a[64:79], v[4:7], v[204:207], a[64:79]
    ds_read_b64_tr_b16 v[4:5], v66 offset:20032
    ds_read_b64_tr_b16 v[6:7], v66 offset:20928
    v_and_b32 v106, s65, v209
    v_fma_f32 v105, v105, v99, v100
    s_waitcnt lgkmcnt(8)
    v_mfma_f32_32x32x16_bf16 a[80:95], v[8:11], v[204:207], a[80:95]
    ds_read_b64_tr_b16 v[8:9], v66 offset:20064
    ds_read_b64_tr_b16 v[10:11], v66 offset:20960
    v_fma_f32 v106, v106, v99, v100
    v_mfma_f32_32x32x16_bf16 a[96:111], v[12:15], v[204:207], a[96:111]
    ds_read_b64_tr_b16 v[12:13], v66 offset:20096
    ds_read_b64_tr_b16 v[14:15], v66 offset:20992
    v_cvt_pk_bf16_f32 v209, v105, v106
    s_waitcnt lgkmcnt(8)
    v_mfma_f32_32x32x16_bf16 a[112:127], v[16:19], v[204:207], a[112:127]
    s_waitcnt vmcnt(17)
    s_barrier
    s_add_u32 m0, s60, 98304
    ds_read_b64_tr_b16 v[16:17], v66 offset:20128
    ds_read_b64_tr_b16 v[18:19], v66 offset:21024
    buffer_load_dwordx4 v28, s[32:35], s56 offen offset:0 lds
    v_lshlrev_b32 v103, 16, v210
    v_and_b32 v104, s65, v210
    v_mfma_f32_32x32x16_bf16 a[128:143], v[20:23], v[204:207], a[128:143]
    ds_read_b64_tr_b16 v[20:21], v66 offset:20160
    ds_read_b64_tr_b16 v[22:23], v66 offset:21056
    v_fma_f32 v103, v103, v99, v100
    s_waitcnt lgkmcnt(8)
    v_mfma_f32_32x32x16_bf16 a[144:159], v[0:3], v[204:207], a[144:159]
    ds_read_b64_tr_b16 v[0:1], v52 offset:0
    ds_read_b64_tr_b16 v[2:3], v52 offset:2048
    v_fma_f32 v104, v104, v99, v100
    v_cvt_pk_bf16_f32 v210, v103, v104
    v_mfma_f32_32x32x16_bf16 a[160:175], v[4:7], v[204:207], a[160:175]
    ds_read_b64_tr_b16 v[4:5], v53 offset:0
    ds_read_b64_tr_b16 v[6:7], v53 offset:2048
    buffer_load_dwordx4 v29, s[32:35], s56 offen offset:1024 lds
    v_lshlrev_b32 v105, 16, v211
    s_waitcnt lgkmcnt(8)
    v_mfma_f32_32x32x16_bf16 a[176:191], v[8:11], v[204:207], a[176:191]
    ds_read_b64_tr_b16 v[8:9], v54 offset:0
    ds_read_b64_tr_b16 v[10:11], v54 offset:2048
    v_and_b32 v106, s65, v211
    v_fma_f32 v105, v105, v99, v100
    v_mfma_f32_32x32x16_bf16 a[192:207], v[12:15], v[204:207], a[192:207]
    ds_read_b64_tr_b16 v[12:13], v55 offset:0
    ds_read_b64_tr_b16 v[14:15], v55 offset:2048
    v_fma_f32 v106, v106, v99, v100
    s_waitcnt lgkmcnt(8)
    v_mfma_f32_32x32x16_bf16 a[208:223], v[16:19], v[204:207], a[208:223]
    ds_read_b64_tr_b16 v[16:17], v52 offset:256
    ds_read_b64_tr_b16 v[18:19], v52 offset:2304
    buffer_load_dwordx4 v30, s[32:35], s56 offen offset:2048 lds
    v_cvt_pk_bf16_f32 v211, v105, v106
    v_mfma_f32_32x32x16_bf16 a[224:239], v[20:23], v[204:207], a[224:239]
    ds_read_b64_tr_b16 v[20:21], v53 offset:256
    ds_read_b64_tr_b16 v[22:23], v53 offset:2304
    s_waitcnt lgkmcnt(8)
    v_mfma_f32_32x32x16_bf16 a[0:15], v[0:3], v[208:211], a[0:15]
    ds_read_b64_tr_b16 v[0:1], v54 offset:256
    ds_read_b64_tr_b16 v[2:3], v54 offset:2304
    v_lshlrev_b32 v103, 16, v212
    v_and_b32 v104, s65, v212
    v_mfma_f32_32x32x16_bf16 a[16:31], v[4:7], v[208:211], a[16:31]
    ds_read_b64_tr_b16 v[4:5], v55 offset:256
    ds_read_b64_tr_b16 v[6:7], v55 offset:2304
    buffer_load_dwordx4 v31, s[32:35], s56 offen offset:3072 lds
    v_fma_f32 v103, v103, v99, v100
    s_waitcnt lgkmcnt(8)
    v_mfma_f32_32x32x16_bf16 a[32:47], v[8:11], v[208:211], a[32:47]
    ds_read_b64_tr_b16 v[8:9], v64 offset:16384
    ds_read_b64_tr_b16 v[10:11], v64 offset:17280
    v_fma_f32 v104, v104, v99, v100
    v_cvt_pk_bf16_f32 v212, v103, v104
    v_mfma_f32_32x32x16_bf16 a[48:63], v[12:15], v[208:211], a[48:63]
    ds_read_b64_tr_b16 v[12:13], v64 offset:16416
    ds_read_b64_tr_b16 v[14:15], v64 offset:17312
    v_lshlrev_b32 v105, 16, v213
    s_waitcnt lgkmcnt(8)
    v_mfma_f32_32x32x16_bf16 a[64:79], v[16:19], v[208:211], a[64:79]
    s_add_u32 m0, s60, 102400
    ds_read_b64_tr_b16 v[16:17], v64 offset:16448
    ds_read_b64_tr_b16 v[18:19], v64 offset:17344
    buffer_load_dwordx4 v32, s[32:35], s56 offen offset:0 lds
    v_and_b32 v106, s65, v213
    v_fma_f32 v105, v105, v99, v100
    v_mfma_f32_32x32x16_bf16 a[80:95], v[20:23], v[208:211], a[80:95]
    ds_read_b64_tr_b16 v[20:21], v64 offset:16480
    ds_read_b64_tr_b16 v[22:23], v64 offset:17376
    v_fma_f32 v106, v106, v99, v100
    s_waitcnt lgkmcnt(8)
    v_mfma_f32_32x32x16_bf16 a[96:111], v[0:3], v[208:211], a[96:111]
    ds_read_b64_tr_b16 v[0:1], v64 offset:16512
    ds_read_b64_tr_b16 v[2:3], v64 offset:17408
    v_cvt_pk_bf16_f32 v213, v105, v106
    v_mfma_f32_32x32x16_bf16 a[112:127], v[4:7], v[208:211], a[112:127]
    ds_read_b64_tr_b16 v[4:5], v64 offset:16544
    ds_read_b64_tr_b16 v[6:7], v64 offset:17440
    buffer_load_dwordx4 v33, s[32:35], s56 offen offset:1024 lds
    v_lshlrev_b32 v103, 16, v214
    v_and_b32 v104, s65, v214
    s_waitcnt lgkmcnt(8)
    v_mfma_f32_32x32x16_bf16 a[128:143], v[8:11], v[208:211], a[128:143]
    ds_read_b64_tr_b16 v[8:9], v64 offset:16576
    ds_read_b64_tr_b16 v[10:11], v64 offset:17472
    v_fma_f32 v103, v103, v99, v100
    v_mfma_f32_32x32x16_bf16 a[144:159], v[12:15], v[208:211], a[144:159]
    ds_read_b64_tr_b16 v[12:13], v52 offset:8192
    ds_read_b64_tr_b16 v[14:15], v52 offset:10240
    v_fma_f32 v104, v104, v99, v100
    v_cvt_pk_bf16_f32 v214, v103, v104
    s_waitcnt lgkmcnt(8)
    v_mfma_f32_32x32x16_bf16 a[160:175], v[16:19], v[208:211], a[160:175]
    ds_read_b64_tr_b16 v[16:17], v53 offset:8192
    ds_read_b64_tr_b16 v[18:19], v53 offset:10240
    buffer_load_dwordx4 v34, s[32:35], s56 offen offset:2048 lds
    v_lshlrev_b32 v105, 16, v215
    v_mfma_f32_32x32x16_bf16 a[176:191], v[20:23], v[208:211], a[176:191]
    ds_read_b64_tr_b16 v[20:21], v54 offset:8192
    ds_read_b64_tr_b16 v[22:23], v54 offset:10240
    v_and_b32 v106, s65, v215
    v_fma_f32 v105, v105, v99, v100
    s_waitcnt lgkmcnt(8)
    v_mfma_f32_32x32x16_bf16 a[192:207], v[0:3], v[208:211], a[192:207]
    ds_read_b64_tr_b16 v[0:1], v55 offset:8192
    ds_read_b64_tr_b16 v[2:3], v55 offset:10240
    v_fma_f32 v106, v106, v99, v100
    v_mfma_f32_32x32x16_bf16 a[208:223], v[4:7], v[208:211], a[208:223]
    ds_read_b64_tr_b16 v[4:5], v52 offset:8448
    ds_read_b64_tr_b16 v[6:7], v52 offset:10496
    buffer_load_dwordx4 v35, s[32:35], s56 offen offset:3072 lds
    s_add_u32 s56, s56, s57
    v_cvt_pk_bf16_f32 v215, v105, v106
    s_waitcnt lgkmcnt(8)
    v_mfma_f32_32x32x16_bf16 a[224:239], v[8:11], v[208:211], a[224:239]
    ds_read_b64_tr_b16 v[8:9], v53 offset:8448
    ds_read_b64_tr_b16 v[10:11], v53 offset:10496
    v_mfma_f32_32x32x16_bf16 a[0:15], v[12:15], v[212:215], a[0:15]
    ds_read_b64_tr_b16 v[12:13], v54 offset:8448
    ds_read_b64_tr_b16 v[14:15], v54 offset:10496
    v_lshlrev_b32 v103, 16, v216
    v_and_b32 v104, s65, v216
    s_waitcnt lgkmcnt(8)
    v_mfma_f32_32x32x16_bf16 a[16:31], v[16:19], v[212:215], a[16:31]
    ds_read_b64_tr_b16 v[16:17], v55 offset:8448
    ds_read_b64_tr_b16 v[18:19], v55 offset:10496
    v_fma_f32 v103, v103, v99, v100
    v_mfma_f32_32x32x16_bf16 a[32:47], v[20:23], v[212:215], a[32:47]
    ds_read_b64_tr_b16 v[20:21], v64 offset:19968
    ds_read_b64_tr_b16 v[22:23], v64 offset:20864
    v_fma_f32 v104, v104, v99, v100
    v_cvt_pk_bf16_f32 v216, v103, v104
    s_waitcnt lgkmcnt(8)
    v_mfma_f32_32x32x16_bf16 a[48:63], v[0:3], v[212:215], a[48:63]
    ds_read_b64_tr_b16 v[0:1], v64 offset:20000
    ds_read_b64_tr_b16 v[2:3], v64 offset:20896
    v_lshlrev_b32 v105, 16, v217
    v_mfma_f32_32x32x16_bf16 a[64:79], v[4:7], v[212:215], a[64:79]
    ds_read_b64_tr_b16 v[4:5], v64 offset:20032
    ds_read_b64_tr_b16 v[6:7], v64 offset:20928
    v_and_b32 v106, s65, v217
    v_fma_f32 v105, v105, v99, v100
    s_waitcnt lgkmcnt(8)
    v_mfma_f32_32x32x16_bf16 a[80:95], v[8:11], v[212:215], a[80:95]
    ds_read_b64_tr_b16 v[8:9], v64 offset:20064
    ds_read_b64_tr_b16 v[10:11], v64 offset:20960
    v_fma_f32 v106, v106, v99, v100
    v_mfma_f32_32x32x16_bf16 a[96:111], v[12:15], v[212:215], a[96:111]
    ds_read_b64_tr_b16 v[12:13], v64 offset:20096
    ds_read_b64_tr_b16 v[14:15], v64 offset:20992
    v_cvt_pk_bf16_f32 v217, v105, v106
    s_waitcnt lgkmcnt(8)
    v_mfma_f32_32x32x16_bf16 a[112:127], v[16:19], v[212:215], a[112:127]
    s_waitcnt vmcnt(16)
    s_barrier
    s_add_u32 m0, s60, 131072
    ds_read_b64_tr_b16 v[16:17], v64 offset:20128
    ds_read_b64_tr_b16 v[18:19], v64 offset:21024
    buffer_load_dwordx4 v44, s[44:47], s15 offen offset:0 lds
    v_lshlrev_b32 v103, 16, v218
    v_and_b32 v104, s65, v218
    v_mfma_f32_32x32x16_bf16 a[128:143], v[20:23], v[212:215], a[128:143]
    ds_read_b64_tr_b16 v[20:21], v64 offset:20160
    ds_read_b64_tr_b16 v[22:23], v64 offset:21056
    v_fma_f32 v103, v103, v99, v100
    s_waitcnt lgkmcnt(8)
    v_mfma_f32_32x32x16_bf16 a[144:159], v[0:3], v[212:215], a[144:159]
    ds_read_b64_tr_b16 v[0:1], v52 offset:32768
    ds_read_b64_tr_b16 v[2:3], v52 offset:34816
    v_fma_f32 v104, v104, v99, v100
    v_cvt_pk_bf16_f32 v218, v103, v104
    v_mfma_f32_32x32x16_bf16 a[160:175], v[4:7], v[212:215], a[160:175]
    ds_read_b64_tr_b16 v[4:5], v53 offset:32768
    ds_read_b64_tr_b16 v[6:7], v53 offset:34816
    buffer_load_dwordx4 v45, s[44:47], s15 offen offset:1024 lds
    v_lshlrev_b32 v105, 16, v219
    s_waitcnt lgkmcnt(8)
    v_mfma_f32_32x32x16_bf16 a[176:191], v[8:11], v[212:215], a[176:191]
    ds_read_b64_tr_b16 v[8:9], v54 offset:32768
    ds_read_b64_tr_b16 v[10:11], v54 offset:34816
    v_and_b32 v106, s65, v219
    v_fma_f32 v105, v105, v99, v100
    v_mfma_f32_32x32x16_bf16 a[192:207], v[12:15], v[212:215], a[192:207]
    ds_read_b64_tr_b16 v[12:13], v55 offset:32768
    ds_read_b64_tr_b16 v[14:15], v55 offset:34816
    v_fma_f32 v106, v106, v99, v100
    s_waitcnt lgkmcnt(8)
    v_mfma_f32_32x32x16_bf16 a[208:223], v[16:19], v[212:215], a[208:223]
    ds_read_b64_tr_b16 v[16:17], v52 offset:33024
    ds_read_b64_tr_b16 v[18:19], v52 offset:35072
    buffer_load_dwordx4 v46, s[44:47], s15 offen offset:2048 lds
    v_cvt_pk_bf16_f32 v219, v105, v106
    v_mfma_f32_32x32x16_bf16 a[224:239], v[20:23], v[212:215], a[224:239]
    ds_read_b64_tr_b16 v[20:21], v53 offset:33024
    ds_read_b64_tr_b16 v[22:23], v53 offset:35072
    s_waitcnt lgkmcnt(8)
    v_mfma_f32_32x32x16_bf16 a[0:15], v[0:3], v[216:219], a[0:15]
    ds_read_b64_tr_b16 v[0:1], v54 offset:33024
    ds_read_b64_tr_b16 v[2:3], v54 offset:35072
    v_lshlrev_b32 v103, 16, v220
    v_and_b32 v104, s65, v220
    v_mfma_f32_32x32x16_bf16 a[16:31], v[4:7], v[216:219], a[16:31]
    ds_read_b64_tr_b16 v[4:5], v55 offset:33024
    ds_read_b64_tr_b16 v[6:7], v55 offset:35072
    buffer_load_dwordx4 v47, s[44:47], s15 offen offset:3072 lds
    v_fma_f32 v103, v103, v99, v100
    s_waitcnt lgkmcnt(8)
    v_mfma_f32_32x32x16_bf16 a[32:47], v[8:11], v[216:219], a[32:47]
    ds_read_b64_tr_b16 v[8:9], v64 offset:49152
    ds_read_b64_tr_b16 v[10:11], v64 offset:50048
    v_fma_f32 v104, v104, v99, v100
    v_cvt_pk_bf16_f32 v220, v103, v104
    v_mfma_f32_32x32x16_bf16 a[48:63], v[12:15], v[216:219], a[48:63]
    ds_read_b64_tr_b16 v[12:13], v64 offset:49184
    ds_read_b64_tr_b16 v[14:15], v64 offset:50080
    v_lshlrev_b32 v105, 16, v221
    s_waitcnt lgkmcnt(8)
    v_mfma_f32_32x32x16_bf16 a[64:79], v[16:19], v[216:219], a[64:79]
    s_add_u32 m0, s60, 135168
    ds_read_b64_tr_b16 v[16:17], v64 offset:49216
    ds_read_b64_tr_b16 v[18:19], v64 offset:50112
    buffer_load_dwordx4 v48, s[44:47], s15 offen offset:0 lds
    v_and_b32 v106, s65, v221
    v_fma_f32 v105, v105, v99, v100
    v_mfma_f32_32x32x16_bf16 a[80:95], v[20:23], v[216:219], a[80:95]
    ds_read_b64_tr_b16 v[20:21], v64 offset:49248
    ds_read_b64_tr_b16 v[22:23], v64 offset:50144
    v_fma_f32 v106, v106, v99, v100
    s_waitcnt lgkmcnt(8)
    v_mfma_f32_32x32x16_bf16 a[96:111], v[0:3], v[216:219], a[96:111]
    ds_read_b64_tr_b16 v[0:1], v64 offset:49280
    ds_read_b64_tr_b16 v[2:3], v64 offset:50176
    v_cvt_pk_bf16_f32 v221, v105, v106
    v_mfma_f32_32x32x16_bf16 a[112:127], v[4:7], v[216:219], a[112:127]
    ds_read_b64_tr_b16 v[4:5], v64 offset:49312
    ds_read_b64_tr_b16 v[6:7], v64 offset:50208
    buffer_load_dwordx4 v49, s[44:47], s15 offen offset:1024 lds
    v_lshlrev_b32 v103, 16, v222
    v_and_b32 v104, s65, v222
    s_waitcnt lgkmcnt(8)
    v_mfma_f32_32x32x16_bf16 a[128:143], v[8:11], v[216:219], a[128:143]
    ds_read_b64_tr_b16 v[8:9], v64 offset:49344
    ds_read_b64_tr_b16 v[10:11], v64 offset:50240
    v_fma_f32 v103, v103, v99, v100
    v_mfma_f32_32x32x16_bf16 a[144:159], v[12:15], v[216:219], a[144:159]
    ds_read_b64_tr_b16 v[12:13], v52 offset:40960
    ds_read_b64_tr_b16 v[14:15], v52 offset:43008
    v_fma_f32 v104, v104, v99, v100
    v_cvt_pk_bf16_f32 v222, v103, v104
    s_waitcnt lgkmcnt(8)
    v_mfma_f32_32x32x16_bf16 a[160:175], v[16:19], v[216:219], a[160:175]
    ds_read_b64_tr_b16 v[16:17], v53 offset:40960
    ds_read_b64_tr_b16 v[18:19], v53 offset:43008
    buffer_load_dwordx4 v50, s[44:47], s15 offen offset:2048 lds
    v_lshlrev_b32 v105, 16, v223
    v_mfma_f32_32x32x16_bf16 a[176:191], v[20:23], v[216:219], a[176:191]
    ds_read_b64_tr_b16 v[20:21], v54 offset:40960
    ds_read_b64_tr_b16 v[22:23], v54 offset:43008
    v_and_b32 v106, s65, v223
    v_fma_f32 v105, v105, v99, v100
    s_waitcnt lgkmcnt(8)
    v_mfma_f32_32x32x16_bf16 a[192:207], v[0:3], v[216:219], a[192:207]
    ds_read_b64_tr_b16 v[0:1], v55 offset:40960
    ds_read_b64_tr_b16 v[2:3], v55 offset:43008
    v_fma_f32 v106, v106, v99, v100
    v_mfma_f32_32x32x16_bf16 a[208:223], v[4:7], v[216:219], a[208:223]
    ds_read_b64_tr_b16 v[4:5], v52 offset:41216
    ds_read_b64_tr_b16 v[6:7], v52 offset:43264
    buffer_load_dwordx4 v51, s[44:47], s15 offen offset:3072 lds
    s_add_u32 s15, s15, 256
    v_cvt_pk_bf16_f32 v223, v105, v106
    s_waitcnt lgkmcnt(8)
    v_mfma_f32_32x32x16_bf16 a[224:239], v[8:11], v[216:219], a[224:239]
    ds_read_b64_tr_b16 v[8:9], v53 offset:41216
    ds_read_b64_tr_b16 v[10:11], v53 offset:43264
    v_mfma_f32_32x32x16_bf16 a[0:15], v[12:15], v[220:223], a[0:15]
    ds_read_b64_tr_b16 v[12:13], v54 offset:41216
    ds_read_b64_tr_b16 v[14:15], v54 offset:43264
    v_lshlrev_b32 v103, 16, v224
    v_and_b32 v104, s65, v224
    s_waitcnt lgkmcnt(8)
    v_mfma_f32_32x32x16_bf16 a[16:31], v[16:19], v[220:223], a[16:31]
    ds_read_b64_tr_b16 v[16:17], v55 offset:41216
    ds_read_b64_tr_b16 v[18:19], v55 offset:43264
    v_fma_f32 v103, v103, v99, v100
    v_mfma_f32_32x32x16_bf16 a[32:47], v[20:23], v[220:223], a[32:47]
    ds_read_b64_tr_b16 v[20:21], v64 offset:52736
    ds_read_b64_tr_b16 v[22:23], v64 offset:53632
    v_fma_f32 v104, v104, v99, v100
    v_cvt_pk_bf16_f32 v224, v103, v104
    s_waitcnt lgkmcnt(8)
    v_mfma_f32_32x32x16_bf16 a[48:63], v[0:3], v[220:223], a[48:63]
    ds_read_b64_tr_b16 v[0:1], v64 offset:52768
    ds_read_b64_tr_b16 v[2:3], v64 offset:53664
    v_lshlrev_b32 v105, 16, v225
    v_mfma_f32_32x32x16_bf16 a[64:79], v[4:7], v[220:223], a[64:79]
    ds_read_b64_tr_b16 v[4:5], v64 offset:52800
    ds_read_b64_tr_b16 v[6:7], v64 offset:53696
    v_and_b32 v106, s65, v225
    v_fma_f32 v105, v105, v99, v100
    s_waitcnt lgkmcnt(8)
    v_mfma_f32_32x32x16_bf16 a[80:95], v[8:11], v[220:223], a[80:95]
    ds_read_b64_tr_b16 v[8:9], v64 offset:52832
    ds_read_b64_tr_b16 v[10:11], v64 offset:53728
    v_fma_f32 v106, v106, v99, v100
    v_mfma_f32_32x32x16_bf16 a[96:111], v[12:15], v[220:223], a[96:111]
    ds_read_b64_tr_b16 v[12:13], v64 offset:52864
    ds_read_b64_tr_b16 v[14:15], v64 offset:53760
    v_cvt_pk_bf16_f32 v225, v105, v106
    s_waitcnt lgkmcnt(8)
    v_mfma_f32_32x32x16_bf16 a[112:127], v[16:19], v[220:223], a[112:127]
    s_waitcnt vmcnt(16)
    s_barrier
    s_add_u32 m0, s60, 0
    ds_read_b64_tr_b16 v[16:17], v64 offset:52896
    ds_read_b64_tr_b16 v[18:19], v64 offset:53792
    buffer_load_dwordx4 v44, s[44:47], s15 offen offset:0 lds
    v_lshlrev_b32 v103, 16, v226
    v_and_b32 v104, s65, v226
    v_mfma_f32_32x32x16_bf16 a[128:143], v[20:23], v[220:223], a[128:143]
    ds_read_b64_tr_b16 v[20:21], v64 offset:52928
    ds_read_b64_tr_b16 v[22:23], v64 offset:53824
    v_fma_f32 v103, v103, v99, v100
    s_waitcnt lgkmcnt(8)
    v_mfma_f32_32x32x16_bf16 a[144:159], v[0:3], v[220:223], a[144:159]
    ds_read_b64_tr_b16 v[0:1], v56 offset:0
    ds_read_b64_tr_b16 v[2:3], v56 offset:2048
    v_fma_f32 v104, v104, v99, v100
    v_cvt_pk_bf16_f32 v226, v103, v104
    v_mfma_f32_32x32x16_bf16 a[160:175], v[4:7], v[220:223], a[160:175]
    ds_read_b64_tr_b16 v[4:5], v57 offset:0
    ds_read_b64_tr_b16 v[6:7], v57 offset:2048
    buffer_load_dwordx4 v45, s[44:47], s15 offen offset:1024 lds
    v_lshlrev_b32 v105, 16, v227
    s_waitcnt lgkmcnt(8)
    v_mfma_f32_32x32x16_bf16 a[176:191], v[8:11], v[220:223], a[176:191]
    ds_read_b64_tr_b16 v[8:9], v58 offset:0
    ds_read_b64_tr_b16 v[10:11], v58 offset:2048
    v_and_b32 v106, s65, v227
    v_fma_f32 v105, v105, v99, v100
    v_mfma_f32_32x32x16_bf16 a[192:207], v[12:15], v[220:223], a[192:207]
    ds_read_b64_tr_b16 v[12:13], v59 offset:0
    ds_read_b64_tr_b16 v[14:15], v59 offset:2048
    v_fma_f32 v106, v106, v99, v100
    s_waitcnt lgkmcnt(8)
    v_mfma_f32_32x32x16_bf16 a[208:223], v[16:19], v[220:223], a[208:223]
    ds_read_b64_tr_b16 v[16:17], v56 offset:256
    ds_read_b64_tr_b16 v[18:19], v56 offset:2304
    buffer_load_dwordx4 v46, s[44:47], s15 offen offset:2048 lds
    v_cvt_pk_bf16_f32 v227, v105, v106
    v_mfma_f32_32x32x16_bf16 a[224:239], v[20:23], v[220:223], a[224:239]
    ds_read_b64_tr_b16 v[20:21], v57 offset:256
    ds_read_b64_tr_b16 v[22:23], v57 offset:2304
    s_waitcnt lgkmcnt(8)
    v_mfma_f32_32x32x16_bf16 a[0:15], v[0:3], v[224:227], a[0:15]
    ds_read_b64_tr_b16 v[0:1], v58 offset:256
    ds_read_b64_tr_b16 v[2:3], v58 offset:2304
    v_lshlrev_b32 v103, 16, v228
    v_and_b32 v104, s65, v228
    v_mfma_f32_32x32x16_bf16 a[16:31], v[4:7], v[224:227], a[16:31]
    ds_read_b64_tr_b16 v[4:5], v59 offset:256
    ds_read_b64_tr_b16 v[6:7], v59 offset:2304
    buffer_load_dwordx4 v47, s[44:47], s15 offen offset:3072 lds
    v_fma_f32 v103, v103, v99, v100
    s_waitcnt lgkmcnt(8)
    v_mfma_f32_32x32x16_bf16 a[32:47], v[8:11], v[224:227], a[32:47]
    ds_read_b64_tr_b16 v[8:9], v65 offset:16384
    ds_read_b64_tr_b16 v[10:11], v65 offset:17280
    v_fma_f32 v104, v104, v99, v100
    v_cvt_pk_bf16_f32 v228, v103, v104
    v_mfma_f32_32x32x16_bf16 a[48:63], v[12:15], v[224:227], a[48:63]
    ds_read_b64_tr_b16 v[12:13], v65 offset:16416
    ds_read_b64_tr_b16 v[14:15], v65 offset:17312
    v_lshlrev_b32 v105, 16, v229
    s_waitcnt lgkmcnt(8)
    v_mfma_f32_32x32x16_bf16 a[64:79], v[16:19], v[224:227], a[64:79]
    s_add_u32 m0, s60, 4096
    ds_read_b64_tr_b16 v[16:17], v65 offset:16448
    ds_read_b64_tr_b16 v[18:19], v65 offset:17344
    buffer_load_dwordx4 v48, s[44:47], s15 offen offset:0 lds
    v_and_b32 v106, s65, v229
    v_fma_f32 v105, v105, v99, v100
    v_mfma_f32_32x32x16_bf16 a[80:95], v[20:23], v[224:227], a[80:95]
    ds_read_b64_tr_b16 v[20:21], v65 offset:16480
    ds_read_b64_tr_b16 v[22:23], v65 offset:17376
    v_fma_f32 v106, v106, v99, v100
    s_waitcnt lgkmcnt(8)
    v_mfma_f32_32x32x16_bf16 a[96:111], v[0:3], v[224:227], a[96:111]
    ds_read_b64_tr_b16 v[0:1], v65 offset:16512
    ds_read_b64_tr_b16 v[2:3], v65 offset:17408
    v_cvt_pk_bf16_f32 v229, v105, v106
    v_mfma_f32_32x32x16_bf16 a[112:127], v[4:7], v[224:227], a[112:127]
    ds_read_b64_tr_b16 v[4:5], v65 offset:16544
    ds_read_b64_tr_b16 v[6:7], v65 offset:17440
    buffer_load_dwordx4 v49, s[44:47], s15 offen offset:1024 lds
    v_lshlrev_b32 v103, 16, v230
    v_and_b32 v104, s65, v230
    s_waitcnt lgkmcnt(8)
    v_mfma_f32_32x32x16_bf16 a[128:143], v[8:11], v[224:227], a[128:143]
    ds_read_b64_tr_b16 v[8:9], v65 offset:16576
    ds_read_b64_tr_b16 v[10:11], v65 offset:17472
    v_fma_f32 v103, v103, v99, v100
    v_mfma_f32_32x32x16_bf16 a[144:159], v[12:15], v[224:227], a[144:159]
    ds_read_b64_tr_b16 v[12:13], v56 offset:8192
    ds_read_b64_tr_b16 v[14:15], v56 offset:10240
    v_fma_f32 v104, v104, v99, v100
    v_cvt_pk_bf16_f32 v230, v103, v104
    s_waitcnt lgkmcnt(8)
    v_mfma_f32_32x32x16_bf16 a[160:175], v[16:19], v[224:227], a[160:175]
    ds_read_b64_tr_b16 v[16:17], v57 offset:8192
    ds_read_b64_tr_b16 v[18:19], v57 offset:10240
    buffer_load_dwordx4 v50, s[44:47], s15 offen offset:2048 lds
    v_lshlrev_b32 v105, 16, v231
    v_mfma_f32_32x32x16_bf16 a[176:191], v[20:23], v[224:227], a[176:191]
    ds_read_b64_tr_b16 v[20:21], v58 offset:8192
    ds_read_b64_tr_b16 v[22:23], v58 offset:10240
    v_and_b32 v106, s65, v231
    v_fma_f32 v105, v105, v99, v100
    s_waitcnt lgkmcnt(8)
    v_mfma_f32_32x32x16_bf16 a[192:207], v[0:3], v[224:227], a[192:207]
    ds_read_b64_tr_b16 v[0:1], v59 offset:8192
    ds_read_b64_tr_b16 v[2:3], v59 offset:10240
    v_fma_f32 v106, v106, v99, v100
    v_mfma_f32_32x32x16_bf16 a[208:223], v[4:7], v[224:227], a[208:223]
    ds_read_b64_tr_b16 v[4:5], v56 offset:8448
    ds_read_b64_tr_b16 v[6:7], v56 offset:10496
    buffer_load_dwordx4 v51, s[44:47], s15 offen offset:3072 lds
    s_add_u32 s15, s15, 256
    v_cvt_pk_bf16_f32 v231, v105, v106
    s_waitcnt lgkmcnt(8)
    v_mfma_f32_32x32x16_bf16 a[224:239], v[8:11], v[224:227], a[224:239]
    ds_read_b64_tr_b16 v[8:9], v57 offset:8448
    ds_read_b64_tr_b16 v[10:11], v57 offset:10496
    v_mfma_f32_32x32x16_bf16 a[0:15], v[12:15], v[228:231], a[0:15]
    ds_read_b64_tr_b16 v[12:13], v58 offset:8448
    ds_read_b64_tr_b16 v[14:15], v58 offset:10496
    v_lshlrev_b32 v103, 16, v232
    v_and_b32 v104, s65, v232
    s_waitcnt lgkmcnt(8)
    v_mfma_f32_32x32x16_bf16 a[16:31], v[16:19], v[228:231], a[16:31]
    ds_read_b64_tr_b16 v[16:17], v59 offset:8448
    ds_read_b64_tr_b16 v[18:19], v59 offset:10496
    v_fma_f32 v103, v103, v99, v100
    v_mfma_f32_32x32x16_bf16 a[32:47], v[20:23], v[228:231], a[32:47]
    ds_read_b64_tr_b16 v[20:21], v65 offset:19968
    ds_read_b64_tr_b16 v[22:23], v65 offset:20864
    v_fma_f32 v104, v104, v99, v100
    v_cvt_pk_bf16_f32 v232, v103, v104
    s_waitcnt lgkmcnt(8)
    v_mfma_f32_32x32x16_bf16 a[48:63], v[0:3], v[228:231], a[48:63]
    ds_read_b64_tr_b16 v[0:1], v65 offset:20000
    ds_read_b64_tr_b16 v[2:3], v65 offset:20896
    v_lshlrev_b32 v105, 16, v233
    v_mfma_f32_32x32x16_bf16 a[64:79], v[4:7], v[228:231], a[64:79]
    ds_read_b64_tr_b16 v[4:5], v65 offset:20032
    ds_read_b64_tr_b16 v[6:7], v65 offset:20928
    v_and_b32 v106, s65, v233
    v_fma_f32 v105, v105, v99, v100
    s_waitcnt lgkmcnt(8)
    v_mfma_f32_32x32x16_bf16 a[80:95], v[8:11], v[228:231], a[80:95]
    ds_read_b64_tr_b16 v[8:9], v65 offset:20064
    ds_read_b64_tr_b16 v[10:11], v65 offset:20960
    v_fma_f32 v106, v106, v99, v100
    v_mfma_f32_32x32x16_bf16 a[96:111], v[12:15], v[228:231], a[96:111]
    ds_read_b64_tr_b16 v[12:13], v65 offset:20096
    ds_read_b64_tr_b16 v[14:15], v65 offset:20992
    v_cvt_pk_bf16_f32 v233, v105, v106
    s_waitcnt lgkmcnt(8)
    v_mfma_f32_32x32x16_bf16 a[112:127], v[16:19], v[228:231], a[112:127]
    s_waitcnt vmcnt(16)
    s_barrier
    s_add_u32 m0, s60, 32768
    ds_read_b64_tr_b16 v[16:17], v65 offset:20128
    ds_read_b64_tr_b16 v[18:19], v65 offset:21024
    buffer_load_dwordx4 v44, s[44:47], s15 offen offset:0 lds
    v_lshlrev_b32 v103, 16, v234
    v_and_b32 v104, s65, v234
    v_mfma_f32_32x32x16_bf16 a[128:143], v[20:23], v[228:231], a[128:143]
    ds_read_b64_tr_b16 v[20:21], v65 offset:20160
    ds_read_b64_tr_b16 v[22:23], v65 offset:21056
    v_fma_f32 v103, v103, v99, v100
    s_waitcnt lgkmcnt(8)
    v_mfma_f32_32x32x16_bf16 a[144:159], v[0:3], v[228:231], a[144:159]
    ds_read_b64_tr_b16 v[0:1], v56 offset:32768
    ds_read_b64_tr_b16 v[2:3], v56 offset:34816
    v_fma_f32 v104, v104, v99, v100
    v_cvt_pk_bf16_f32 v234, v103, v104
    v_mfma_f32_32x32x16_bf16 a[160:175], v[4:7], v[228:231], a[160:175]
    ds_read_b64_tr_b16 v[4:5], v57 offset:32768
    ds_read_b64_tr_b16 v[6:7], v57 offset:34816
    buffer_load_dwordx4 v45, s[44:47], s15 offen offset:1024 lds
    v_lshlrev_b32 v105, 16, v235
    s_waitcnt lgkmcnt(8)
    v_mfma_f32_32x32x16_bf16 a[176:191], v[8:11], v[228:231], a[176:191]
    ds_read_b64_tr_b16 v[8:9], v58 offset:32768
    ds_read_b64_tr_b16 v[10:11], v58 offset:34816
    v_and_b32 v106, s65, v235
    v_fma_f32 v105, v105, v99, v100
    v_mfma_f32_32x32x16_bf16 a[192:207], v[12:15], v[228:231], a[192:207]
    ds_read_b64_tr_b16 v[12:13], v59 offset:32768
    ds_read_b64_tr_b16 v[14:15], v59 offset:34816
    v_fma_f32 v106, v106, v99, v100
    s_waitcnt lgkmcnt(8)
    v_mfma_f32_32x32x16_bf16 a[208:223], v[16:19], v[228:231], a[208:223]
    ds_read_b64_tr_b16 v[16:17], v56 offset:33024
    ds_read_b64_tr_b16 v[18:19], v56 offset:35072
    buffer_load_dwordx4 v46, s[44:47], s15 offen offset:2048 lds
    v_cvt_pk_bf16_f32 v235, v105, v106
    v_mfma_f32_32x32x16_bf16 a[224:239], v[20:23], v[228:231], a[224:239]
    ds_read_b64_tr_b16 v[20:21], v57 offset:33024
    ds_read_b64_tr_b16 v[22:23], v57 offset:35072
    s_waitcnt lgkmcnt(8)
    v_mfma_f32_32x32x16_bf16 a[0:15], v[0:3], v[232:235], a[0:15]
    ds_read_b64_tr_b16 v[0:1], v58 offset:33024
    ds_read_b64_tr_b16 v[2:3], v58 offset:35072
    v_lshlrev_b32 v103, 16, v236
    v_and_b32 v104, s65, v236
    v_mfma_f32_32x32x16_bf16 a[16:31], v[4:7], v[232:235], a[16:31]
    ds_read_b64_tr_b16 v[4:5], v59 offset:33024
    ds_read_b64_tr_b16 v[6:7], v59 offset:35072
    buffer_load_dwordx4 v47, s[44:47], s15 offen offset:3072 lds
    v_fma_f32 v103, v103, v99, v100
    s_waitcnt lgkmcnt(8)
    v_mfma_f32_32x32x16_bf16 a[32:47], v[8:11], v[232:235], a[32:47]
    ds_read_b64_tr_b16 v[8:9], v65 offset:49152
    ds_read_b64_tr_b16 v[10:11], v65 offset:50048
    v_fma_f32 v104, v104, v99, v100
    v_cvt_pk_bf16_f32 v236, v103, v104
    v_mfma_f32_32x32x16_bf16 a[48:63], v[12:15], v[232:235], a[48:63]
    ds_read_b64_tr_b16 v[12:13], v65 offset:49184
    ds_read_b64_tr_b16 v[14:15], v65 offset:50080
    v_lshlrev_b32 v105, 16, v237
    s_waitcnt lgkmcnt(8)
    v_mfma_f32_32x32x16_bf16 a[64:79], v[16:19], v[232:235], a[64:79]
    s_add_u32 m0, s60, 36864
    ds_read_b64_tr_b16 v[16:17], v65 offset:49216
    ds_read_b64_tr_b16 v[18:19], v65 offset:50112
    buffer_load_dwordx4 v48, s[44:47], s15 offen offset:0 lds
    v_and_b32 v106, s65, v237
    v_fma_f32 v105, v105, v99, v100
    v_mfma_f32_32x32x16_bf16 a[80:95], v[20:23], v[232:235], a[80:95]
    ds_read_b64_tr_b16 v[20:21], v65 offset:49248
    ds_read_b64_tr_b16 v[22:23], v65 offset:50144
    v_fma_f32 v106, v106, v99, v100
    s_waitcnt lgkmcnt(8)
    v_mfma_f32_32x32x16_bf16 a[96:111], v[0:3], v[232:235], a[96:111]
    ds_read_b64_tr_b16 v[0:1], v65 offset:49280
    ds_read_b64_tr_b16 v[2:3], v65 offset:50176
    v_cvt_pk_bf16_f32 v237, v105, v106
    v_mfma_f32_32x32x16_bf16 a[112:127], v[4:7], v[232:235], a[112:127]
    ds_read_b64_tr_b16 v[4:5], v65 offset:49312
    ds_read_b64_tr_b16 v[6:7], v65 offset:50208
    buffer_load_dwordx4 v49, s[44:47], s15 offen offset:1024 lds
    v_lshlrev_b32 v103, 16, v238
    v_and_b32 v104, s65, v238
    s_waitcnt lgkmcnt(8)
    v_mfma_f32_32x32x16_bf16 a[128:143], v[8:11], v[232:235], a[128:143]
    ds_read_b64_tr_b16 v[8:9], v65 offset:49344
    ds_read_b64_tr_b16 v[10:11], v65 offset:50240
    v_fma_f32 v103, v103, v99, v100
    v_mfma_f32_32x32x16_bf16 a[144:159], v[12:15], v[232:235], a[144:159]
    ds_read_b64_tr_b16 v[12:13], v65 offset:52736
    ds_read_b64_tr_b16 v[14:15], v65 offset:53632
    v_fma_f32 v104, v104, v99, v100
    v_cvt_pk_bf16_f32 v238, v103, v104
    s_waitcnt lgkmcnt(8)
    v_mfma_f32_32x32x16_bf16 a[160:175], v[16:19], v[232:235], a[160:175]
    ds_read_b64_tr_b16 v[16:17], v65 offset:52768
    ds_read_b64_tr_b16 v[18:19], v65 offset:53664
    buffer_load_dwordx4 v50, s[44:47], s15 offen offset:2048 lds
    v_lshlrev_b32 v105, 16, v239
    v_mfma_f32_32x32x16_bf16 a[176:191], v[20:23], v[232:235], a[176:191]
    ds_read_b64_tr_b16 v[20:21], v65 offset:52800
    ds_read_b64_tr_b16 v[22:23], v65 offset:53696
    v_and_b32 v106, s65, v239
    v_fma_f32 v105, v105, v99, v100
    s_waitcnt lgkmcnt(8)
    v_mfma_f32_32x32x16_bf16 a[192:207], v[0:3], v[232:235], a[192:207]
    ds_read_b64_tr_b16 v[0:1], v65 offset:52832
    ds_read_b64_tr_b16 v[2:3], v65 offset:53728
    v_fma_f32 v106, v106, v99, v100
    v_mfma_f32_32x32x16_bf16 a[208:223], v[4:7], v[232:235], a[208:223]
    ds_read_b64_tr_b16 v[4:5], v65 offset:52864
    ds_read_b64_tr_b16 v[6:7], v65 offset:53760
    buffer_load_dwordx4 v51, s[44:47], s15 offen offset:3072 lds
    s_add_u32 s15, s15, s70
    v_cvt_pk_bf16_f32 v239, v105, v106
    s_waitcnt lgkmcnt(8)
    v_mfma_f32_32x32x16_bf16 a[224:239], v[8:11], v[232:235], a[224:239]
    ds_read_b64_tr_b16 v[8:9], v65 offset:52896
    ds_read_b64_tr_b16 v[10:11], v65 offset:53792
    v_mfma_f32_32x32x16_bf16 a[128:143], v[12:15], v[236:239], a[128:143]
    ds_read_b64_tr_b16 v[12:13], v65 offset:52928
    ds_read_b64_tr_b16 v[14:15], v65 offset:53824
    s_waitcnt lgkmcnt(8)
    v_mfma_f32_32x32x16_bf16 a[144:159], v[16:19], v[236:239], a[144:159]
    ds_read_b64_tr_b16 v[16:17], v56 offset:40960
    ds_read_b64_tr_b16 v[18:19], v56 offset:43008
    v_mfma_f32_32x32x16_bf16 a[160:175], v[20:23], v[236:239], a[160:175]
    ds_read_b64_tr_b16 v[20:21], v57 offset:40960
    ds_read_b64_tr_b16 v[22:23], v57 offset:43008
    s_nop 2
    v_accvgpr_read_b32 v103, a128
    v_accvgpr_read_b32 v104, a136
    v_accvgpr_read_b32 v105, a129
    v_accvgpr_read_b32 v106, a137
    v_mul_f32 v103, v103, v104
    v_mul_f32 v105, v105, v106
    v_cvt_pk_bf16_f32 v24, v103, v105
    s_waitcnt lgkmcnt(8)
    v_mfma_f32_32x32x16_bf16 a[176:191], v[0:3], v[236:239], a[176:191]
    ds_read_b64_tr_b16 v[0:1], v58 offset:40960
    ds_read_b64_tr_b16 v[2:3], v58 offset:43008
    v_accvgpr_read_b32 v107, a130
    v_accvgpr_read_b32 v108, a138
    v_accvgpr_read_b32 v109, a131
    v_accvgpr_read_b32 v110, a139
    v_mul_f32 v107, v107, v108
    v_mul_f32 v109, v109, v110
    v_cvt_pk_bf16_f32 v25, v107, v109
    v_mfma_f32_32x32x16_bf16 a[192:207], v[4:7], v[236:239], a[192:207]
    ds_read_b64_tr_b16 v[4:5], v59 offset:40960
    ds_read_b64_tr_b16 v[6:7], v59 offset:43008
    v_accvgpr_read_b32 v103, a132
    v_accvgpr_read_b32 v104, a140
    v_accvgpr_read_b32 v105, a133
    v_accvgpr_read_b32 v106, a141
    v_mul_f32 v103, v103, v104
    v_mul_f32 v105, v105, v106
    v_cvt_pk_bf16_f32 v26, v103, v105
    s_waitcnt lgkmcnt(8)
    v_mfma_f32_32x32x16_bf16 a[208:223], v[8:11], v[236:239], a[208:223]
    ds_read_b64_tr_b16 v[8:9], v56 offset:41216
    ds_read_b64_tr_b16 v[10:11], v56 offset:43264
    v_accvgpr_read_b32 v107, a134
    v_accvgpr_read_b32 v108, a142
    v_accvgpr_read_b32 v109, a135
    v_accvgpr_read_b32 v110, a143
    v_mul_f32 v107, v107, v108
    v_mul_f32 v109, v109, v110
    v_cvt_pk_bf16_f32 v27, v107, v109
    v_mfma_f32_32x32x16_bf16 a[224:239], v[12:15], v[236:239], a[224:239]
    ds_read_b64_tr_b16 v[12:13], v57 offset:41216
    ds_read_b64_tr_b16 v[14:15], v57 offset:43264
    v_accvgpr_read_b32 v103, a144
    v_accvgpr_read_b32 v104, a152
    v_accvgpr_read_b32 v105, a145
    v_accvgpr_read_b32 v106, a153
    v_mul_f32 v103, v103, v104
    v_mul_f32 v105, v105, v106
    v_cvt_pk_bf16_f32 v28, v103, v105
    s_waitcnt lgkmcnt(8)
    v_mfma_f32_32x32x16_bf16 a[0:15], v[16:19], v[236:239], a[0:15]
    s_waitcnt vmcnt(16)
    s_barrier
    s_add_u32 m0, s60, 65536
    ds_read_b64_tr_b16 v[16:17], v58 offset:41216
    ds_read_b64_tr_b16 v[18:19], v58 offset:43264
    buffer_load_dwordx4 v44, s[44:47], s15 offen offset:0 lds
    v_accvgpr_read_b32 v107, a146
    v_accvgpr_read_b32 v108, a154
    v_accvgpr_read_b32 v109, a147
    v_accvgpr_read_b32 v110, a155
    v_mul_f32 v107, v107, v108
    v_mul_f32 v109, v109, v110
    v_cvt_pk_bf16_f32 v29, v107, v109
    v_mfma_f32_32x32x16_bf16 a[16:31], v[20:23], v[236:239], a[16:31]
    ds_read_b64_tr_b16 v[20:21], v59 offset:41216
    ds_read_b64_tr_b16 v[22:23], v59 offset:43264
    v_accvgpr_read_b32 v103, a148
    v_accvgpr_read_b32 v104, a156
    v_accvgpr_read_b32 v105, a149
    v_accvgpr_read_b32 v106, a157
    v_mul_f32 v103, v103, v104
    v_mul_f32 v105, v105, v106
    v_cvt_pk_bf16_f32 v30, v103, v105
    s_waitcnt lgkmcnt(8)
    v_mfma_f32_32x32x16_bf16 a[32:47], v[0:3], v[236:239], a[32:47]
    ds_read_b64_tr_b16 v[0:1], v71 offset:0
    ds_read_b64_tr_b16 v[2:3], v71 offset:512
    v_accvgpr_read_b32 v107, a150
    v_accvgpr_read_b32 v108, a158
    v_accvgpr_read_b32 v109, a151
    v_accvgpr_read_b32 v110, a159
    v_mul_f32 v107, v107, v108
    v_mul_f32 v109, v109, v110
    v_cvt_pk_bf16_f32 v31, v107, v109
    v_mfma_f32_32x32x16_bf16 a[48:63], v[4:7], v[236:239], a[48:63]
    ds_read_b64_tr_b16 v[4:5], v72 offset:0
    ds_read_b64_tr_b16 v[6:7], v72 offset:512
    buffer_load_dwordx4 v45, s[44:47], s15 offen offset:1024 lds
    v_accvgpr_read_b32 v103, a160
    v_accvgpr_read_b32 v104, a168
    v_accvgpr_read_b32 v105, a161
    v_accvgpr_read_b32 v106, a169
    v_mul_f32 v103, v103, v104
    v_mul_f32 v105, v105, v106
    v_cvt_pk_bf16_f32 v32, v103, v105
    s_waitcnt lgkmcnt(8)
    v_mfma_f32_32x32x16_bf16 a[64:79], v[8:11], v[236:239], a[64:79]
    ds_read_b64_tr_b16 v[8:9], v71 offset:16384
    ds_read_b64_tr_b16 v[10:11], v71 offset:16896
    v_accvgpr_read_b32 v107, a162
    v_accvgpr_read_b32 v108, a170
    v_accvgpr_read_b32 v109, a163
    v_accvgpr_read_b32 v110, a171
    v_mul_f32 v107, v107, v108
    v_mul_f32 v109, v109, v110
    v_cvt_pk_bf16_f32 v33, v107, v109
    v_mfma_f32_32x32x16_bf16 a[80:95], v[12:15], v[236:239], a[80:95]
    ds_read_b64_tr_b16 v[12:13], v71 offset:2048
    ds_read_b64_tr_b16 v[14:15], v71 offset:2560
    v_accvgpr_read_b32 v103, a164
    v_accvgpr_read_b32 v104, a172
    v_accvgpr_read_b32 v105, a165
    v_accvgpr_read_b32 v106, a173
    v_mul_f32 v103, v103, v104
    v_mul_f32 v105, v105, v106
    v_cvt_pk_bf16_f32 v34, v103, v105
    s_waitcnt lgkmcnt(8)
    v_mfma_f32_32x32x16_bf16 a[96:111], v[16:19], v[236:239], a[96:111]
    ds_read_b64_tr_b16 v[16:17], v72 offset:2048
    ds_read_b64_tr_b16 v[18:19], v72 offset:2560
    buffer_load_dwordx4 v46, s[44:47], s15 offen offset:2048 lds
    v_accvgpr_read_b32 v107, a166
    v_accvgpr_read_b32 v108, a174
    v_accvgpr_read_b32 v109, a167
    v_accvgpr_read_b32 v110, a175
    v_mul_f32 v107, v107, v108
    v_mul_f32 v109, v109, v110
    v_cvt_pk_bf16_f32 v35, v107, v109
    v_mfma_f32_32x32x16_bf16 a[112:127], v[20:23], v[236:239], a[112:127]
    ds_read_b64_tr_b16 v[20:21], v71 offset:18432
    ds_read_b64_tr_b16 v[22:23], v71 offset:18944
    v_accvgpr_read_b32 v103, a176
    v_accvgpr_read_b32 v104, a184
    v_accvgpr_read_b32 v105, a177
    v_accvgpr_read_b32 v106, a185
    v_mul_f32 v103, v103, v104
    v_mul_f32 v105, v105, v106
    v_cvt_pk_bf16_f32 v112, v103, v105
    s_waitcnt lgkmcnt(8)
    v_mfma_f32_32x32x16_bf16 v[192:207], v[0:3], v[24:27], 0
    ds_read_b64_tr_b16 v[0:1], v71 offset:4096
    ds_read_b64_tr_b16 v[2:3], v71 offset:4608
    v_accvgpr_read_b32 v107, a178
    v_accvgpr_read_b32 v108, a186
    v_accvgpr_read_b32 v109, a179
    v_accvgpr_read_b32 v110, a187
    v_mul_f32 v107, v107, v108
    v_mul_f32 v109, v109, v110
    v_cvt_pk_bf16_f32 v113, v107, v109
    v_mfma_f32_32x32x16_bf16 v[208:223], v[4:7], v[24:27], 0
    ds_read_b64_tr_b16 v[4:5], v72 offset:4096
    ds_read_b64_tr_b16 v[6:7], v72 offset:4608
    buffer_load_dwordx4 v47, s[44:47], s15 offen offset:3072 lds
    v_accvgpr_read_b32 v103, a180
    v_accvgpr_read_b32 v104, a188
    v_accvgpr_read_b32 v105, a181
    v_accvgpr_read_b32 v106, a189
    v_mul_f32 v103, v103, v104
    v_mul_f32 v105, v105, v106
    v_cvt_pk_bf16_f32 v114, v103, v105
    s_waitcnt lgkmcnt(8)
    v_mfma_f32_32x32x16_bf16 v[224:239], v[8:11], v[24:27], 0
    ds_read_b64_tr_b16 v[8:9], v71 offset:20480
    ds_read_b64_tr_b16 v[10:11], v71 offset:20992
    v_accvgpr_read_b32 v107, a182
    v_accvgpr_read_b32 v108, a190
    v_accvgpr_read_b32 v109, a183
    v_accvgpr_read_b32 v110, a191
    v_mul_f32 v107, v107, v108
    v_mul_f32 v109, v109, v110
    v_cvt_pk_bf16_f32 v115, v107, v109
    v_mfma_f32_32x32x16_bf16 v[192:207], v[12:15], v[28:31], v[192:207]
    ds_read_b64_tr_b16 v[12:13], v71 offset:6144
    ds_read_b64_tr_b16 v[14:15], v71 offset:6656
    v_accvgpr_read_b32 v103, a192
    v_accvgpr_read_b32 v104, a200
    v_accvgpr_read_b32 v105, a193
    v_accvgpr_read_b32 v106, a201
    v_mul_f32 v103, v103, v104
    v_mul_f32 v105, v105, v106
    v_cvt_pk_bf16_f32 v116, v103, v105
    s_waitcnt lgkmcnt(8)
    v_mfma_f32_32x32x16_bf16 v[208:223], v[16:19], v[28:31], v[208:223]
    s_add_u32 m0, s60, 69632
    ds_read_b64_tr_b16 v[16:17], v72 offset:6144
    ds_read_b64_tr_b16 v[18:19], v72 offset:6656
    buffer_load_dwordx4 v48, s[44:47], s15 offen offset:0 lds
    v_accvgpr_read_b32 v107, a194
    v_accvgpr_read_b32 v108, a202
    v_accvgpr_read_b32 v109, a195
    v_accvgpr_read_b32 v110, a203
    v_mul_f32 v107, v107, v108
    v_mul_f32 v109, v109, v110
    v_cvt_pk_bf16_f32 v117, v107, v109
    v_mfma_f32_32x32x16_bf16 v[224:239], v[20:23], v[28:31], v[224:239]
    ds_read_b64_tr_b16 v[20:21], v71 offset:22528
    ds_read_b64_tr_b16 v[22:23], v71 offset:23040
    v_accvgpr_read_b32 v103, a196
    v_accvgpr_read_b32 v104, a204
    v_accvgpr_read_b32 v105, a197
    v_accvgpr_read_b32 v106, a205
    v_mul_f32 v103, v103, v104
    v_mul_f32 v105, v105, v106
    v_cvt_pk_bf16_f32 v118, v103, v105
    s_waitcnt lgkmcnt(8)
    v_mfma_f32_32x32x16_bf16 v[192:207], v[0:3], v[32:35], v[192:207]
    ds_read_b64_tr_b16 v[0:1], v71 offset:8192
    ds_read_b64_tr_b16 v[2:3], v71 offset:8704
    v_accvgpr_read_b32 v107, a198
    v_accvgpr_read_b32 v108, a206
    v_accvgpr_read_b32 v109, a199
    v_accvgpr_read_b32 v110, a207
    v_mul_f32 v107, v107, v108
    v_mul_f32 v109, v109, v110
    v_cvt_pk_bf16_f32 v119, v107, v109
    v_mfma_f32_32x32x16_bf16 v[208:223], v[4:7], v[32:35], v[208:223]
    ds_read_b64_tr_b16 v[4:5], v72 offset:8192
    ds_read_b64_tr_b16 v[6:7], v72 offset:8704
    buffer_load_dwordx4 v49, s[44:47], s15 offen offset:1024 lds
    v_accvgpr_read_b32 v103, a208
    v_accvgpr_read_b32 v104, a216
    v_accvgpr_read_b32 v105, a209
    v_accvgpr_read_b32 v106, a217
    v_mul_f32 v103, v103, v104
    v_mul_f32 v105, v105, v106
    v_cvt_pk_bf16_f32 v120, v103, v105
    s_waitcnt lgkmcnt(8)
    v_mfma_f32_32x32x16_bf16 v[224:239], v[8:11], v[32:35], v[224:239]
    ds_read_b64_tr_b16 v[8:9], v71 offset:24576
    ds_read_b64_tr_b16 v[10:11], v71 offset:25088
    v_accvgpr_read_b32 v107, a210
    v_accvgpr_read_b32 v108, a218
    v_accvgpr_read_b32 v109, a211
    v_accvgpr_read_b32 v110, a219
    v_mul_f32 v107, v107, v108
    v_mul_f32 v109, v109, v110
    v_cvt_pk_bf16_f32 v121, v107, v109
    v_mfma_f32_32x32x16_bf16 v[192:207], v[12:15], v[112:115], v[192:207]
    ds_read_b64_tr_b16 v[12:13], v71 offset:10240
    ds_read_b64_tr_b16 v[14:15], v71 offset:10752
    v_accvgpr_read_b32 v103, a212
    v_accvgpr_read_b32 v104, a220
    v_accvgpr_read_b32 v105, a213
    v_accvgpr_read_b32 v106, a221
    v_mul_f32 v103, v103, v104
    v_mul_f32 v105, v105, v106
    v_cvt_pk_bf16_f32 v122, v103, v105
    s_waitcnt lgkmcnt(8)
    v_mfma_f32_32x32x16_bf16 v[208:223], v[16:19], v[112:115], v[208:223]
    ds_read_b64_tr_b16 v[16:17], v72 offset:10240
    ds_read_b64_tr_b16 v[18:19], v72 offset:10752
    buffer_load_dwordx4 v50, s[44:47], s15 offen offset:2048 lds
    v_accvgpr_read_b32 v107, a214
    v_accvgpr_read_b32 v108, a222
    v_accvgpr_read_b32 v109, a215
    v_accvgpr_read_b32 v110, a223
    v_mul_f32 v107, v107, v108
    v_mul_f32 v109, v109, v110
    v_cvt_pk_bf16_f32 v123, v107, v109
    v_mfma_f32_32x32x16_bf16 v[224:239], v[20:23], v[112:115], v[224:239]
    ds_read_b64_tr_b16 v[20:21], v71 offset:26624
    ds_read_b64_tr_b16 v[22:23], v71 offset:27136
    v_accvgpr_read_b32 v103, a224
    v_accvgpr_read_b32 v104, a232
    v_accvgpr_read_b32 v105, a225
    v_accvgpr_read_b32 v106, a233
    v_mul_f32 v103, v103, v104
    v_mul_f32 v105, v105, v106
    v_cvt_pk_bf16_f32 v124, v103, v105
    s_waitcnt lgkmcnt(8)
    v_mfma_f32_32x32x16_bf16 v[192:207], v[0:3], v[116:119], v[192:207]
    ds_read_b64_tr_b16 v[0:1], v71 offset:12288
    ds_read_b64_tr_b16 v[2:3], v71 offset:12800
    v_accvgpr_read_b32 v107, a226
    v_accvgpr_read_b32 v108, a234
    v_accvgpr_read_b32 v109, a227
    v_accvgpr_read_b32 v110, a235
    v_mul_f32 v107, v107, v108
    v_mul_f32 v109, v109, v110
    v_cvt_pk_bf16_f32 v125, v107, v109
    v_mfma_f32_32x32x16_bf16 v[208:223], v[4:7], v[116:119], v[208:223]
    ds_read_b64_tr_b16 v[4:5], v72 offset:12288
    ds_read_b64_tr_b16 v[6:7], v72 offset:12800
    buffer_load_dwordx4 v51, s[44:47], s15 offen offset:3072 lds
    s_add_u32 s15, s15, 256
    v_accvgpr_read_b32 v103, a228
    v_accvgpr_read_b32 v104, a236
    v_accvgpr_read_b32 v105, a229
    v_accvgpr_read_b32 v106, a237
    v_mul_f32 v103, v103, v104
    v_mul_f32 v105, v105, v106
    v_cvt_pk_bf16_f32 v126, v103, v105
    s_waitcnt lgkmcnt(8)
    v_mfma_f32_32x32x16_bf16 v[224:239], v[8:11], v[116:119], v[224:239]
    ds_read_b64_tr_b16 v[8:9], v71 offset:28672
    ds_read_b64_tr_b16 v[10:11], v71 offset:29184
    v_accvgpr_read_b32 v107, a230
    v_accvgpr_read_b32 v108, a238
    v_accvgpr_read_b32 v109, a231
    v_accvgpr_read_b32 v110, a239
    v_mul_f32 v107, v107, v108
    v_mul_f32 v109, v109, v110
    v_cvt_pk_bf16_f32 v127, v107, v109
    v_mfma_f32_32x32x16_bf16 v[192:207], v[12:15], v[120:123], v[192:207]
    ds_read_b64_tr_b16 v[12:13], v72 offset:16384
    ds_read_b64_tr_b16 v[14:15], v72 offset:16896
    v_accvgpr_read_b32 v103, a0
    v_accvgpr_read_b32 v104, a1
    v_cvt_pk_bf16_f32 v128, v103, v104
    v_accvgpr_read_b32 v105, a2
    v_accvgpr_read_b32 v106, a3
    v_cvt_pk_bf16_f32 v129, v105, v106
    s_waitcnt lgkmcnt(8)
    v_mfma_f32_32x32x16_bf16 v[208:223], v[16:19], v[120:123], v[208:223]
    ds_read_b64_tr_b16 v[16:17], v72 offset:18432
    ds_read_b64_tr_b16 v[18:19], v72 offset:18944
    v_accvgpr_read_b32 v103, a4
    v_accvgpr_read_b32 v104, a5
    v_cvt_pk_bf16_f32 v130, v103, v104
    v_accvgpr_read_b32 v105, a6
    v_accvgpr_read_b32 v106, a7
    v_cvt_pk_bf16_f32 v131, v105, v106
    v_mfma_f32_32x32x16_bf16 v[224:239], v[20:23], v[120:123], v[224:239]
    ds_read_b64_tr_b16 v[20:21], v72 offset:20480
    ds_read_b64_tr_b16 v[22:23], v72 offset:20992
    v_accvgpr_read_b32 v103, a8
    v_accvgpr_read_b32 v104, a9
    v_cvt_pk_bf16_f32 v132, v103, v104
    v_accvgpr_read_b32 v105, a10
    v_accvgpr_read_b32 v106, a11
    v_cvt_pk_bf16_f32 v133, v105, v106
    s_waitcnt lgkmcnt(8)
    v_mfma_f32_32x32x16_bf16 v[192:207], v[0:3], v[124:127], v[192:207]
    ds_read_b64_tr_b16 v[0:1], v72 offset:22528
    ds_read_b64_tr_b16 v[2:3], v72 offset:23040
    v_accvgpr_read_b32 v103, a12
    v_accvgpr_read_b32 v104, a13
    v_cvt_pk_bf16_f32 v134, v103, v104
    v_accvgpr_read_b32 v105, a14
    v_accvgpr_read_b32 v106, a15
    v_cvt_pk_bf16_f32 v135, v105, v106
    v_mfma_f32_32x32x16_bf16 v[208:223], v[4:7], v[124:127], v[208:223]
    ds_read_b64_tr_b16 v[4:5], v72 offset:24576
    ds_read_b64_tr_b16 v[6:7], v72 offset:25088
    v_accvgpr_read_b32 v103, a16
    v_accvgpr_read_b32 v104, a17
    v_cvt_pk_bf16_f32 v136, v103, v104
    v_accvgpr_read_b32 v105, a18
    v_accvgpr_read_b32 v106, a19
    v_cvt_pk_bf16_f32 v137, v105, v106
    s_waitcnt lgkmcnt(8)
    v_mfma_f32_32x32x16_bf16 v[224:239], v[8:11], v[124:127], v[224:239]
    s_waitcnt vmcnt(16)
    s_barrier
    s_add_u32 m0, s60, 98304
    ds_read_b64_tr_b16 v[8:9], v72 offset:26624
    ds_read_b64_tr_b16 v[10:11], v72 offset:27136
    s_mov_b32 s75, s38
    s_cmp_lt_u32 s52, 2
    s_cselect_b32 s38, s75, 0
    buffer_load_dwordx4 v36, s[36:39], s58 offen offset:0 lds
    v_cvt_pk_bf16_f32 v192, v192, v193
    v_cvt_pk_bf16_f32 v193, v194, v195
    v_cvt_pk_bf16_f32 v194, v196, v197
    v_cvt_pk_bf16_f32 v195, v198, v199
    s_add_u32 s61, s69, 0
    buffer_store_dwordx4 v[192:195], v97, s[48:51], s61 offen offset:0 sc1
    v_cvt_pk_bf16_f32 v196, v200, v201
    v_mfma_f32_32x32x16_bf16 v[240:255], v[12:15], v[24:27], 0
    ds_read_b64_tr_b16 v[12:13], v72 offset:28672
    ds_read_b64_tr_b16 v[14:15], v72 offset:29184
    v_cvt_pk_bf16_f32 v197, v202, v203
    v_cvt_pk_bf16_f32 v198, v204, v205
    v_cvt_pk_bf16_f32 v199, v206, v207
    s_add_u32 s61, s69, 0
    buffer_store_dwordx4 v[196:199], v97, s[48:51], s61 offen offset:1024 sc1
    v_cvt_pk_bf16_f32 v208, v208, v209
    v_cvt_pk_bf16_f32 v209, v210, v211
    s_waitcnt lgkmcnt(8)
    v_mfma_f32_32x32x16_bf16 v[240:255], v[16:19], v[28:31], v[240:255]
    ds_read_b64_tr_b16 v[16:17], v67 offset:0
    ds_read_b64_tr_b16 v[18:19], v67 offset:512
    v_cvt_pk_bf16_f32 v210, v212, v213
    v_cvt_pk_bf16_f32 v211, v214, v215
    s_add_u32 s61, s69, 0
    buffer_store_dwordx4 v[208:211], v97, s[48:51], s61 offen offset:2048 sc1
    v_cvt_pk_bf16_f32 v212, v216, v217
    v_cvt_pk_bf16_f32 v213, v218, v219
    v_cvt_pk_bf16_f32 v214, v220, v221
    v_mfma_f32_32x32x16_bf16 v[240:255], v[20:23], v[32:35], v[240:255]
    ds_read_b64_tr_b16 v[20:21], v67 offset:2048
    ds_read_b64_tr_b16 v[22:23], v67 offset:2560
    buffer_load_dwordx4 v37, s[36:39], s58 offen offset:1024 lds
    v_cvt_pk_bf16_f32 v215, v222, v223
    s_add_u32 s61, s69, 0
    buffer_store_dwordx4 v[212:215], v97, s[48:51], s61 offen offset:3072 sc1
    v_cvt_pk_bf16_f32 v224, v224, v225
    v_cvt_pk_bf16_f32 v225, v226, v227
    v_cvt_pk_bf16_f32 v226, v228, v229
    v_cvt_pk_bf16_f32 v227, v230, v231
    s_waitcnt lgkmcnt(8)
    v_mfma_f32_32x32x16_bf16 v[240:255], v[0:3], v[112:115], v[240:255]
    ds_read_b64_tr_b16 v[0:1], v67 offset:4096
    ds_read_b64_tr_b16 v[2:3], v67 offset:4608
    s_add_u32 s61, s69, 4096
    buffer_store_dwordx4 v[224:227], v97, s[48:51], s61 offen offset:0 sc1
    v_cvt_pk_bf16_f32 v228, v232, v233
    v_cvt_pk_bf16_f32 v229, v234, v235
    v_cvt_pk_bf16_f32 v230, v236, v237
    v_cvt_pk_bf16_f32 v231, v238, v239
    s_add_u32 s61, s69, 4096
    buffer_store_dwordx4 v[228:231], v97, s[48:51], s61 offen offset:1024 sc1
    v_mfma_f32_32x32x16_bf16 v[240:255], v[4:7], v[116:119], v[240:255]
    ds_read_b64_tr_b16 v[4:5], v67 offset:6144
    ds_read_b64_tr_b16 v[6:7], v67 offset:6656
    v_accvgpr_read_b32 v103, a20
    v_accvgpr_read_b32 v104, a21
    v_cvt_pk_bf16_f32 v138, v103, v104
    v_accvgpr_read_b32 v105, a22
    v_accvgpr_read_b32 v106, a23
    v_cvt_pk_bf16_f32 v139, v105, v106
    s_waitcnt lgkmcnt(8)
    v_mfma_f32_32x32x16_bf16 v[240:255], v[8:11], v[120:123], v[240:255]
    ds_read_b64_tr_b16 v[8:9], v67 offset:8192
    ds_read_b64_tr_b16 v[10:11], v67 offset:8704
    buffer_load_dwordx4 v38, s[36:39], s58 offen offset:2048 lds
    v_accvgpr_read_b32 v103, a24
    v_accvgpr_read_b32 v104, a25
    v_cvt_pk_bf16_f32 v140, v103, v104
    v_accvgpr_read_b32 v105, a26
    v_accvgpr_read_b32 v106, a27
    v_cvt_pk_bf16_f32 v141, v105, v106
    v_mfma_f32_32x32x16_bf16 v[240:255], v[12:15], v[124:127], v[240:255]
    ds_read_b64_tr_b16 v[12:13], v67 offset:10240
    ds_read_b64_tr_b16 v[14:15], v67 offset:10752
    v_accvgpr_read_b32 v103, a28
    v_accvgpr_read_b32 v104, a29
    v_cvt_pk_bf16_f32 v142, v103, v104
    v_accvgpr_read_b32 v105, a30
    v_accvgpr_read_b32 v106, a31
    v_cvt_pk_bf16_f32 v143, v105, v106
    s_waitcnt lgkmcnt(8)
    v_mfma_f32_32x32x16_bf16 v[192:207], v[16:19], v[24:27], 0
    ds_read_b64_tr_b16 v[16:17], v67 offset:12288
    ds_read_b64_tr_b16 v[18:19], v67 offset:12800
    v_accvgpr_read_b32 v103, a32
    v_accvgpr_read_b32 v104, a33
    v_cvt_pk_bf16_f32 v144, v103, v104
    v_accvgpr_read_b32 v105, a34
    v_accvgpr_read_b32 v106, a35
    v_cvt_pk_bf16_f32 v145, v105, v106
    v_mfma_f32_32x32x16_bf16 v[192:207], v[20:23], v[28:31], v[192:207]
    ds_read_b64_tr_b16 v[20:21], v68 offset:0
    ds_read_b64_tr_b16 v[22:23], v68 offset:512
    buffer_load_dwordx4 v39, s[36:39], s58 offen offset:3072 lds
    v_cvt_pk_bf16_f32 v107, v240, v241
    v_cvt_pk_bf16_f32 v108, v242, v243
    v_accvgpr_write_b32 a128, v107
    v_accvgpr_write_b32 a129, v108
    v_cvt_pk_bf16_f32 v109, v244, v245
    v_cvt_pk_bf16_f32 v110, v246, v247
    s_waitcnt lgkmcnt(8)
    v_mfma_f32_32x32x16_bf16 v[192:207], v[0:3], v[32:35], v[192:207]
    ds_read_b64_tr_b16 v[0:1], v68 offset:2048
    ds_read_b64_tr_b16 v[2:3], v68 offset:2560
    v_accvgpr_write_b32 a130, v109
    v_accvgpr_write_b32 a131, v110
    v_cvt_pk_bf16_f32 v107, v248, v249
    v_cvt_pk_bf16_f32 v108, v250, v251
    v_accvgpr_write_b32 a132, v107
    v_accvgpr_write_b32 a133, v108
    v_mfma_f32_32x32x16_bf16 v[192:207], v[4:7], v[112:115], v[192:207]
    ds_read_b64_tr_b16 v[4:5], v68 offset:4096
    ds_read_b64_tr_b16 v[6:7], v68 offset:4608
    v_cvt_pk_bf16_f32 v109, v252, v253
    v_cvt_pk_bf16_f32 v110, v254, v255
    v_accvgpr_write_b32 a134, v109
    v_accvgpr_write_b32 a135, v110
    v_accvgpr_read_b32 v103, a36
    v_accvgpr_read_b32 v104, a37
    s_waitcnt lgkmcnt(8)
    v_mfma_f32_32x32x16_bf16 v[192:207], v[8:11], v[116:119], v[192:207]
    s_add_u32 m0, s60, 102400
    ds_read_b64_tr_b16 v[8:9], v68 offset:6144
    ds_read_b64_tr_b16 v[10:11], v68 offset:6656
    buffer_load_dwordx4 v40, s[36:39], s58 offen offset:0 lds
    v_cvt_pk_bf16_f32 v146, v103, v104
    v_accvgpr_read_b32 v105, a38
    v_accvgpr_read_b32 v106, a39
    v_cvt_pk_bf16_f32 v147, v105, v106
    v_accvgpr_read_b32 v103, a40
    v_accvgpr_read_b32 v104, a41
    v_mfma_f32_32x32x16_bf16 v[192:207], v[12:15], v[120:123], v[192:207]
    ds_read_b64_tr_b16 v[12:13], v68 offset:8192
    ds_read_b64_tr_b16 v[14:15], v68 offset:8704
    v_cvt_pk_bf16_f32 v148, v103, v104
    v_accvgpr_read_b32 v105, a42
    v_accvgpr_read_b32 v106, a43
    v_cvt_pk_bf16_f32 v149, v105, v106
    v_accvgpr_read_b32 v103, a44
    v_accvgpr_read_b32 v104, a45
    s_waitcnt lgkmcnt(8)
    v_mfma_f32_32x32x16_bf16 v[192:207], v[16:19], v[124:127], v[192:207]
    ds_read_b64_tr_b16 v[16:17], v68 offset:10240
    ds_read_b64_tr_b16 v[18:19], v68 offset:10752
    v_cvt_pk_bf16_f32 v150, v103, v104
    v_accvgpr_read_b32 v105, a46
    v_accvgpr_read_b32 v106, a47
    v_cvt_pk_bf16_f32 v151, v105, v106
    v_accvgpr_read_b32 v103, a48
    v_accvgpr_read_b32 v104, a49
    v_mfma_f32_32x32x16_bf16 v[208:223], v[20:23], v[24:27], 0
    ds_read_b64_tr_b16 v[20:21], v68 offset:12288
    ds_read_b64_tr_b16 v[22:23], v68 offset:12800
    buffer_load_dwordx4 v41, s[36:39], s58 offen offset:1024 lds
    v_cvt_pk_bf16_f32 v152, v103, v104
    v_accvgpr_read_b32 v105, a50
    v_accvgpr_read_b32 v106, a51
    v_cvt_pk_bf16_f32 v153, v105, v106
    v_accvgpr_read_b32 v103, a52
    v_accvgpr_read_b32 v104, a53
    s_waitcnt lgkmcnt(8)
    v_mfma_f32_32x32x16_bf16 v[208:223], v[0:3], v[28:31], v[208:223]
    ds_read_b64_tr_b16 v[0:1], v67 offset:16384
    ds_read_b64_tr_b16 v[2:3], v67 offset:16896
    v_cvt_pk_bf16_f32 v107, v192, v193
    v_cvt_pk_bf16_f32 v108, v194, v195
    v_accvgpr_write_b32 a136, v107
    v_accvgpr_write_b32 a137, v108
    v_cvt_pk_bf16_f32 v109, v196, v197
    v_cvt_pk_bf16_f32 v110, v198, v199
    v_mfma_f32_32x32x16_bf16 v[208:223], v[4:7], v[32:35], v[208:223]
    ds_read_b64_tr_b16 v[4:5], v67 offset:18432
    ds_read_b64_tr_b16 v[6:7], v67 offset:18944
    v_accvgpr_write_b32 a138, v109
    v_accvgpr_write_b32 a139, v110
    v_cvt_pk_bf16_f32 v107, v200, v201
    v_cvt_pk_bf16_f32 v108, v202, v203
    v_accvgpr_write_b32 a140, v107
    v_accvgpr_write_b32 a141, v108
    s_waitcnt lgkmcnt(8)
    v_mfma_f32_32x32x16_bf16 v[208:223], v[8:11], v[112:115], v[208:223]
    ds_read_b64_tr_b16 v[8:9], v67 offset:20480
    ds_read_b64_tr_b16 v[10:11], v67 offset:20992
    buffer_load_dwordx4 v42, s[36:39], s58 offen offset:2048 lds
    v_cvt_pk_bf16_f32 v109, v204, v205
    v_cvt_pk_bf16_f32 v110, v206, v207
    v_accvgpr_write_b32 a142, v109
    v_accvgpr_write_b32 a143, v110
    v_cvt_pk_bf16_f32 v154, v103, v104
    v_accvgpr_read_b32 v105, a54
    v_mfma_f32_32x32x16_bf16 v[208:223], v[12:15], v[116:119], v[208:223]
    ds_read_b64_tr_b16 v[12:13], v67 offset:22528
    ds_read_b64_tr_b16 v[14:15], v67 offset:23040
    v_accvgpr_read_b32 v106, a55
    v_cvt_pk_bf16_f32 v155, v105, v106
    v_accvgpr_read_b32 v103, a56
    v_accvgpr_read_b32 v104, a57
    v_cvt_pk_bf16_f32 v156, v103, v104
    v_accvgpr_read_b32 v105, a58
    s_waitcnt lgkmcnt(8)
    v_mfma_f32_32x32x16_bf16 v[208:223], v[16:19], v[120:123], v[208:223]
    ds_read_b64_tr_b16 v[16:17], v67 offset:24576
    ds_read_b64_tr_b16 v[18:19], v67 offset:25088
    v_accvgpr_read_b32 v106, a59
    v_cvt_pk_bf16_f32 v157, v105, v106
    v_accvgpr_read_b32 v103, a60
    v_accvgpr_read_b32 v104, a61
    v_cvt_pk_bf16_f32 v158, v103, v104
    v_accvgpr_read_b32 v105, a62
    v_mfma_f32_32x32x16_bf16 v[208:223], v[20:23], v[124:127], v[208:223]
    ds_read_b64_tr_b16 v[20:21], v67 offset:26624
    ds_read_b64_tr_b16 v[22:23], v67 offset:27136
    buffer_load_dwordx4 v43, s[36:39], s58 offen offset:3072 lds
    s_mov_b32 s38, s75
    s_add_u32 s58, s58, 0x4000
    v_accvgpr_read_b32 v106, a63
    v_cvt_pk_bf16_f32 v159, v105, v106
    v_accvgpr_read_b32 v103, a64
    v_accvgpr_read_b32 v104, a65
    v_cvt_pk_bf16_f32 v160, v103, v104
    v_accvgpr_read_b32 v105, a66
    s_waitcnt lgkmcnt(8)
    v_mfma_f32_32x32x16_bf16 v[224:239], v[0:3], v[24:27], 0
    ds_read_b64_tr_b16 v[0:1], v67 offset:28672
    ds_read_b64_tr_b16 v[2:3], v67 offset:29184
    v_accvgpr_read_b32 v106, a67
    v_cvt_pk_bf16_f32 v161, v105, v106
    v_accvgpr_read_b32 v103, a68
    v_accvgpr_read_b32 v104, a69
    v_cvt_pk_bf16_f32 v162, v103, v104
    v_accvgpr_read_b32 v105, a70
    v_mfma_f32_32x32x16_bf16 v[224:239], v[4:7], v[28:31], v[224:239]
    ds_read_b64_tr_b16 v[4:5], v68 offset:16384
    ds_read_b64_tr_b16 v[6:7], v68 offset:16896
    v_cvt_pk_bf16_f32 v208, v208, v209
    v_cvt_pk_bf16_f32 v209, v210, v211
    v_cvt_pk_bf16_f32 v210, v212, v213
    v_cvt_pk_bf16_f32 v211, v214, v215
    s_add_u32 s61, s69, 8192
    buffer_store_dwordx4 v[208:211], v97, s[48:51], s61 offen offset:2048 sc1
    v_cvt_pk_bf16_f32 v212, v216, v217
    s_waitcnt lgkmcnt(8)
    v_mfma_f32_32x32x16_bf16 v[224:239], v[8:11], v[32:35], v[224:239]
    ds_read_b64_tr_b16 v[8:9], v68 offset:18432
    ds_read_b64_tr_b16 v[10:11], v68 offset:18944
    v_cvt_pk_bf16_f32 v213, v218, v219
    v_cvt_pk_bf16_f32 v214, v220, v221
    v_cvt_pk_bf16_f32 v215, v222, v223
    s_add_u32 s61, s69, 8192
    buffer_store_dwordx4 v[212:215], v97, s[48:51], s61 offen offset:3072 sc1
    v_accvgpr_read_b32 v106, a71
    v_cvt_pk_bf16_f32 v163, v105, v106
    v_mfma_f32_32x32x16_bf16 v[224:239], v[12:15], v[112:115], v[224:239]
    ds_read_b64_tr_b16 v[12:13], v68 offset:20480
    ds_read_b64_tr_b16 v[14:15], v68 offset:20992
    v_accvgpr_read_b32 v103, a72
    v_accvgpr_read_b32 v104, a73
    v_cvt_pk_bf16_f32 v164, v103, v104
    v_accvgpr_read_b32 v105, a74
    v_accvgpr_read_b32 v106, a75
    v_cvt_pk_bf16_f32 v165, v105, v106
    s_waitcnt lgkmcnt(8)
    v_mfma_f32_32x32x16_bf16 v[224:239], v[16:19], v[116:119], v[224:239]
    ds_read_b64_tr_b16 v[16:17], v68 offset:22528
    ds_read_b64_tr_b16 v[18:19], v68 offset:23040
    v_accvgpr_read_b32 v103, a76
    v_accvgpr_read_b32 v104, a77
    v_cvt_pk_bf16_f32 v166, v103, v104
    v_accvgpr_read_b32 v105, a78
    v_accvgpr_read_b32 v106, a79
    v_cvt_pk_bf16_f32 v167, v105, v106
    v_mfma_f32_32x32x16_bf16 v[224:239], v[20:23], v[120:123], v[224:239]
    ds_read_b64_tr_b16 v[20:21], v68 offset:24576
    ds_read_b64_tr_b16 v[22:23], v68 offset:25088
    v_accvgpr_read_b32 v103, a80
    v_accvgpr_read_b32 v104, a81
    v_cvt_pk_bf16_f32 v168, v103, v104
    v_accvgpr_read_b32 v105, a82
    v_accvgpr_read_b32 v106, a83
    v_cvt_pk_bf16_f32 v169, v105, v106
    s_waitcnt lgkmcnt(8)
    v_mfma_f32_32x32x16_bf16 v[224:239], v[0:3], v[124:127], v[224:239]
    s_waitcnt vmcnt(24)
    s_barrier
    s_add_u32 m0, s60, 131072
    ds_read_b64_tr_b16 v[0:1], v68 offset:26624
    ds_read_b64_tr_b16 v[2:3], v68 offset:27136
    buffer_load_dwordx4 v36, s[36:39], s58 offen offset:0 lds
    v_accvgpr_read_b32 v103, a84
    v_accvgpr_read_b32 v104, a85
    v_cvt_pk_bf16_f32 v170, v103, v104
    v_accvgpr_read_b32 v105, a86
    v_accvgpr_read_b32 v106, a87
    v_cvt_pk_bf16_f32 v171, v105, v106
    v_mfma_f32_32x32x16_bf16 v[240:255], v[4:7], v[24:27], 0
    ds_read_b64_tr_b16 v[4:5], v68 offset:28672
    ds_read_b64_tr_b16 v[6:7], v68 offset:29184
    v_accvgpr_read_b32 v103, a88
    v_accvgpr_read_b32 v104, a89
    v_cvt_pk_bf16_f32 v172, v103, v104
    v_accvgpr_read_b32 v105, a90
    v_accvgpr_read_b32 v106, a91
    v_cvt_pk_bf16_f32 v173, v105, v106
    s_waitcnt lgkmcnt(8)
    v_mfma_f32_32x32x16_bf16 v[240:255], v[8:11], v[28:31], v[240:255]
    ds_read_b64_tr_b16 v[8:9], v67 offset:32768
    ds_read_b64_tr_b16 v[10:11], v67 offset:33280
    v_cvt_pk_bf16_f32 v107, v224, v225
    v_cvt_pk_bf16_f32 v108, v226, v227
    v_accvgpr_write_b32 a144, v107
    v_accvgpr_write_b32 a145, v108
    v_cvt_pk_bf16_f32 v109, v228, v229
    v_cvt_pk_bf16_f32 v110, v230, v231
    v_mfma_f32_32x32x16_bf16 v[240:255], v[12:15], v[32:35], v[240:255]
    ds_read_b64_tr_b16 v[12:13], v67 offset:34816
    ds_read_b64_tr_b16 v[14:15], v67 offset:35328
    buffer_load_dwordx4 v37, s[36:39], s58 offen offset:1024 lds
    v_accvgpr_write_b32 a146, v109
    v_accvgpr_write_b32 a147, v110
    v_cvt_pk_bf16_f32 v107, v232, v233
    v_cvt_pk_bf16_f32 v108, v234, v235
    v_accvgpr_write_b32 a148, v107
    v_accvgpr_write_b32 a149, v108
    s_waitcnt lgkmcnt(8)
    v_mfma_f32_32x32x16_bf16 v[240:255], v[16:19], v[112:115], v[240:255]
    ds_read_b64_tr_b16 v[16:17], v67 offset:36864
    ds_read_b64_tr_b16 v[18:19], v67 offset:37376
    v_cvt_pk_bf16_f32 v109, v236, v237
    v_cvt_pk_bf16_f32 v110, v238, v239
    v_accvgpr_write_b32 a150, v109
    v_accvgpr_write_b32 a151, v110
    v_accvgpr_read_b32 v103, a92
    v_accvgpr_read_b32 v104, a93
    v_mfma_f32_32x32x16_bf16 v[240:255], v[20:23], v[116:119], v[240:255]
    ds_read_b64_tr_b16 v[20:21], v67 offset:38912
    ds_read_b64_tr_b16 v[22:23], v67 offset:39424
    v_cvt_pk_bf16_f32 v174, v103, v104
    v_accvgpr_read_b32 v105, a94
    v_accvgpr_read_b32 v106, a95
    v_cvt_pk_bf16_f32 v175, v105, v106
    v_accvgpr_read_b32 v103, a96
    v_accvgpr_read_b32 v104, a97
    s_waitcnt lgkmcnt(8)
    v_mfma_f32_32x32x16_bf16 v[240:255], v[0:3], v[120:123], v[240:255]
    ds_read_b64_tr_b16 v[0:1], v67 offset:40960
    ds_read_b64_tr_b16 v[2:3], v67 offset:41472
    buffer_load_dwordx4 v38, s[36:39], s58 offen offset:2048 lds
    v_cvt_pk_bf16_f32 v176, v103, v104
    v_accvgpr_read_b32 v105, a98
    v_accvgpr_read_b32 v106, a99
    v_cvt_pk_bf16_f32 v177, v105, v106
    v_accvgpr_read_b32 v103, a100
    v_accvgpr_read_b32 v104, a101
    v_mfma_f32_32x32x16_bf16 v[240:255], v[4:7], v[124:127], v[240:255]
    ds_read_b64_tr_b16 v[4:5], v67 offset:43008
    ds_read_b64_tr_b16 v[6:7], v67 offset:43520
    v_cvt_pk_bf16_f32 v178, v103, v104
    v_accvgpr_read_b32 v105, a102
    v_accvgpr_read_b32 v106, a103
    v_cvt_pk_bf16_f32 v179, v105, v106
    v_accvgpr_read_b32 v103, a104
    v_accvgpr_read_b32 v104, a105
    s_waitcnt lgkmcnt(8)
    v_mfma_f32_32x32x16_bf16 v[192:207], v[8:11], v[24:27], 0
    ds_read_b64_tr_b16 v[8:9], v67 offset:45056
    ds_read_b64_tr_b16 v[10:11], v67 offset:45568
    v_cvt_pk_bf16_f32 v180, v103, v104
    v_accvgpr_read_b32 v105, a106
    v_accvgpr_read_b32 v106, a107
    v_cvt_pk_bf16_f32 v181, v105, v106
    v_accvgpr_read_b32 v103, a108
    v_accvgpr_read_b32 v104, a109
    v_mfma_f32_32x32x16_bf16 v[192:207], v[12:15], v[28:31], v[192:207]
    ds_read_b64_tr_b16 v[12:13], v68 offset:32768
    ds_read_b64_tr_b16 v[14:15], v68 offset:33280
    buffer_load_dwordx4 v39, s[36:39], s58 offen offset:3072 lds
    v_cvt_pk_bf16_f32 v107, v240, v241
    v_cvt_pk_bf16_f32 v108, v242, v243
    v_accvgpr_write_b32 a152, v107
    v_accvgpr_write_b32 a153, v108
    v_cvt_pk_bf16_f32 v109, v244, v245
    v_cvt_pk_bf16_f32 v110, v246, v247
    s_waitcnt lgkmcnt(8)
    v_mfma_f32_32x32x16_bf16 v[192:207], v[16:19], v[32:35], v[192:207]
    ds_read_b64_tr_b16 v[16:17], v68 offset:34816
    ds_read_b64_tr_b16 v[18:19], v68 offset:35328
    v_accvgpr_write_b32 a154, v109
    v_accvgpr_write_b32 a155, v110
    v_cvt_pk_bf16_f32 v107, v248, v249
    v_cvt_pk_bf16_f32 v108, v250, v251
    v_accvgpr_write_b32 a156, v107
    v_accvgpr_write_b32 a157, v108
    v_mfma_f32_32x32x16_bf16 v[192:207], v[20:23], v[112:115], v[192:207]
    ds_read_b64_tr_b16 v[20:21], v68 offset:36864
    ds_read_b64_tr_b16 v[22:23], v68 offset:37376
    v_cvt_pk_bf16_f32 v109, v252, v253
    v_cvt_pk_bf16_f32 v110, v254, v255
    v_accvgpr_write_b32 a158, v109
    v_accvgpr_write_b32 a159, v110
    v_cvt_pk_bf16_f32 v182, v103, v104
    v_accvgpr_read_b32 v105, a110
    s_waitcnt lgkmcnt(8)
    v_mfma_f32_32x32x16_bf16 v[192:207], v[0:3], v[116:119], v[192:207]
    s_add_u32 m0, s60, 135168
    ds_read_b64_tr_b16 v[0:1], v68 offset:38912
    ds_read_b64_tr_b16 v[2:3], v68 offset:39424
    buffer_load_dwordx4 v40, s[36:39], s58 offen offset:0 lds
    v_accvgpr_read_b32 v106, a111
    v_cvt_pk_bf16_f32 v183, v105, v106
    v_accvgpr_read_b32 v103, a112
    v_accvgpr_read_b32 v104, a113
    v_cvt_pk_bf16_f32 v184, v103, v104
    v_accvgpr_read_b32 v105, a114
    v_mfma_f32_32x32x16_bf16 v[192:207], v[4:7], v[120:123], v[192:207]
    ds_read_b64_tr_b16 v[4:5], v68 offset:40960
    ds_read_b64_tr_b16 v[6:7], v68 offset:41472
    v_accvgpr_read_b32 v106, a115
    v_cvt_pk_bf16_f32 v185, v105, v106
    v_accvgpr_read_b32 v103, a116
    v_accvgpr_read_b32 v104, a117
    v_cvt_pk_bf16_f32 v186, v103, v104
    v_accvgpr_read_b32 v105, a118
    s_waitcnt lgkmcnt(8)
    v_mfma_f32_32x32x16_bf16 v[192:207], v[8:11], v[124:127], v[192:207]
    ds_read_b64_tr_b16 v[8:9], v68 offset:43008
    ds_read_b64_tr_b16 v[10:11], v68 offset:43520
    v_accvgpr_read_b32 v106, a119
    v_cvt_pk_bf16_f32 v187, v105, v106
    v_accvgpr_read_b32 v103, a120
    v_accvgpr_read_b32 v104, a121
    v_cvt_pk_bf16_f32 v188, v103, v104
    v_accvgpr_read_b32 v105, a122
    v_mfma_f32_32x32x16_bf16 v[208:223], v[12:15], v[24:27], 0
    ds_read_b64_tr_b16 v[12:13], v68 offset:45056
    ds_read_b64_tr_b16 v[14:15], v68 offset:45568
    buffer_load_dwordx4 v41, s[36:39], s58 offen offset:1024 lds
    v_accvgpr_read_b32 v106, a123
    v_cvt_pk_bf16_f32 v189, v105, v106
    v_accvgpr_read_b32 v103, a124
    v_accvgpr_read_b32 v104, a125
    v_cvt_pk_bf16_f32 v190, v103, v104
    v_accvgpr_read_b32 v105, a126
    s_waitcnt lgkmcnt(8)
    v_mfma_f32_32x32x16_bf16 v[208:223], v[16:19], v[28:31], v[208:223]
    ds_read_b64_tr_b16 v[16:17], v67 offset:49152
    ds_read_b64_tr_b16 v[18:19], v67 offset:49664
    v_cvt_pk_bf16_f32 v192, v192, v193
    v_cvt_pk_bf16_f32 v193, v194, v195
    v_cvt_pk_bf16_f32 v194, v196, v197
    v_cvt_pk_bf16_f32 v195, v198, v199
    s_add_u32 s61, s69, 16384
    buffer_store_dwordx4 v[192:195], v97, s[48:51], s61 offen offset:0 sc1
    v_cvt_pk_bf16_f32 v196, v200, v201
    v_mfma_f32_32x32x16_bf16 v[208:223], v[20:23], v[32:35], v[208:223]
    ds_read_b64_tr_b16 v[20:21], v67 offset:51200
    ds_read_b64_tr_b16 v[22:23], v67 offset:51712
    v_cvt_pk_bf16_f32 v197, v202, v203
    v_cvt_pk_bf16_f32 v198, v204, v205
    v_cvt_pk_bf16_f32 v199, v206, v207
    s_add_u32 s61, s69, 16384
    buffer_store_dwordx4 v[196:199], v97, s[48:51], s61 offen offset:1024 sc1
    v_accvgpr_read_b32 v106, a127
    v_cvt_pk_bf16_f32 v191, v105, v106
    s_waitcnt lgkmcnt(8)
    v_mfma_f32_32x32x16_bf16 v[208:223], v[0:3], v[112:115], v[208:223]
    ds_read_b64_tr_b16 v[0:1], v67 offset:53248
    ds_read_b64_tr_b16 v[2:3], v67 offset:53760
    buffer_load_dwordx4 v42, s[36:39], s58 offen offset:2048 lds
    v_mfma_f32_32x32x16_bf16 v[208:223], v[4:7], v[116:119], v[208:223]
    ds_read_b64_tr_b16 v[4:5], v67 offset:55296
    ds_read_b64_tr_b16 v[6:7], v67 offset:55808
    s_waitcnt lgkmcnt(8)
    v_mfma_f32_32x32x16_bf16 v[208:223], v[8:11], v[120:123], v[208:223]
    ds_read_b64_tr_b16 v[8:9], v67 offset:57344
    ds_read_b64_tr_b16 v[10:11], v67 offset:57856
    v_mfma_f32_32x32x16_bf16 v[208:223], v[12:15], v[124:127], v[208:223]
    ds_read_b64_tr_b16 v[12:13], v67 offset:59392
    ds_read_b64_tr_b16 v[14:15], v67 offset:59904
    buffer_load_dwordx4 v43, s[36:39], s58 offen offset:3072 lds
    s_add_u32 s58, s58, 0x4000
    s_waitcnt lgkmcnt(8)
    v_mfma_f32_32x32x16_bf16 v[224:239], v[16:19], v[24:27], 0
    ds_read_b64_tr_b16 v[16:17], v67 offset:61440
    ds_read_b64_tr_b16 v[18:19], v67 offset:61952
    v_mfma_f32_32x32x16_bf16 v[224:239], v[20:23], v[28:31], v[224:239]
    ds_read_b64_tr_b16 v[20:21], v68 offset:49152
    ds_read_b64_tr_b16 v[22:23], v68 offset:49664
    s_nop 0
    v_cvt_pk_bf16_f32 v107, v208, v209
    v_cvt_pk_bf16_f32 v108, v210, v211
    v_accvgpr_write_b32 a160, v107
    v_accvgpr_write_b32 a161, v108
    v_cvt_pk_bf16_f32 v109, v212, v213
    v_cvt_pk_bf16_f32 v110, v214, v215
    s_waitcnt lgkmcnt(8)
    v_mfma_f32_32x32x16_bf16 v[224:239], v[0:3], v[32:35], v[224:239]
    ds_read_b64_tr_b16 v[0:1], v68 offset:51200
    ds_read_b64_tr_b16 v[2:3], v68 offset:51712
    v_accvgpr_write_b32 a162, v109
    v_accvgpr_write_b32 a163, v110
    v_cvt_pk_bf16_f32 v107, v216, v217
    v_cvt_pk_bf16_f32 v108, v218, v219
    v_accvgpr_write_b32 a164, v107
    v_accvgpr_write_b32 a165, v108
    v_mfma_f32_32x32x16_bf16 v[224:239], v[4:7], v[112:115], v[224:239]
    ds_read_b64_tr_b16 v[4:5], v68 offset:53248
    ds_read_b64_tr_b16 v[6:7], v68 offset:53760
    v_cvt_pk_bf16_f32 v109, v220, v221
    v_cvt_pk_bf16_f32 v110, v222, v223
    v_accvgpr_write_b32 a166, v109
    v_accvgpr_write_b32 a167, v110
    s_waitcnt lgkmcnt(8)
    v_mfma_f32_32x32x16_bf16 v[224:239], v[8:11], v[116:119], v[224:239]
    ds_read_b64_tr_b16 v[8:9], v68 offset:55296
    ds_read_b64_tr_b16 v[10:11], v68 offset:55808
    v_mfma_f32_32x32x16_bf16 v[224:239], v[12:15], v[120:123], v[224:239]
    ds_read_b64_tr_b16 v[12:13], v68 offset:57344
    ds_read_b64_tr_b16 v[14:15], v68 offset:57856
    s_waitcnt lgkmcnt(8)
    v_mfma_f32_32x32x16_bf16 v[224:239], v[16:19], v[124:127], v[224:239]
    s_waitcnt vmcnt(26)
    s_barrier
    s_add_u32 m0, s60, 0
    ds_read_b64_tr_b16 v[16:17], v68 offset:59392
    ds_read_b64_tr_b16 v[18:19], v68 offset:59904
    buffer_load_dwordx4 v36, s[36:39], s58 offen offset:0 lds
    v_mfma_f32_32x32x16_bf16 v[240:255], v[20:23], v[24:27], 0
    ds_read_b64_tr_b16 v[20:21], v68 offset:61440
    ds_read_b64_tr_b16 v[22:23], v68 offset:61952
    s_waitcnt lgkmcnt(8)
    v_mfma_f32_32x32x16_bf16 v[240:255], v[0:3], v[28:31], v[240:255]
    ds_read_b64_tr_b16 v[0:1], v69 offset:0
    ds_read_b64_tr_b16 v[2:3], v69 offset:512
    v_cvt_pk_bf16_f32 v107, v224, v225
    v_cvt_pk_bf16_f32 v108, v226, v227
    v_accvgpr_write_b32 a168, v107
    v_accvgpr_write_b32 a169, v108
    v_cvt_pk_bf16_f32 v109, v228, v229
    v_cvt_pk_bf16_f32 v110, v230, v231
    v_mfma_f32_32x32x16_bf16 v[240:255], v[4:7], v[32:35], v[240:255]
    ds_read_b64_tr_b16 v[4:5], v69 offset:2048
    ds_read_b64_tr_b16 v[6:7], v69 offset:2560
    buffer_load_dwordx4 v37, s[36:39], s58 offen offset:1024 lds
    v_accvgpr_write_b32 a170, v109
    v_accvgpr_write_b32 a171, v110
    v_cvt_pk_bf16_f32 v107, v232, v233
    v_cvt_pk_bf16_f32 v108, v234, v235
    v_accvgpr_write_b32 a172, v107
    v_accvgpr_write_b32 a173, v108
    s_waitcnt lgkmcnt(8)
    v_mfma_f32_32x32x16_bf16 v[240:255], v[8:11], v[112:115], v[240:255]
    ds_read_b64_tr_b16 v[8:9], v69 offset:4096
    ds_read_b64_tr_b16 v[10:11], v69 offset:4608
    v_cvt_pk_bf16_f32 v109, v236, v237
    v_cvt_pk_bf16_f32 v110, v238, v239
    v_accvgpr_write_b32 a174, v109
    v_accvgpr_write_b32 a175, v110
    v_mfma_f32_32x32x16_bf16 v[240:255], v[12:15], v[116:119], v[240:255]
    ds_read_b64_tr_b16 v[12:13], v69 offset:6144
    ds_read_b64_tr_b16 v[14:15], v69 offset:6656
    s_waitcnt lgkmcnt(8)
    v_mfma_f32_32x32x16_bf16 v[240:255], v[16:19], v[120:123], v[240:255]
    ds_read_b64_tr_b16 v[16:17], v69 offset:8192
    ds_read_b64_tr_b16 v[18:19], v69 offset:8704
    buffer_load_dwordx4 v38, s[36:39], s58 offen offset:2048 lds
    v_mfma_f32_32x32x16_bf16 v[240:255], v[20:23], v[124:127], v[240:255]
    ds_read_b64_tr_b16 v[20:21], v69 offset:10240
    ds_read_b64_tr_b16 v[22:23], v69 offset:10752
    s_waitcnt lgkmcnt(8)
    v_mfma_f32_32x32x16_bf16 v[192:207], v[0:3], v[24:27], 0
    ds_read_b64_tr_b16 v[0:1], v69 offset:12288
    ds_read_b64_tr_b16 v[2:3], v69 offset:12800
    v_mfma_f32_32x32x16_bf16 v[192:207], v[4:7], v[28:31], v[192:207]
    ds_read_b64_tr_b16 v[4:5], v70 offset:0
    ds_read_b64_tr_b16 v[6:7], v70 offset:512
    buffer_load_dwordx4 v39, s[36:39], s58 offen offset:3072 lds
    s_nop 1
    v_cvt_pk_bf16_f32 v240, v240, v241
    v_cvt_pk_bf16_f32 v241, v242, v243
    v_cvt_pk_bf16_f32 v242, v244, v245
    v_cvt_pk_bf16_f32 v243, v246, v247
    s_add_u32 s61, s69, 20480
    buffer_store_dwordx4 v[240:243], v97, s[48:51], s61 offen offset:2048 sc1
    v_cvt_pk_bf16_f32 v244, v248, v249
    s_waitcnt lgkmcnt(8)
    v_mfma_f32_32x32x16_bf16 v[192:207], v[8:11], v[32:35], v[192:207]
    ds_read_b64_tr_b16 v[8:9], v70 offset:2048
    ds_read_b64_tr_b16 v[10:11], v70 offset:2560
    v_cvt_pk_bf16_f32 v245, v250, v251
    v_cvt_pk_bf16_f32 v246, v252, v253
    v_cvt_pk_bf16_f32 v247, v254, v255
    s_add_u32 s61, s69, 20480
    buffer_store_dwordx4 v[244:247], v97, s[48:51], s61 offen offset:3072 sc1
    v_mfma_f32_32x32x16_bf16 v[192:207], v[12:15], v[112:115], v[192:207]
    ds_read_b64_tr_b16 v[12:13], v70 offset:4096
    ds_read_b64_tr_b16 v[14:15], v70 offset:4608
    s_waitcnt lgkmcnt(8)
    v_mfma_f32_32x32x16_bf16 v[192:207], v[16:19], v[116:119], v[192:207]
    s_add_u32 m0, s60, 4096
    ds_read_b64_tr_b16 v[16:17], v70 offset:6144
    ds_read_b64_tr_b16 v[18:19], v70 offset:6656
    buffer_load_dwordx4 v40, s[36:39], s58 offen offset:0 lds
    v_mfma_f32_32x32x16_bf16 v[192:207], v[20:23], v[120:123], v[192:207]
    ds_read_b64_tr_b16 v[20:21], v70 offset:8192
    ds_read_b64_tr_b16 v[22:23], v70 offset:8704
    s_waitcnt lgkmcnt(8)
    v_mfma_f32_32x32x16_bf16 v[192:207], v[0:3], v[124:127], v[192:207]
    s_waitcnt vmcnt(19)
    s_barrier
    ds_read_b64_tr_b16 v[0:1], v70 offset:10240
    ds_read_b64_tr_b16 v[2:3], v70 offset:10752
    buffer_load_dwordx4 v41, s[36:39], s58 offen offset:1024 lds
    v_mfma_f32_32x32x16_bf16 v[208:223], v[4:7], v[24:27], 0
    ds_read_b64_tr_b16 v[4:5], v70 offset:12288
    ds_read_b64_tr_b16 v[6:7], v70 offset:12800
    buffer_load_dwordx4 v42, s[36:39], s58 offen offset:2048 lds
    s_waitcnt lgkmcnt(8)
    v_mfma_f32_32x32x16_bf16 v[208:223], v[8:11], v[28:31], v[208:223]
    ds_read_b128 v[8:11], v81 offset:32768
    buffer_load_dwordx4 v43, s[36:39], s58 offen offset:3072 lds
    s_add_u32 s58, s58, 0x4000
    v_cvt_pk_bf16_f32 v107, v192, v193
    v_cvt_pk_bf16_f32 v108, v194, v195
    v_accvgpr_write_b32 a176, v107
    v_accvgpr_write_b32 a177, v108
    v_cvt_pk_bf16_f32 v109, v196, v197
    v_cvt_pk_bf16_f32 v110, v198, v199
    v_mfma_f32_32x32x16_bf16 v[208:223], v[12:15], v[32:35], v[208:223]
    ds_read_b128 v[12:15], v82 offset:32768
    v_accvgpr_write_b32 a178, v109
    v_accvgpr_write_b32 a179, v110
    v_cvt_pk_bf16_f32 v107, v200, v201
    v_cvt_pk_bf16_f32 v108, v202, v203
    v_accvgpr_write_b32 a180, v107
    v_accvgpr_write_b32 a181, v108
    s_waitcnt lgkmcnt(6)
    v_mfma_f32_32x32x16_bf16 v[208:223], v[16:19], v[112:115], v[208:223]
    ds_read_b128 v[16:19], v83 offset:32768
    v_cvt_pk_bf16_f32 v109, v204, v205
    v_cvt_pk_bf16_f32 v110, v206, v207
    v_accvgpr_write_b32 a182, v109
    v_accvgpr_write_b32 a183, v110
    v_mfma_f32_32x32x16_bf16 v[208:223], v[20:23], v[116:119], v[208:223]
    s_add_u32 m0, s60, 32768
    ds_read_b128 v[20:23], v84 offset:32768
    buffer_load_dwordx4 v36, s[36:39], s58 offen offset:0 lds
    s_waitcnt lgkmcnt(4)
    v_mfma_f32_32x32x16_bf16 v[208:223], v[0:3], v[120:123], v[208:223]
    ds_read_b128 v[0:3], v85 offset:32768
    v_mfma_f32_32x32x16_bf16 v[208:223], v[4:7], v[124:127], v[208:223]
    ds_read_b128 v[4:7], v86 offset:32768
    s_waitcnt lgkmcnt(4)
    v_mfma_f32_32x32x16_bf16 v[192:207], v[8:11], v[128:131], 0
    ds_read_b128 v[8:11], v87 offset:32768
    buffer_load_dwordx4 v37, s[36:39], s58 offen offset:1024 lds
    v_mfma_f32_32x32x16_bf16 v[192:207], v[12:15], v[132:135], v[192:207]
    ds_read_b128 v[12:15], v88 offset:32768
    s_nop 4
    v_cvt_pk_bf16_f32 v107, v208, v209
    v_cvt_pk_bf16_f32 v108, v210, v211
    v_accvgpr_write_b32 a184, v107
    v_accvgpr_write_b32 a185, v108
    v_cvt_pk_bf16_f32 v109, v212, v213
    v_cvt_pk_bf16_f32 v110, v214, v215
    s_waitcnt lgkmcnt(4)
    v_mfma_f32_32x32x16_bf16 v[192:207], v[16:19], v[136:139], v[192:207]
    ds_read_b128 v[16:19], v81 offset:33024
    v_accvgpr_write_b32 a186, v109
    v_accvgpr_write_b32 a187, v110
    v_cvt_pk_bf16_f32 v107, v216, v217
    v_cvt_pk_bf16_f32 v108, v218, v219
    v_accvgpr_write_b32 a188, v107
    v_accvgpr_write_b32 a189, v108
    v_mfma_f32_32x32x16_bf16 v[192:207], v[20:23], v[140:143], v[192:207]
    ds_read_b128 v[20:23], v82 offset:33024
    buffer_load_dwordx4 v38, s[36:39], s58 offen offset:2048 lds
    v_cvt_pk_bf16_f32 v109, v220, v221
    v_cvt_pk_bf16_f32 v110, v222, v223
    v_accvgpr_write_b32 a190, v109
    v_accvgpr_write_b32 a191, v110
    s_waitcnt lgkmcnt(4)
    v_mfma_f32_32x32x16_bf16 v[192:207], v[0:3], v[144:147], v[192:207]
    ds_read_b128 v[0:3], v83 offset:33024
    v_mfma_f32_32x32x16_bf16 v[192:207], v[4:7], v[148:151], v[192:207]
    ds_read_b128 v[4:7], v84 offset:33024
    s_waitcnt lgkmcnt(4)
    v_mfma_f32_32x32x16_bf16 v[192:207], v[8:11], v[152:155], v[192:207]
    ds_read_b128 v[8:11], v85 offset:33024
    buffer_load_dwordx4 v39, s[36:39], s58 offen offset:3072 lds
    v_mfma_f32_32x32x16_bf16 v[192:207], v[12:15], v[156:159], v[192:207]
    ds_read_b128 v[12:15], v86 offset:33024
    s_waitcnt lgkmcnt(4)
    v_mfma_f32_32x32x16_bf16 v[192:207], v[16:19], v[160:163], v[192:207]
    s_waitcnt vmcnt(14)
    s_barrier
    s_add_u32 m0, s60, 36864
    ds_read_b128 v[16:19], v87 offset:33024
    buffer_load_dwordx4 v40, s[36:39], s58 offen offset:0 lds
    v_mfma_f32_32x32x16_bf16 v[192:207], v[20:23], v[164:167], v[192:207]
    ds_read_b128 v[20:23], v88 offset:33024
    buffer_load_dwordx4 v41, s[36:39], s58 offen offset:1024 lds
    s_waitcnt lgkmcnt(4)
    v_mfma_f32_32x32x16_bf16 v[192:207], v[0:3], v[168:171], v[192:207]
    ds_read_b128 v[0:3], v89 offset:0
    buffer_load_dwordx4 v42, s[36:39], s58 offen offset:2048 lds
    v_mfma_f32_32x32x16_bf16 v[192:207], v[4:7], v[172:175], v[192:207]
    ds_read_b128 v[4:7], v90 offset:0
    buffer_load_dwordx4 v43, s[36:39], s58 offen offset:3072 lds
    s_add_u32 s58, s58, 0x4000
    s_waitcnt lgkmcnt(4)
    v_mfma_f32_32x32x16_bf16 v[192:207], v[8:11], v[176:179], v[192:207]
    ds_read_b128 v[8:11], v91 offset:0
    s_add_u32 s61, s69, 4096
    buffer_store_dwordx4 a[128:131], v97, s[48:51], s61 offen offset:2048 sc1
    v_mfma_f32_32x32x16_bf16 v[192:207], v[12:15], v[180:183], v[192:207]
    ds_read_b128 v[12:15], v92 offset:0
    s_waitcnt lgkmcnt(4)
    v_mfma_f32_32x32x16_bf16 v[192:207], v[16:19], v[184:187], v[192:207]
    s_add_u32 m0, s60, 65536
    ds_read_b128 v[16:19], v93 offset:0
    buffer_load_dwordx4 v36, s[36:39], s58 offen offset:0 lds
    v_mfma_f32_32x32x16_bf16 v[192:207], v[20:23], v[188:191], v[192:207]
    ds_read_b128 v[20:23], v94 offset:0
    s_waitcnt lgkmcnt(4)
    v_mfma_f32_32x32x16_bf16 v[208:223], v[0:3], v[128:131], 0
    ds_read_b128 v[0:3], v95 offset:0
    v_mfma_f32_32x32x16_bf16 v[208:223], v[4:7], v[132:135], v[208:223]
    ds_read_b128 v[4:7], v96 offset:0
    buffer_load_dwordx4 v37, s[36:39], s58 offen offset:1024 lds
    s_waitcnt lgkmcnt(4)
    v_mfma_f32_32x32x16_bf16 v[208:223], v[8:11], v[136:139], v[208:223]
    ds_read_b128 v[8:11], v89 offset:256
    s_nop 1
    v_max3_f32 v101, v192, v193, v194
    v_max3_f32 v101, v101, v195, v196
    v_max3_f32 v101, v101, v197, v198
    v_mfma_f32_32x32x16_bf16 v[208:223], v[12:15], v[140:143], v[208:223]
    ds_read_b128 v[12:15], v90 offset:256
    v_max3_f32 v101, v101, v199, v200
    v_max3_f32 v101, v101, v201, v202
    v_max3_f32 v101, v101, v203, v204
    s_waitcnt lgkmcnt(4)
    v_mfma_f32_32x32x16_bf16 v[208:223], v[16:19], v[144:147], v[208:223]
    ds_read_b128 v[16:19], v91 offset:256
    buffer_load_dwordx4 v38, s[36:39], s58 offen offset:2048 lds
    v_max3_f32 v101, v101, v205, v206
    v_max_f32 v101, v101, v207
    v_mov_b32 v107, v101
    v_mfma_f32_32x32x16_bf16 v[208:223], v[20:23], v[148:151], v[208:223]
    ds_read_b128 v[20:23], v92 offset:256
    v_permlane32_swap_b32 v101, v107
    v_max_f32 v101, v101, v107
    s_waitcnt lgkmcnt(4)
    v_mfma_f32_32x32x16_bf16 v[208:223], v[0:3], v[152:155], v[208:223]
    ds_read_b128 v[0:3], v93 offset:256
    v_sub_f32 v192, v192, v101
    v_sub_f32 v193, v193, v101
    v_exp_f32 v192, v192
    v_exp_f32 v193, v193
    v_mfma_f32_32x32x16_bf16 v[208:223], v[4:7], v[156:159], v[208:223]
    ds_read_b128 v[4:7], v94 offset:256
    buffer_load_dwordx4 v39, s[36:39], s58 offen offset:3072 lds
    s_add_u32 s61, s69, 4096
    buffer_store_dwordx4 a[132:135], v97, s[48:51], s61 offen offset:3072 sc1
    v_add_f32 v98, v98, v192
    v_add_f32 v98, v98, v193
    v_cvt_pk_bf16_f32 v224, v192, v193
    s_waitcnt lgkmcnt(4)
    v_mfma_f32_32x32x16_bf16 v[208:223], v[8:11], v[160:163], v[208:223]
    ds_read_b128 v[8:11], v95 offset:256
    v_sub_f32 v194, v194, v101
    v_sub_f32 v195, v195, v101
    v_exp_f32 v194, v194
    v_mfma_f32_32x32x16_bf16 v[208:223], v[12:15], v[164:167], v[208:223]
    ds_read_b128 v[12:15], v96 offset:256
    v_exp_f32 v195, v195
    v_add_f32 v98, v98, v194
    v_add_f32 v98, v98, v195
    s_waitcnt lgkmcnt(4)
    v_mfma_f32_32x32x16_bf16 v[208:223], v[16:19], v[168:171], v[208:223]
    s_add_u32 m0, s60, 69632
    ds_read_b64_tr_b16 v[16:17], v60 offset:16384
    ds_read_b64_tr_b16 v[18:19], v60 offset:18432
    buffer_load_dwordx4 v40, s[36:39], s58 offen offset:0 lds
    v_cvt_pk_bf16_f32 v225, v194, v195
    v_sub_f32 v196, v196, v101
    v_sub_f32 v197, v197, v101
    v_mfma_f32_32x32x16_bf16 v[208:223], v[20:23], v[172:175], v[208:223]
    ds_read_b64_tr_b16 v[20:21], v61 offset:16384
    ds_read_b64_tr_b16 v[22:23], v61 offset:18432
    v_exp_f32 v196, v196
    v_exp_f32 v197, v197
    v_add_f32 v98, v98, v196
    s_waitcnt lgkmcnt(6)
    v_mfma_f32_32x32x16_bf16 v[208:223], v[0:3], v[176:179], v[208:223]
    ds_read_b64_tr_b16 v[0:1], v62 offset:16384
    ds_read_b64_tr_b16 v[2:3], v62 offset:18432
    v_add_f32 v98, v98, v197
    v_cvt_pk_bf16_f32 v226, v196, v197
    v_sub_f32 v198, v198, v101
    v_mfma_f32_32x32x16_bf16 v[208:223], v[4:7], v[180:183], v[208:223]
    ds_read_b64_tr_b16 v[4:5], v63 offset:16384
    ds_read_b64_tr_b16 v[6:7], v63 offset:18432
    buffer_load_dwordx4 v41, s[36:39], s58 offen offset:1024 lds
    v_sub_f32 v199, v199, v101
    v_exp_f32 v198, v198
    v_exp_f32 v199, v199
    s_waitcnt lgkmcnt(8)
    v_mfma_f32_32x32x16_bf16 v[208:223], v[8:11], v[184:187], v[208:223]
    ds_read_b64_tr_b16 v[8:9], v60 offset:16640
    ds_read_b64_tr_b16 v[10:11], v60 offset:18688
    v_add_f32 v98, v98, v198
    v_add_f32 v98, v98, v199
    v_cvt_pk_bf16_f32 v227, v198, v199
    v_mfma_f32_32x32x16_bf16 v[208:223], v[12:15], v[188:191], v[208:223]
    ds_read_b64_tr_b16 v[12:13], v61 offset:16640
    ds_read_b64_tr_b16 v[14:15], v61 offset:18688
    v_sub_f32 v200, v200, v101
    v_sub_f32 v201, v201, v101
    v_exp_f32 v200, v200
    v_exp_f32 v201, v201
    s_waitcnt lgkmcnt(8)
    v_mfma_f32_32x32x16_bf16 a[0:15], v[16:19], v[224:227], 0
    ds_read_b64_tr_b16 v[16:17], v62 offset:16640
    ds_read_b64_tr_b16 v[18:19], v62 offset:18688
    buffer_load_dwordx4 v42, s[36:39], s58 offen offset:2048 lds
    v_add_f32 v98, v98, v200
    v_add_f32 v98, v98, v201
    v_cvt_pk_bf16_f32 v228, v200, v201
    v_mfma_f32_32x32x16_bf16 a[16:31], v[20:23], v[224:227], 0
    ds_read_b64_tr_b16 v[20:21], v63 offset:16640
    ds_read_b64_tr_b16 v[22:23], v63 offset:18688
    v_sub_f32 v202, v202, v101
    v_sub_f32 v203, v203, v101
    v_exp_f32 v202, v202
    v_exp_f32 v203, v203
    s_waitcnt lgkmcnt(8)
    v_mfma_f32_32x32x16_bf16 a[32:47], v[0:3], v[224:227], 0
    ds_read_b64_tr_b16 v[0:1], v60 offset:24576
    ds_read_b64_tr_b16 v[2:3], v60 offset:26624
    s_add_u32 s61, s69, 8192
    buffer_store_dwordx4 a[136:139], v97, s[48:51], s61 offen offset:0 sc1
    v_add_f32 v98, v98, v202
    v_add_f32 v98, v98, v203
    v_cvt_pk_bf16_f32 v229, v202, v203
    v_mfma_f32_32x32x16_bf16 a[48:63], v[4:7], v[224:227], 0
    ds_read_b64_tr_b16 v[4:5], v61 offset:24576
    ds_read_b64_tr_b16 v[6:7], v61 offset:26624
    buffer_load_dwordx4 v43, s[36:39], s58 offen offset:3072 lds
    s_add_u32 s58, s58, 0x4000
    v_sub_f32 v204, v204, v101
    v_sub_f32 v205, v205, v101
    v_exp_f32 v204, v204
    v_exp_f32 v205, v205
    v_sub_f32 v208, v208, v101
    v_sub_f32 v209, v209, v101
    v_sub_f32 v210, v210, v101
    v_sub_f32 v211, v211, v101
    s_waitcnt lgkmcnt(8)
    v_mfma_f32_32x32x16_bf16 a[64:79], v[8:11], v[224:227], 0
    ds_read_b64_tr_b16 v[8:9], v62 offset:24576
    ds_read_b64_tr_b16 v[10:11], v62 offset:26624
    v_add_f32 v98, v98, v204
    v_add_f32 v98, v98, v205
    v_cvt_pk_bf16_f32 v230, v204, v205
    v_sub_f32 v212, v212, v101
    v_sub_f32 v213, v213, v101
    v_sub_f32 v214, v214, v101
    v_sub_f32 v215, v215, v101
    v_mfma_f32_32x32x16_bf16 a[80:95], v[12:15], v[224:227], 0
    ds_read_b64_tr_b16 v[12:13], v63 offset:24576
    ds_read_b64_tr_b16 v[14:15], v63 offset:26624
    v_sub_f32 v206, v206, v101
    v_sub_f32 v207, v207, v101
    v_exp_f32 v206, v206
    v_exp_f32 v207, v207
    v_sub_f32 v216, v216, v101
    v_sub_f32 v217, v217, v101
    v_sub_f32 v218, v218, v101
    s_waitcnt lgkmcnt(8)
    v_mfma_f32_32x32x16_bf16 a[96:111], v[16:19], v[224:227], 0
    ds_read_b64_tr_b16 v[16:17], v60 offset:24832
    ds_read_b64_tr_b16 v[18:19], v60 offset:26880
    v_add_f32 v98, v98, v206
    v_add_f32 v98, v98, v207
    v_cvt_pk_bf16_f32 v231, v206, v207
    v_sub_f32 v219, v219, v101
    v_sub_f32 v220, v220, v101
    v_sub_f32 v221, v221, v101
    v_sub_f32 v222, v222, v101
    v_mfma_f32_32x32x16_bf16 a[112:127], v[20:23], v[224:227], 0
    ds_read_b64_tr_b16 v[20:21], v61 offset:24832
    ds_read_b64_tr_b16 v[22:23], v61 offset:26880
    v_sub_f32 v223, v223, v101
    v_sub_f32 v112, 0, v101
    v_sub_f32 v113, 0, v101
    s_waitcnt lgkmcnt(8)
    v_mfma_f32_32x32x16_bf16 a[0:15], v[0:3], v[228:231], a[0:15]
    s_waitcnt vmcnt(19)
    s_barrier
    s_add_u32 m0, s60, 98304
    ds_read_b64_tr_b16 v[0:1], v62 offset:24832
    ds_read_b64_tr_b16 v[2:3], v62 offset:26880
    buffer_load_dwordx4 v36, s[36:39], s58 offen offset:0 lds
    v_sub_f32 v114, 0, v101
    v_sub_f32 v115, 0, v101
    v_sub_f32 v116, 0, v101
    v_sub_f32 v117, 0, v101
    v_mfma_f32_32x32x16_bf16 a[16:31], v[4:7], v[228:231], a[16:31]
    ds_read_b64_tr_b16 v[4:5], v63 offset:24832
    ds_read_b64_tr_b16 v[6:7], v63 offset:26880
    v_sub_f32 v118, 0, v101
    v_sub_f32 v119, 0, v101
    v_sub_f32 v120, 0, v101
    s_waitcnt lgkmcnt(8)
    v_mfma_f32_32x32x16_bf16 a[32:47], v[8:11], v[228:231], a[32:47]
    ds_read_b128 v[8:11], v73 offset:0
    v_sub_f32 v121, 0, v101
    v_sub_f32 v122, 0, v101
    v_sub_f32 v123, 0, v101
    v_sub_f32 v124, 0, v101
    v_mfma_f32_32x32x16_bf16 a[48:63], v[12:15], v[228:231], a[48:63]
    ds_read_b128 v[12:15], v74 offset:0
    buffer_load_dwordx4 v37, s[36:39], s58 offen offset:1024 lds
    v_sub_f32 v125, 0, v101
    v_sub_f32 v126, 0, v101
    v_sub_f32 v127, 0, v101
    s_waitcnt lgkmcnt(6)
    v_mfma_f32_32x32x16_bf16 a[64:79], v[16:19], v[228:231], a[64:79]
    ds_read_b128 v[16:19], v75 offset:0
    v_max3_f32 v108, v208, v209, v210
    v_max3_f32 v108, v108, v211, v212
    v_max3_f32 v108, v108, v213, v214
    v_mfma_f32_32x32x16_bf16 a[80:95], v[20:23], v[228:231], a[80:95]
    ds_read_b128 v[20:23], v76 offset:0
    s_add_u32 s61, s69, 8192
    buffer_store_dwordx4 a[140:143], v97, s[48:51], s61 offen offset:1024 sc1
    v_max3_f32 v108, v108, v215, v216
    v_max3_f32 v108, v108, v217, v218
    v_max3_f32 v108, v108, v219, v220
    s_waitcnt lgkmcnt(4)
    v_mfma_f32_32x32x16_bf16 a[96:111], v[0:3], v[228:231], a[96:111]
    ds_read_b128 v[0:3], v77 offset:0
    buffer_load_dwordx4 v38, s[36:39], s58 offen offset:2048 lds
    v_max3_f32 v108, v108, v221, v222
    v_max_f32 v108, v108, v223
    v_cmp_lt_f32 vcc, s66, v108
    v_mfma_f32_32x32x16_bf16 a[112:127], v[4:7], v[228:231], a[112:127]
    ds_read_b128 v[4:7], v78 offset:0
    s_cbranch_vccnz L1_tr1
L1_bk1:
    s_waitcnt lgkmcnt(4)
    v_mfma_f32_32x32x16_bf16 v[192:207], v[8:11], v[128:131], v[112:127]
    ds_read_b128 v[8:11], v79 offset:0
    v_exp_f32 v208, v208
    v_exp_f32 v209, v209
    v_mfma_f32_32x32x16_bf16 v[192:207], v[12:15], v[132:135], v[192:207]
    ds_read_b128 v[12:15], v80 offset:0
    buffer_load_dwordx4 v39, s[36:39], s58 offen offset:3072 lds
    v_add_f32 v98, v98, v208
    v_add_f32 v98, v98, v209
    s_waitcnt lgkmcnt(4)
    v_mfma_f32_32x32x16_bf16 v[192:207], v[16:19], v[136:139], v[192:207]
    ds_read_b128 v[16:19], v73 offset:256
    v_cvt_pk_bf16_f32 v224, v208, v209
    v_exp_f32 v210, v210
    v_mfma_f32_32x32x16_bf16 v[192:207], v[20:23], v[140:143], v[192:207]
    ds_read_b128 v[20:23], v74 offset:256
    v_exp_f32 v211, v211
    v_add_f32 v98, v98, v210
    s_waitcnt lgkmcnt(4)
    v_mfma_f32_32x32x16_bf16 v[192:207], v[0:3], v[144:147], v[192:207]
    s_add_u32 m0, s60, 102400
    ds_read_b128 v[0:3], v75 offset:256
    buffer_load_dwordx4 v40, s[36:39], s58 offen offset:0 lds
    v_add_f32 v98, v98, v211
    v_cvt_pk_bf16_f32 v225, v210, v211
    v_mfma_f32_32x32x16_bf16 v[192:207], v[4:7], v[148:151], v[192:207]
    ds_read_b128 v[4:7], v76 offset:256
    v_exp_f32 v212, v212
    v_exp_f32 v213, v213
    s_waitcnt lgkmcnt(4)
    v_mfma_f32_32x32x16_bf16 v[192:207], v[8:11], v[152:155], v[192:207]
    ds_read_b128 v[8:11], v77 offset:256
    v_add_f32 v98, v98, v212
    v_add_f32 v98, v98, v213
    v_mfma_f32_32x32x16_bf16 v[192:207], v[12:15], v[156:159], v[192:207]
    ds_read_b128 v[12:15], v78 offset:256
    buffer_load_dwordx4 v41, s[36:39], s58 offen offset:1024 lds
    v_cvt_pk_bf16_f32 v226, v212, v213
    v_exp_f32 v214, v214
    s_waitcnt lgkmcnt(4)
    v_mfma_f32_32x32x16_bf16 v[192:207], v[16:19], v[160:163], v[192:207]
    ds_read_b128 v[16:19], v79 offset:256
    s_add_u32 s61, s69, 12288
    buffer_store_dwordx4 a[144:147], v97, s[48:51], s61 offen offset:0 sc1
    v_exp_f32 v215, v215
    v_add_f32 v98, v98, v214
    v_mfma_f32_32x32x16_bf16 v[192:207], v[20:23], v[164:167], v[192:207]
    ds_read_b128 v[20:23], v80 offset:256
    v_add_f32 v98, v98, v215
    v_cvt_pk_bf16_f32 v227, v214, v215
    s_waitcnt lgkmcnt(4)
    v_mfma_f32_32x32x16_bf16 v[192:207], v[0:3], v[168:171], v[192:207]
    ds_read_b64_tr_b16 v[0:1], v52 offset:16384
    ds_read_b64_tr_b16 v[2:3], v52 offset:18432
    buffer_load_dwordx4 v42, s[36:39], s58 offen offset:2048 lds
    v_exp_f32 v216, v216
    v_exp_f32 v217, v217
    v_mfma_f32_32x32x16_bf16 v[192:207], v[4:7], v[172:175], v[192:207]
    ds_read_b64_tr_b16 v[4:5], v53 offset:16384
    ds_read_b64_tr_b16 v[6:7], v53 offset:18432
    v_add_f32 v98, v98, v216
    v_add_f32 v98, v98, v217
    s_waitcnt lgkmcnt(6)
    v_mfma_f32_32x32x16_bf16 v[192:207], v[8:11], v[176:179], v[192:207]
    ds_read_b64_tr_b16 v[8:9], v54 offset:16384
    ds_read_b64_tr_b16 v[10:11], v54 offset:18432
    v_cvt_pk_bf16_f32 v228, v216, v217
    v_mfma_f32_32x32x16_bf16 v[192:207], v[12:15], v[180:183], v[192:207]
    ds_read_b64_tr_b16 v[12:13], v55 offset:16384
    ds_read_b64_tr_b16 v[14:15], v55 offset:18432
    buffer_load_dwordx4 v43, s[36:39], s58 offen offset:3072 lds
    s_add_u32 s58, s58, 0x4000
    v_exp_f32 v218, v218
    v_exp_f32 v219, v219
    s_waitcnt lgkmcnt(8)
    v_mfma_f32_32x32x16_bf16 v[192:207], v[16:19], v[184:187], v[192:207]
    ds_read_b64_tr_b16 v[16:17], v52 offset:16640
    ds_read_b64_tr_b16 v[18:19], v52 offset:18688
    v_add_f32 v98, v98, v218
    v_add_f32 v98, v98, v219
    v_mfma_f32_32x32x16_bf16 v[192:207], v[20:23], v[188:191], v[192:207]
    ds_read_b64_tr_b16 v[20:21], v53 offset:16640
    ds_read_b64_tr_b16 v[22:23], v53 offset:18688
    v_cvt_pk_bf16_f32 v229, v218, v219
    s_waitcnt lgkmcnt(8)
    v_mfma_f32_32x32x16_bf16 a[0:15], v[0:3], v[224:227], a[0:15]
    ds_read_b64_tr_b16 v[0:1], v54 offset:16640
    ds_read_b64_tr_b16 v[2:3], v54 offset:18688
    v_exp_f32 v220, v220
    v_exp_f32 v221, v221
    v_mfma_f32_32x32x16_bf16 a[16:31], v[4:7], v[224:227], a[16:31]
    ds_read_b64_tr_b16 v[4:5], v55 offset:16640
    ds_read_b64_tr_b16 v[6:7], v55 offset:18688
    v_add_f32 v98, v98, v220
    v_add_f32 v98, v98, v221
    s_waitcnt lgkmcnt(8)
    v_mfma_f32_32x32x16_bf16 a[32:47], v[8:11], v[224:227], a[32:47]
    ds_read_b64_tr_b16 v[8:9], v52 offset:24576
    ds_read_b64_tr_b16 v[10:11], v52 offset:26624
    v_cvt_pk_bf16_f32 v230, v220, v221
    v_mfma_f32_32x32x16_bf16 a[48:63], v[12:15], v[224:227], a[48:63]
    ds_read_b64_tr_b16 v[12:13], v53 offset:24576
    ds_read_b64_tr_b16 v[14:15], v53 offset:26624
    s_add_u32 s61, s69, 12288
    buffer_store_dwordx4 a[148:151], v97, s[48:51], s61 offen offset:1024 sc1
    v_exp_f32 v222, v222
    v_exp_f32 v223, v223
    s_waitcnt lgkmcnt(8)
    v_mfma_f32_32x32x16_bf16 a[64:79], v[16:19], v[224:227], a[64:79]
    ds_read_b64_tr_b16 v[16:17], v54 offset:24576
    ds_read_b64_tr_b16 v[18:19], v54 offset:26624
    v_add_f32 v98, v98, v222
    v_add_f32 v98, v98, v223
    v_mfma_f32_32x32x16_bf16 a[80:95], v[20:23], v[224:227], a[80:95]
    ds_read_b64_tr_b16 v[20:21], v55 offset:24576
    ds_read_b64_tr_b16 v[22:23], v55 offset:26624
    v_cvt_pk_bf16_f32 v231, v222, v223
    s_waitcnt lgkmcnt(8)
    v_mfma_f32_32x32x16_bf16 a[96:111], v[0:3], v[224:227], a[96:111]
    ds_read_b64_tr_b16 v[0:1], v52 offset:24832
    ds_read_b64_tr_b16 v[2:3], v52 offset:26880
    v_max3_f32 v108, v192, v193, v194
    v_mfma_f32_32x32x16_bf16 a[112:127], v[4:7], v[224:227], a[112:127]
    ds_read_b64_tr_b16 v[4:5], v53 offset:24832
    ds_read_b64_tr_b16 v[6:7], v53 offset:26880
    v_max3_f32 v108, v108, v195, v196
    s_waitcnt lgkmcnt(8)
    v_mfma_f32_32x32x16_bf16 a[0:15], v[8:11], v[228:231], a[0:15]
    s_waitcnt vmcnt(22)
    s_barrier
    s_add_u32 m0, s60, 131072
    ds_read_b64_tr_b16 v[8:9], v54 offset:24832
    ds_read_b64_tr_b16 v[10:11], v54 offset:26880
    buffer_load_dwordx4 v36, s[36:39], s58 offen offset:0 lds
    v_max3_f32 v108, v108, v197, v198
    v_mfma_f32_32x32x16_bf16 a[16:31], v[12:15], v[228:231], a[16:31]
    ds_read_b64_tr_b16 v[12:13], v55 offset:24832
    ds_read_b64_tr_b16 v[14:15], v55 offset:26880
    v_max3_f32 v108, v108, v199, v200
    s_waitcnt lgkmcnt(8)
    v_mfma_f32_32x32x16_bf16 a[32:47], v[16:19], v[228:231], a[32:47]
    ds_read_b128 v[16:19], v73 offset:32768
    v_max3_f32 v108, v108, v201, v202
    v_mfma_f32_32x32x16_bf16 a[48:63], v[20:23], v[228:231], a[48:63]
    ds_read_b128 v[20:23], v74 offset:32768
    buffer_load_dwordx4 v37, s[36:39], s58 offen offset:1024 lds
    v_max3_f32 v108, v108, v203, v204
    s_waitcnt lgkmcnt(6)
    v_mfma_f32_32x32x16_bf16 a[64:79], v[0:3], v[228:231], a[64:79]
    ds_read_b128 v[0:3], v75 offset:32768
    v_max3_f32 v108, v108, v205, v206
    v_mfma_f32_32x32x16_bf16 a[80:95], v[4:7], v[228:231], a[80:95]
    ds_read_b128 v[4:7], v76 offset:32768
    v_max_f32 v108, v108, v207
    s_waitcnt lgkmcnt(4)
    v_mfma_f32_32x32x16_bf16 a[96:111], v[8:11], v[228:231], a[96:111]
    ds_read_b128 v[8:11], v77 offset:32768
    buffer_load_dwordx4 v38, s[36:39], s58 offen offset:2048 lds
    s_add_u32 s61, s69, 12288
    buffer_store_dwordx4 a[152:155], v97, s[48:51], s61 offen offset:2048 sc1
    v_cmp_lt_f32 vcc, s66, v108
    v_mfma_f32_32x32x16_bf16 a[112:127], v[12:15], v[228:231], a[112:127]
    ds_read_b128 v[12:15], v78 offset:32768
    s_cbranch_vccnz L1_tr2
L1_bk2:
    s_waitcnt lgkmcnt(4)
    v_mfma_f32_32x32x16_bf16 v[208:223], v[16:19], v[128:131], v[112:127]
    ds_read_b128 v[16:19], v79 offset:32768
    v_exp_f32 v192, v192
    v_exp_f32 v193, v193
    v_mov_b32 v29, 0
    v_mfma_f32_32x32x16_bf16 v[208:223], v[20:23], v[132:135], v[208:223]
    ds_read_b128 v[20:23], v80 offset:32768
    buffer_load_dwordx4 v39, s[36:39], s58 offen offset:3072 lds
    v_add_f32 v98, v98, v192
    v_add_f32 v98, v98, v193
    buffer_load_dword v28, v29, s[4:7], 0 offen sc1
    s_waitcnt lgkmcnt(4)
    v_mfma_f32_32x32x16_bf16 v[208:223], v[0:3], v[136:139], v[208:223]
    ds_read_b128 v[0:3], v73 offset:33024
    v_cvt_pk_bf16_f32 v224, v192, v193
    v_exp_f32 v194, v194
    v_lshrrev_b32 v109, 4, v97
    v_mfma_f32_32x32x16_bf16 v[208:223], v[4:7], v[140:143], v[208:223]
    ds_read_b128 v[4:7], v74 offset:33024
    v_exp_f32 v195, v195
    v_add_f32 v98, v98, v194
    v_cmp_gt_u32 vcc, 32, v109
    s_waitcnt lgkmcnt(4)
    v_mfma_f32_32x32x16_bf16 v[208:223], v[8:11], v[144:147], v[208:223]
    s_add_u32 m0, s60, 135168
    ds_read_b128 v[8:11], v75 offset:33024
    buffer_load_dwordx4 v40, s[36:39], s58 offen offset:0 lds
    v_add_f32 v98, v98, v195
    v_cvt_pk_bf16_f32 v225, v194, v195
    v_mov_b32 v110, 0x40000000
    v_mfma_f32_32x32x16_bf16 v[208:223], v[12:15], v[148:151], v[208:223]
    ds_read_b128 v[12:15], v76 offset:33024
    v_exp_f32 v196, v196
    v_exp_f32 v197, v197
    v_lshlrev_b32 v111, 2, v109
    s_waitcnt lgkmcnt(4)
    v_mfma_f32_32x32x16_bf16 v[208:223], v[16:19], v[152:155], v[208:223]
    ds_read_b128 v[16:19], v77 offset:33024
    v_add_f32 v98, v98, v196
    v_add_f32 v98, v98, v197
    v_and_b32 v100, 15, v109
    v_mfma_f32_32x32x16_bf16 v[208:223], v[20:23], v[156:159], v[208:223]
    ds_read_b128 v[20:23], v78 offset:33024
    buffer_load_dwordx4 v41, s[36:39], s58 offen offset:1024 lds
    v_cvt_pk_bf16_f32 v226, v196, v197
    v_exp_f32 v198, v198
    v_cndmask_b32 v99, v110, v111, vcc
    s_waitcnt lgkmcnt(4)
    v_mfma_f32_32x32x16_bf16 v[208:223], v[0:3], v[160:163], v[208:223]
    ds_read_b128 v[0:3], v79 offset:33024
    v_exp_f32 v199, v199
    v_add_f32 v98, v98, v198
    v_mul_u32_u24 v100, 256, v100
    v_mfma_f32_32x32x16_bf16 v[208:223], v[4:7], v[164:167], v[208:223]
    ds_read_b128 v[4:7], v80 offset:33024
    s_add_u32 s61, s69, 12288
    buffer_store_dwordx4 a[156:159], v97, s[48:51], s61 offen offset:3072 sc1
    v_add_f32 v98, v98, v199
    v_cvt_pk_bf16_f32 v227, v198, v199
    v_and_b32 v110, 31, v109
    s_waitcnt lgkmcnt(4)
    v_mfma_f32_32x32x16_bf16 v[208:223], v[8:11], v[168:171], v[208:223]
    ds_read_b64_tr_b16 v[8:9], v52 offset:49152
    ds_read_b64_tr_b16 v[10:11], v52 offset:51200
    buffer_load_dwordx4 v42, s[36:39], s58 offen offset:2048 lds
    v_exp_f32 v200, v200
    v_exp_f32 v201, v201
    v_mul_u32_u24 v110, 896, v110
    v_mfma_f32_32x32x16_bf16 v[208:223], v[12:15], v[172:175], v[208:223]
    ds_read_b64_tr_b16 v[12:13], v53 offset:49152
    ds_read_b64_tr_b16 v[14:15], v53 offset:51200
    v_add_f32 v98, v98, v200
    v_add_f32 v98, v98, v201
    v_and_b32 v111, 32, v109
    s_waitcnt lgkmcnt(6)
    v_mfma_f32_32x32x16_bf16 v[208:223], v[16:19], v[176:179], v[208:223]
    ds_read_b64_tr_b16 v[16:17], v54 offset:49152
    ds_read_b64_tr_b16 v[18:19], v54 offset:51200
    v_cvt_pk_bf16_f32 v228, v200, v201
    v_add_u32 v101, v110, v111
    v_mfma_f32_32x32x16_bf16 v[208:223], v[20:23], v[180:183], v[208:223]
    ds_read_b64_tr_b16 v[20:21], v55 offset:49152
    ds_read_b64_tr_b16 v[22:23], v55 offset:51200
    buffer_load_dwordx4 v43, s[36:39], s58 offen offset:3072 lds
    s_add_u32 s58, s58, 0x4000
    v_exp_f32 v202, v202
    v_exp_f32 v203, v203
    s_waitcnt lgkmcnt(8)
    v_mfma_f32_32x32x16_bf16 v[208:223], v[0:3], v[184:187], v[208:223]
    ds_read_b64_tr_b16 v[0:1], v52 offset:49408
    ds_read_b64_tr_b16 v[2:3], v52 offset:51456
    v_add_f32 v98, v98, v202
    v_add_f32 v98, v98, v203
    v_mfma_f32_32x32x16_bf16 v[208:223], v[4:7], v[188:191], v[208:223]
    ds_read_b64_tr_b16 v[4:5], v53 offset:49408
    ds_read_b64_tr_b16 v[6:7], v53 offset:51456
    v_cvt_pk_bf16_f32 v229, v202, v203
    s_waitcnt lgkmcnt(8)
    v_mfma_f32_32x32x16_bf16 a[0:15], v[8:11], v[224:227], a[0:15]
    ds_read_b64_tr_b16 v[8:9], v54 offset:49408
    ds_read_b64_tr_b16 v[10:11], v54 offset:51456
    v_exp_f32 v204, v204
    v_exp_f32 v205, v205
    v_mfma_f32_32x32x16_bf16 a[16:31], v[12:15], v[224:227], a[16:31]
    ds_read_b64_tr_b16 v[12:13], v55 offset:49408
    ds_read_b64_tr_b16 v[14:15], v55 offset:51456
    v_add_f32 v98, v98, v204
    v_add_f32 v98, v98, v205
    s_waitcnt lgkmcnt(8)
    v_mfma_f32_32x32x16_bf16 a[32:47], v[16:19], v[224:227], a[32:47]
    ds_read_b64_tr_b16 v[16:17], v52 offset:57344
    ds_read_b64_tr_b16 v[18:19], v52 offset:59392
    v_cvt_pk_bf16_f32 v230, v204, v205
    v_mfma_f32_32x32x16_bf16 a[48:63], v[20:23], v[224:227], a[48:63]
    ds_read_b64_tr_b16 v[20:21], v53 offset:57344
    ds_read_b64_tr_b16 v[22:23], v53 offset:59392
    v_exp_f32 v206, v206
    v_exp_f32 v207, v207
    s_waitcnt lgkmcnt(8)
    v_mfma_f32_32x32x16_bf16 a[64:79], v[0:3], v[224:227], a[64:79]
    ds_read_b64_tr_b16 v[0:1], v54 offset:57344
    ds_read_b64_tr_b16 v[2:3], v54 offset:59392
    s_add_u32 s61, s69, 16384
    buffer_store_dwordx4 a[160:163], v97, s[48:51], s61 offen offset:2048 sc1
    v_add_f32 v98, v98, v206
    v_add_f32 v98, v98, v207
    v_mfma_f32_32x32x16_bf16 a[80:95], v[4:7], v[224:227], a[80:95]
    ds_read_b64_tr_b16 v[4:5], v55 offset:57344
    ds_read_b64_tr_b16 v[6:7], v55 offset:59392
    v_cvt_pk_bf16_f32 v231, v206, v207
    s_waitcnt lgkmcnt(8)
    v_mfma_f32_32x32x16_bf16 a[96:111], v[8:11], v[224:227], a[96:111]
    ds_read_b64_tr_b16 v[8:9], v52 offset:57600
    ds_read_b64_tr_b16 v[10:11], v52 offset:59648
    v_max3_f32 v108, v208, v209, v210
    v_mfma_f32_32x32x16_bf16 a[112:127], v[12:15], v[224:227], a[112:127]
    ds_read_b64_tr_b16 v[12:13], v53 offset:57600
    ds_read_b64_tr_b16 v[14:15], v53 offset:59648
    v_max3_f32 v108, v108, v211, v212
    s_waitcnt lgkmcnt(8)
    v_mfma_f32_32x32x16_bf16 a[0:15], v[16:19], v[228:231], a[0:15]
    s_waitcnt vmcnt(23)
    s_barrier
    s_add_u32 m0, s60, 0
    ds_read_b64_tr_b16 v[16:17], v54 offset:57600
    ds_read_b64_tr_b16 v[18:19], v54 offset:59648
    buffer_load_dwordx4 v36, s[36:39], s58 offen offset:0 lds
    v_max3_f32 v108, v108, v213, v214
    v_mfma_f32_32x32x16_bf16 a[16:31], v[20:23], v[228:231], a[16:31]
    ds_read_b64_tr_b16 v[20:21], v55 offset:57600
    ds_read_b64_tr_b16 v[22:23], v55 offset:59648
    v_max3_f32 v108, v108, v215, v216
    s_waitcnt lgkmcnt(8)
    v_mfma_f32_32x32x16_bf16 a[32:47], v[0:3], v[228:231], a[32:47]
    ds_read_b128 v[0:3], v81 offset:0
    v_max3_f32 v108, v108, v217, v218
    v_mfma_f32_32x32x16_bf16 a[48:63], v[4:7], v[228:231], a[48:63]
    ds_read_b128 v[4:7], v82 offset:0
    buffer_load_dwordx4 v37, s[36:39], s58 offen offset:1024 lds
    v_max3_f32 v108, v108, v219, v220
    s_waitcnt lgkmcnt(6)
    v_mfma_f32_32x32x16_bf16 a[64:79], v[8:11], v[228:231], a[64:79]
    ds_read_b128 v[8:11], v83 offset:0
    v_max3_f32 v108, v108, v221, v222
    v_mfma_f32_32x32x16_bf16 a[80:95], v[12:15], v[228:231], a[80:95]
    ds_read_b128 v[12:15], v84 offset:0
    v_max_f32 v108, v108, v223
    s_waitcnt lgkmcnt(4)
    v_mfma_f32_32x32x16_bf16 a[96:111], v[16:19], v[228:231], a[96:111]
    ds_read_b128 v[16:19], v85 offset:0
    buffer_load_dwordx4 v38, s[36:39], s58 offen offset:2048 lds
    v_cmp_lt_f32 vcc, s66, v108
    v_mfma_f32_32x32x16_bf16 a[112:127], v[20:23], v[228:231], a[112:127]
    ds_read_b128 v[20:23], v86 offset:0
    s_cbranch_vccnz L1_tr3
L1_bk3:
    s_add_u32 s61, s69, 16384
    buffer_store_dwordx4 a[164:167], v97, s[48:51], s61 offen offset:3072 sc1
    s_waitcnt lgkmcnt(4)
    v_mfma_f32_32x32x16_bf16 v[192:207], v[0:3], v[128:131], v[112:127]
    ds_read_b128 v[0:3], v87 offset:0
    v_exp_f32 v208, v208
    v_exp_f32 v209, v209
    v_mfma_f32_32x32x16_bf16 v[192:207], v[4:7], v[132:135], v[192:207]
    ds_read_b128 v[4:7], v88 offset:0
    buffer_load_dwordx4 v39, s[36:39], s58 offen offset:3072 lds
    v_add_f32 v98, v98, v208
    v_add_f32 v98, v98, v209
    s_waitcnt lgkmcnt(4)
    v_mfma_f32_32x32x16_bf16 v[192:207], v[8:11], v[136:139], v[192:207]
    ds_read_b128 v[8:11], v81 offset:256
    v_cvt_pk_bf16_f32 v224, v208, v209
    v_exp_f32 v210, v210
    v_mfma_f32_32x32x16_bf16 v[192:207], v[12:15], v[140:143], v[192:207]
    ds_read_b128 v[12:15], v82 offset:256
    v_exp_f32 v211, v211
    v_add_f32 v98, v98, v210
    s_waitcnt lgkmcnt(4)
    v_mfma_f32_32x32x16_bf16 v[192:207], v[16:19], v[144:147], v[192:207]
    s_add_u32 m0, s60, 4096
    ds_read_b128 v[16:19], v83 offset:256
    buffer_load_dwordx4 v40, s[36:39], s58 offen offset:0 lds
    v_add_f32 v98, v98, v211
    v_cvt_pk_bf16_f32 v225, v210, v211
    v_mfma_f32_32x32x16_bf16 v[192:207], v[20:23], v[148:151], v[192:207]
    ds_read_b128 v[20:23], v84 offset:256
    v_exp_f32 v212, v212
    v_exp_f32 v213, v213
    s_waitcnt lgkmcnt(4)
    v_mfma_f32_32x32x16_bf16 v[192:207], v[0:3], v[152:155], v[192:207]
    ds_read_b128 v[0:3], v85 offset:256
    v_add_f32 v98, v98, v212
    v_add_f32 v98, v98, v213
    v_mfma_f32_32x32x16_bf16 v[192:207], v[4:7], v[156:159], v[192:207]
    ds_read_b128 v[4:7], v86 offset:256
    buffer_load_dwordx4 v41, s[36:39], s58 offen offset:1024 lds
    v_cvt_pk_bf16_f32 v226, v212, v213
    v_exp_f32 v214, v214
    s_waitcnt lgkmcnt(4)
    v_mfma_f32_32x32x16_bf16 v[192:207], v[8:11], v[160:163], v[192:207]
    ds_read_b128 v[8:11], v87 offset:256
    v_exp_f32 v215, v215
    v_add_f32 v98, v98, v214
    v_mfma_f32_32x32x16_bf16 v[192:207], v[12:15], v[164:167], v[192:207]
    ds_read_b128 v[12:15], v88 offset:256
    v_add_f32 v98, v98, v215
    v_cvt_pk_bf16_f32 v227, v214, v215
    s_waitcnt lgkmcnt(4)
    v_mfma_f32_32x32x16_bf16 v[192:207], v[16:19], v[168:171], v[192:207]
    ds_read_b64_tr_b16 v[16:17], v56 offset:16384
    ds_read_b64_tr_b16 v[18:19], v56 offset:18432
    buffer_load_dwordx4 v42, s[36:39], s58 offen offset:2048 lds
    s_add_u32 s61, s69, 20480
    buffer_store_dwordx4 a[168:171], v97, s[48:51], s61 offen offset:0 sc1
    v_exp_f32 v216, v216
    v_exp_f32 v217, v217
    v_mfma_f32_32x32x16_bf16 v[192:207], v[20:23], v[172:175], v[192:207]
    ds_read_b64_tr_b16 v[20:21], v57 offset:16384
    ds_read_b64_tr_b16 v[22:23], v57 offset:18432
    v_add_f32 v98, v98, v216
    v_add_f32 v98, v98, v217
    s_waitcnt lgkmcnt(6)
    v_mfma_f32_32x32x16_bf16 v[192:207], v[0:3], v[176:179], v[192:207]
    ds_read_b64_tr_b16 v[0:1], v58 offset:16384
    ds_read_b64_tr_b16 v[2:3], v58 offset:18432
    v_cvt_pk_bf16_f32 v228, v216, v217
    v_mfma_f32_32x32x16_bf16 v[192:207], v[4:7], v[180:183], v[192:207]
    ds_read_b64_tr_b16 v[4:5], v59 offset:16384
    ds_read_b64_tr_b16 v[6:7], v59 offset:18432
    buffer_load_dwordx4 v43, s[36:39], s58 offen offset:3072 lds
    s_add_u32 s58, s58, 0x4000
    v_exp_f32 v218, v218
    v_exp_f32 v219, v219
    s_waitcnt lgkmcnt(8)
    v_mfma_f32_32x32x16_bf16 v[192:207], v[8:11], v[184:187], v[192:207]
    ds_read_b64_tr_b16 v[8:9], v56 offset:16640
    ds_read_b64_tr_b16 v[10:11], v56 offset:18688
    v_add_f32 v98, v98, v218
    v_add_f32 v98, v98, v219
    v_mfma_f32_32x32x16_bf16 v[192:207], v[12:15], v[188:191], v[192:207]
    ds_read_b64_tr_b16 v[12:13], v57 offset:16640
    ds_read_b64_tr_b16 v[14:15], v57 offset:18688
    v_cvt_pk_bf16_f32 v229, v218, v219
    s_waitcnt lgkmcnt(8)
    v_mfma_f32_32x32x16_bf16 a[0:15], v[16:19], v[224:227], a[0:15]
    ds_read_b64_tr_b16 v[16:17], v58 offset:16640
    ds_read_b64_tr_b16 v[18:19], v58 offset:18688
    v_exp_f32 v220, v220
    v_exp_f32 v221, v221
    v_mfma_f32_32x32x16_bf16 a[16:31], v[20:23], v[224:227], a[16:31]
    ds_read_b64_tr_b16 v[20:21], v59 offset:16640
    ds_read_b64_tr_b16 v[22:23], v59 offset:18688
    v_add_f32 v98, v98, v220
    v_add_f32 v98, v98, v221
    s_waitcnt lgkmcnt(8)
    v_mfma_f32_32x32x16_bf16 a[32:47], v[0:3], v[224:227], a[32:47]
    ds_read_b64_tr_b16 v[0:1], v56 offset:24576
    ds_read_b64_tr_b16 v[2:3], v56 offset:26624
    v_cvt_pk_bf16_f32 v230, v220, v221
    v_mfma_f32_32x32x16_bf16 a[48:63], v[4:7], v[224:227], a[48:63]
    ds_read_b64_tr_b16 v[4:5], v57 offset:24576
    ds_read_b64_tr_b16 v[6:7], v57 offset:26624
    v_exp_f32 v222, v222
    v_exp_f32 v223, v223
    s_waitcnt lgkmcnt(8)
    v_mfma_f32_32x32x16_bf16 a[64:79], v[8:11], v[224:227], a[64:79]
    ds_read_b64_tr_b16 v[8:9], v58 offset:24576
    ds_read_b64_tr_b16 v[10:11], v58 offset:26624
    v_add_f32 v98, v98, v222
    v_add_f32 v98, v98, v223
    v_mfma_f32_32x32x16_bf16 a[80:95], v[12:15], v[224:227], a[80:95]
    ds_read_b64_tr_b16 v[12:13], v59 offset:24576
    ds_read_b64_tr_b16 v[14:15], v59 offset:26624
    s_add_u32 s61, s69, 20480
    buffer_store_dwordx4 a[172:175], v97, s[48:51], s61 offen offset:1024 sc1
    v_cvt_pk_bf16_f32 v231, v222, v223
    s_waitcnt lgkmcnt(8)
    v_mfma_f32_32x32x16_bf16 a[96:111], v[16:19], v[224:227], a[96:111]
    ds_read_b64_tr_b16 v[16:17], v56 offset:24832
    ds_read_b64_tr_b16 v[18:19], v56 offset:26880
    v_max3_f32 v108, v192, v193, v194
    v_mfma_f32_32x32x16_bf16 a[112:127], v[20:23], v[224:227], a[112:127]
    ds_read_b64_tr_b16 v[20:21], v57 offset:24832
    ds_read_b64_tr_b16 v[22:23], v57 offset:26880
    v_max3_f32 v108, v108, v195, v196
    s_waitcnt lgkmcnt(8)
    v_mfma_f32_32x32x16_bf16 a[0:15], v[0:3], v[228:231], a[0:15]
    s_waitcnt vmcnt(24)
    s_barrier
    s_add_u32 m0, s60, 32768
    ds_read_b64_tr_b16 v[0:1], v58 offset:24832
    ds_read_b64_tr_b16 v[2:3], v58 offset:26880
    buffer_load_dwordx4 v36, s[36:39], s58 offen offset:0 lds
    v_max3_f32 v108, v108, v197, v198
    v_mfma_f32_32x32x16_bf16 a[16:31], v[4:7], v[228:231], a[16:31]
    ds_read_b64_tr_b16 v[4:5], v59 offset:24832
    ds_read_b64_tr_b16 v[6:7], v59 offset:26880
    v_max3_f32 v108, v108, v199, v200
    s_waitcnt lgkmcnt(8)
    v_mfma_f32_32x32x16_bf16 a[32:47], v[8:11], v[228:231], a[32:47]
    ds_read_b128 v[8:11], v81 offset:32768
    v_max3_f32 v108, v108, v201, v202
    v_mfma_f32_32x32x16_bf16 a[48:63], v[12:15], v[228:231], a[48:63]
    ds_read_b128 v[12:15], v82 offset:32768
    buffer_load_dwordx4 v37, s[36:39], s58 offen offset:1024 lds
    v_max3_f32 v108, v108, v203, v204
    s_waitcnt lgkmcnt(6)
    v_mfma_f32_32x32x16_bf16 a[64:79], v[16:19], v[228:231], a[64:79]
    ds_read_b128 v[16:19], v83 offset:32768
    v_max3_f32 v108, v108, v205, v206
    v_mfma_f32_32x32x16_bf16 a[80:95], v[20:23], v[228:231], a[80:95]
    ds_read_b128 v[20:23], v84 offset:32768
    v_max_f32 v108, v108, v207
    s_waitcnt lgkmcnt(4)
    v_mfma_f32_32x32x16_bf16 a[96:111], v[0:3], v[228:231], a[96:111]
    ds_read_b128 v[0:3], v85 offset:32768
    buffer_load_dwordx4 v38, s[36:39], s58 offen offset:2048 lds
    v_cmp_lt_f32 vcc, s66, v108
    v_mfma_f32_32x32x16_bf16 a[112:127], v[4:7], v[228:231], a[112:127]
    ds_read_b128 v[4:7], v86 offset:32768
    s_cbranch_vccnz L1_tr4
L1_bk4:
    s_waitcnt lgkmcnt(4)
    v_mfma_f32_32x32x16_bf16 v[208:223], v[8:11], v[128:131], v[112:127]
    ds_read_b128 v[8:11], v87 offset:32768
    s_add_u32 s61, s69, 24576
    buffer_store_dwordx4 a[176:179], v97, s[48:51], s61 offen offset:0 sc1
    v_exp_f32 v192, v192
    v_exp_f32 v193, v193
    v_mfma_f32_32x32x16_bf16 v[208:223], v[12:15], v[132:135], v[208:223]
    ds_read_b128 v[12:15], v88 offset:32768
    buffer_load_dwordx4 v39, s[36:39], s58 offen offset:3072 lds
    v_add_f32 v98, v98, v192
    v_add_f32 v98, v98, v193
    s_waitcnt lgkmcnt(4)
    v_mfma_f32_32x32x16_bf16 v[208:223], v[16:19], v[136:139], v[208:223]
    ds_read_b128 v[16:19], v81 offset:33024
    v_cvt_pk_bf16_f32 v224, v192, v193
    v_exp_f32 v194, v194
    v_mfma_f32_32x32x16_bf16 v[208:223], v[20:23], v[140:143], v[208:223]
    ds_read_b128 v[20:23], v82 offset:33024
    v_exp_f32 v195, v195
    v_add_f32 v98, v98, v194
    s_waitcnt lgkmcnt(4)
    v_mfma_f32_32x32x16_bf16 v[208:223], v[0:3], v[144:147], v[208:223]
    s_add_u32 m0, s60, 36864
    ds_read_b128 v[0:3], v83 offset:33024
    buffer_load_dwordx4 v40, s[36:39], s58 offen offset:0 lds
    v_add_f32 v98, v98, v195
    v_cvt_pk_bf16_f32 v225, v194, v195
    v_mfma_f32_32x32x16_bf16 v[208:223], v[4:7], v[148:151], v[208:223]
    ds_read_b128 v[4:7], v84 offset:33024
    v_exp_f32 v196, v196
    v_exp_f32 v197, v197
    s_waitcnt lgkmcnt(4)
    v_mfma_f32_32x32x16_bf16 v[208:223], v[8:11], v[152:155], v[208:223]
    ds_read_b128 v[8:11], v85 offset:33024
    v_add_f32 v98, v98, v196
    v_add_f32 v98, v98, v197
    v_mfma_f32_32x32x16_bf16 v[208:223], v[12:15], v[156:159], v[208:223]
    ds_read_b128 v[12:15], v86 offset:33024
    buffer_load_dwordx4 v41, s[36:39], s58 offen offset:1024 lds
    v_cvt_pk_bf16_f32 v226, v196, v197
    v_exp_f32 v198, v198
    s_waitcnt lgkmcnt(4)
    v_mfma_f32_32x32x16_bf16 v[208:223], v[16:19], v[160:163], v[208:223]
    ds_read_b128 v[16:19], v87 offset:33024
    v_exp_f32 v199, v199
    v_add_f32 v98, v98, v198
    v_mfma_f32_32x32x16_bf16 v[208:223], v[20:23], v[164:167], v[208:223]
    ds_read_b128 v[20:23], v88 offset:33024
    v_add_f32 v98, v98, v199
    v_cvt_pk_bf16_f32 v227, v198, v199
    s_waitcnt lgkmcnt(4)
    v_mfma_f32_32x32x16_bf16 v[208:223], v[0:3], v[168:171], v[208:223]
    ds_read_b64_tr_b16 v[0:1], v56 offset:49152
    ds_read_b64_tr_b16 v[2:3], v56 offset:51200
    buffer_load_dwordx4 v42, s[36:39], s58 offen offset:2048 lds
    v_exp_f32 v200, v200
    v_exp_f32 v201, v201
    v_mfma_f32_32x32x16_bf16 v[208:223], v[4:7], v[172:175], v[208:223]
    ds_read_b64_tr_b16 v[4:5], v57 offset:49152
    ds_read_b64_tr_b16 v[6:7], v57 offset:51200
    s_add_u32 s61, s69, 24576
    buffer_store_dwordx4 a[180:183], v97, s[48:51], s61 offen offset:1024 sc1
    v_add_f32 v98, v98, v200
    v_add_f32 v98, v98, v201
    s_waitcnt lgkmcnt(6)
    v_mfma_f32_32x32x16_bf16 v[208:223], v[8:11], v[176:179], v[208:223]
    ds_read_b64_tr_b16 v[8:9], v58 offset:49152
    ds_read_b64_tr_b16 v[10:11], v58 offset:51200
    v_cvt_pk_bf16_f32 v228, v200, v201
    v_mfma_f32_32x32x16_bf16 v[208:223], v[12:15], v[180:183], v[208:223]
    ds_read_b64_tr_b16 v[12:13], v59 offset:49152
    ds_read_b64_tr_b16 v[14:15], v59 offset:51200
    buffer_load_dwordx4 v43, s[36:39], s58 offen offset:3072 lds
    s_add_u32 s58, s58, 0x4000
    v_exp_f32 v202, v202
    v_exp_f32 v203, v203
    s_waitcnt lgkmcnt(8)
    v_mfma_f32_32x32x16_bf16 v[208:223], v[16:19], v[184:187], v[208:223]
    ds_read_b64_tr_b16 v[16:17], v56 offset:49408
    ds_read_b64_tr_b16 v[18:19], v56 offset:51456
    v_add_f32 v98, v98, v202
    v_add_f32 v98, v98, v203
    v_mfma_f32_32x32x16_bf16 v[208:223], v[20:23], v[188:191], v[208:223]
    ds_read_b64_tr_b16 v[20:21], v57 offset:49408
    ds_read_b64_tr_b16 v[22:23], v57 offset:51456
    v_cvt_pk_bf16_f32 v229, v202, v203
    s_waitcnt lgkmcnt(8)
    v_mfma_f32_32x32x16_bf16 a[0:15], v[0:3], v[224:227], a[0:15]
    ds_read_b64_tr_b16 v[0:1], v58 offset:49408
    ds_read_b64_tr_b16 v[2:3], v58 offset:51456
    v_exp_f32 v204, v204
    v_exp_f32 v205, v205
    v_mfma_f32_32x32x16_bf16 a[16:31], v[4:7], v[224:227], a[16:31]
    ds_read_b64_tr_b16 v[4:5], v59 offset:49408
    ds_read_b64_tr_b16 v[6:7], v59 offset:51456
    v_add_f32 v98, v98, v204
    v_add_f32 v98, v98, v205
    s_waitcnt lgkmcnt(8)
    v_mfma_f32_32x32x16_bf16 a[32:47], v[8:11], v[224:227], a[32:47]
    ds_read_b64_tr_b16 v[8:9], v56 offset:57344
    ds_read_b64_tr_b16 v[10:11], v56 offset:59392
    v_cvt_pk_bf16_f32 v230, v204, v205
    v_mfma_f32_32x32x16_bf16 a[48:63], v[12:15], v[224:227], a[48:63]
    ds_read_b64_tr_b16 v[12:13], v57 offset:57344
    ds_read_b64_tr_b16 v[14:15], v57 offset:59392
    v_exp_f32 v206, v206
    v_exp_f32 v207, v207
    s_waitcnt lgkmcnt(8)
    v_mfma_f32_32x32x16_bf16 a[64:79], v[16:19], v[224:227], a[64:79]
    ds_read_b64_tr_b16 v[16:17], v58 offset:57344
    ds_read_b64_tr_b16 v[18:19], v58 offset:59392
    v_add_f32 v98, v98, v206
    v_add_f32 v98, v98, v207
    v_mfma_f32_32x32x16_bf16 a[80:95], v[20:23], v[224:227], a[80:95]
    ds_read_b64_tr_b16 v[20:21], v59 offset:57344
    ds_read_b64_tr_b16 v[22:23], v59 offset:59392
    v_cvt_pk_bf16_f32 v231, v206, v207
    s_waitcnt lgkmcnt(8)
    v_mfma_f32_32x32x16_bf16 a[96:111], v[0:3], v[224:227], a[96:111]
    ds_read_b64_tr_b16 v[0:1], v56 offset:57600
    ds_read_b64_tr_b16 v[2:3], v56 offset:59648
    s_add_u32 s61, s69, 24576
    buffer_store_dwordx4 a[184:187], v97, s[48:51], s61 offen offset:2048 sc1
    v_max3_f32 v108, v208, v209, v210
    v_mfma_f32_32x32x16_bf16 a[112:127], v[4:7], v[224:227], a[112:127]
    ds_read_b64_tr_b16 v[4:5], v57 offset:57600
    ds_read_b64_tr_b16 v[6:7], v57 offset:59648
    v_max3_f32 v108, v108, v211, v212
    s_waitcnt lgkmcnt(8)
    v_mfma_f32_32x32x16_bf16 a[0:15], v[8:11], v[228:231], a[0:15]
    s_waitcnt vmcnt(23)
    s_barrier
    s_add_u32 m0, s60, 65536
    ds_read_b64_tr_b16 v[8:9], v58 offset:57600
    ds_read_b64_tr_b16 v[10:11], v58 offset:59648
    buffer_load_dwordx4 v36, s[36:39], s58 offen offset:0 lds
    v_max3_f32 v108, v108, v213, v214
    v_mfma_f32_32x32x16_bf16 a[16:31], v[12:15], v[228:231], a[16:31]
    ds_read_b64_tr_b16 v[12:13], v59 offset:57600
    ds_read_b64_tr_b16 v[14:15], v59 offset:59648
    v_max3_f32 v108, v108, v215, v216
    s_waitcnt lgkmcnt(8)
    v_mfma_f32_32x32x16_bf16 a[32:47], v[16:19], v[228:231], a[32:47]
    ds_read_b128 v[16:19], v89 offset:0
    v_max3_f32 v108, v108, v217, v218
    v_mfma_f32_32x32x16_bf16 a[48:63], v[20:23], v[228:231], a[48:63]
    ds_read_b128 v[20:23], v90 offset:0
    buffer_load_dwordx4 v37, s[36:39], s58 offen offset:1024 lds
    v_max3_f32 v108, v108, v219, v220
    s_waitcnt lgkmcnt(6)
    v_mfma_f32_32x32x16_bf16 a[64:79], v[0:3], v[228:231], a[64:79]
    ds_read_b128 v[0:3], v91 offset:0
    v_max3_f32 v108, v108, v221, v222
    v_mfma_f32_32x32x16_bf16 a[80:95], v[4:7], v[228:231], a[80:95]
    ds_read_b128 v[4:7], v92 offset:0
    v_max_f32 v108, v108, v223
    s_waitcnt lgkmcnt(4)
    v_mfma_f32_32x32x16_bf16 a[96:111], v[8:11], v[228:231], a[96:111]
    ds_read_b128 v[8:11], v93 offset:0
    buffer_load_dwordx4 v38, s[36:39], s58 offen offset:2048 lds
    v_cmp_lt_f32 vcc, s66, v108
    v_mfma_f32_32x32x16_bf16 a[112:127], v[12:15], v[228:231], a[112:127]
    ds_read_b128 v[12:15], v94 offset:0
    s_cbranch_vccnz L1_tr5
L1_bk5:
    s_waitcnt lgkmcnt(4)
    v_mfma_f32_32x32x16_bf16 v[192:207], v[16:19], v[128:131], v[112:127]
    ds_read_b128 v[16:19], v95 offset:0
    v_exp_f32 v208, v208
    v_exp_f32 v209, v209
    v_mfma_f32_32x32x16_bf16 v[192:207], v[20:23], v[132:135], v[192:207]
    ds_read_b128 v[20:23], v96 offset:0
    buffer_load_dwordx4 v39, s[36:39], s58 offen offset:3072 lds
    s_add_u32 s61, s69, 24576
    buffer_store_dwordx4 a[188:191], v97, s[48:51], s61 offen offset:3072 sc1
    v_add_f32 v98, v98, v208
    v_add_f32 v98, v98, v209
    s_waitcnt lgkmcnt(4)
    v_mfma_f32_32x32x16_bf16 v[192:207], v[0:3], v[136:139], v[192:207]
    ds_read_b128 v[0:3], v89 offset:256
    v_cvt_pk_bf16_f32 v224, v208, v209
    v_exp_f32 v210, v210
    v_mfma_f32_32x32x16_bf16 v[192:207], v[4:7], v[140:143], v[192:207]
    ds_read_b128 v[4:7], v90 offset:256
    v_exp_f32 v211, v211
    v_add_f32 v98, v98, v210
    s_waitcnt lgkmcnt(4)
    v_mfma_f32_32x32x16_bf16 v[192:207], v[8:11], v[144:147], v[192:207]
    s_add_u32 m0, s60, 69632
    ds_read_b128 v[8:11], v91 offset:256
    buffer_load_dwordx4 v40, s[36:39], s58 offen offset:0 lds
    v_add_f32 v98, v98, v211
    v_cvt_pk_bf16_f32 v225, v210, v211
    v_mfma_f32_32x32x16_bf16 v[192:207], v[12:15], v[148:151], v[192:207]
    ds_read_b128 v[12:15], v92 offset:256
    v_exp_f32 v212, v212
    v_exp_f32 v213, v213
    s_waitcnt lgkmcnt(4)
    v_mfma_f32_32x32x16_bf16 v[192:207], v[16:19], v[152:155], v[192:207]
    ds_read_b128 v[16:19], v93 offset:256
    v_add_f32 v98, v98, v212
    v_add_f32 v98, v98, v213
    v_mfma_f32_32x32x16_bf16 v[192:207], v[20:23], v[156:159], v[192:207]
    ds_read_b128 v[20:23], v94 offset:256
    buffer_load_dwordx4 v41, s[36:39], s58 offen offset:1024 lds
    v_cvt_pk_bf16_f32 v226, v212, v213
    v_exp_f32 v214, v214
    s_waitcnt lgkmcnt(4)
    v_mfma_f32_32x32x16_bf16 v[192:207], v[0:3], v[160:163], v[192:207]
    ds_read_b128 v[0:3], v95 offset:256
    v_exp_f32 v215, v215
    v_add_f32 v98, v98, v214
    v_mfma_f32_32x32x16_bf16 v[192:207], v[4:7], v[164:167], v[192:207]
    ds_read_b128 v[4:7], v96 offset:256
    v_add_f32 v98, v98, v215
    v_cvt_pk_bf16_f32 v227, v214, v215
    s_waitcnt lgkmcnt(4)
    v_mfma_f32_32x32x16_bf16 v[192:207], v[8:11], v[168:171], v[192:207]
    ds_read_b64_tr_b16 v[8:9], v60 offset:16384
    ds_read_b64_tr_b16 v[10:11], v60 offset:18432
    buffer_load_dwordx4 v42, s[36:39], s58 offen offset:2048 lds
    v_exp_f32 v216, v216
    v_exp_f32 v217, v217
    v_mfma_f32_32x32x16_bf16 v[192:207], v[12:15], v[172:175], v[192:207]
    ds_read_b64_tr_b16 v[12:13], v61 offset:16384
    ds_read_b64_tr_b16 v[14:15], v61 offset:18432
    v_add_f32 v98, v98, v216
    v_add_f32 v98, v98, v217
    s_waitcnt lgkmcnt(6)
    v_mfma_f32_32x32x16_bf16 v[192:207], v[16:19], v[176:179], v[192:207]
    ds_read_b64_tr_b16 v[16:17], v62 offset:16384
    ds_read_b64_tr_b16 v[18:19], v62 offset:18432
    v_cvt_pk_bf16_f32 v228, v216, v217
    v_mfma_f32_32x32x16_bf16 v[192:207], v[20:23], v[180:183], v[192:207]
    ds_read_b64_tr_b16 v[20:21], v63 offset:16384
    ds_read_b64_tr_b16 v[22:23], v63 offset:18432
    buffer_load_dwordx4 v43, s[36:39], s58 offen offset:3072 lds
    s_add_u32 s58, s58, 0x4000
    v_exp_f32 v218, v218
    v_exp_f32 v219, v219
    s_waitcnt lgkmcnt(8)
    v_mfma_f32_32x32x16_bf16 v[192:207], v[0:3], v[184:187], v[192:207]
    ds_read_b64_tr_b16 v[0:1], v60 offset:16640
    ds_read_b64_tr_b16 v[2:3], v60 offset:18688
    v_add_f32 v98, v98, v218
    v_add_f32 v98, v98, v219
    v_mfma_f32_32x32x16_bf16 v[192:207], v[4:7], v[188:191], v[192:207]
    ds_read_b64_tr_b16 v[4:5], v61 offset:16640
    ds_read_b64_tr_b16 v[6:7], v61 offset:18688
    v_cvt_pk_bf16_f32 v229, v218, v219
    s_waitcnt lgkmcnt(8)
    v_mfma_f32_32x32x16_bf16 a[0:15], v[8:11], v[224:227], a[0:15]
    ds_read_b64_tr_b16 v[8:9], v62 offset:16640
    ds_read_b64_tr_b16 v[10:11], v62 offset:18688
    v_exp_f32 v220, v220
    v_exp_f32 v221, v221
    v_mfma_f32_32x32x16_bf16 a[16:31], v[12:15], v[224:227], a[16:31]
    ds_read_b64_tr_b16 v[12:13], v63 offset:16640
    ds_read_b64_tr_b16 v[14:15], v63 offset:18688
    v_add_f32 v98, v98, v220
    v_add_f32 v98, v98, v221
    s_waitcnt lgkmcnt(8)
    v_mfma_f32_32x32x16_bf16 a[32:47], v[16:19], v[224:227], a[32:47]
    ds_read_b64_tr_b16 v[16:17], v60 offset:24576
    ds_read_b64_tr_b16 v[18:19], v60 offset:26624
    v_cvt_pk_bf16_f32 v230, v220, v221
    v_mfma_f32_32x32x16_bf16 a[48:63], v[20:23], v[224:227], a[48:63]
    ds_read_b64_tr_b16 v[20:21], v61 offset:24576
    ds_read_b64_tr_b16 v[22:23], v61 offset:26624
    v_exp_f32 v222, v222
    v_exp_f32 v223, v223
    s_waitcnt lgkmcnt(8)
    v_mfma_f32_32x32x16_bf16 a[64:79], v[0:3], v[224:227], a[64:79]
    ds_read_b64_tr_b16 v[0:1], v62 offset:24576
    ds_read_b64_tr_b16 v[2:3], v62 offset:26624
    v_add_f32 v98, v98, v222
    v_add_f32 v98, v98, v223
    v_mfma_f32_32x32x16_bf16 a[80:95], v[4:7], v[224:227], a[80:95]
    ds_read_b64_tr_b16 v[4:5], v63 offset:24576
    ds_read_b64_tr_b16 v[6:7], v63 offset:26624
    v_cvt_pk_bf16_f32 v231, v222, v223
    s_waitcnt lgkmcnt(8)
    v_mfma_f32_32x32x16_bf16 a[96:111], v[8:11], v[224:227], a[96:111]
    ds_read_b64_tr_b16 v[8:9], v60 offset:24832
    ds_read_b64_tr_b16 v[10:11], v60 offset:26880
    v_max3_f32 v108, v192, v193, v194
    v_mfma_f32_32x32x16_bf16 a[112:127], v[12:15], v[224:227], a[112:127]
    ds_read_b64_tr_b16 v[12:13], v61 offset:24832
    ds_read_b64_tr_b16 v[14:15], v61 offset:26880
    v_max3_f32 v108, v108, v195, v196
    s_waitcnt lgkmcnt(8)
    v_mfma_f32_32x32x16_bf16 a[0:15], v[16:19], v[228:231], a[0:15]
    s_waitcnt vmcnt(21)
    s_barrier
    s_add_u32 m0, s60, 98304
    ds_read_b64_tr_b16 v[16:17], v62 offset:24832
    ds_read_b64_tr_b16 v[18:19], v62 offset:26880
    buffer_load_dwordx4 v36, s[36:39], s58 offen offset:0 lds
    v_max3_f32 v108, v108, v197, v198
    v_mfma_f32_32x32x16_bf16 a[16:31], v[20:23], v[228:231], a[16:31]
    ds_read_b64_tr_b16 v[20:21], v63 offset:24832
    ds_read_b64_tr_b16 v[22:23], v63 offset:26880
    v_max3_f32 v108, v108, v199, v200
    s_waitcnt lgkmcnt(8)
    v_mfma_f32_32x32x16_bf16 a[32:47], v[0:3], v[228:231], a[32:47]
    ds_read_b128 v[0:3], v73 offset:0
    v_max3_f32 v108, v108, v201, v202
    v_mfma_f32_32x32x16_bf16 a[48:63], v[4:7], v[228:231], a[48:63]
    ds_read_b128 v[4:7], v74 offset:0
    buffer_load_dwordx4 v37, s[36:39], s58 offen offset:1024 lds
    v_max3_f32 v108, v108, v203, v204
    s_waitcnt lgkmcnt(6)
    v_mfma_f32_32x32x16_bf16 a[64:79], v[8:11], v[228:231], a[64:79]
    ds_read_b128 v[8:11], v75 offset:0
    v_max3_f32 v108, v108, v205, v206
    v_mfma_f32_32x32x16_bf16 a[80:95], v[12:15], v[228:231], a[80:95]
    ds_read_b128 v[12:15], v76 offset:0
    v_max_f32 v108, v108, v207
    s_waitcnt lgkmcnt(4)
    v_mfma_f32_32x32x16_bf16 a[96:111], v[16:19], v[228:231], a[96:111]
    ds_read_b128 v[16:19], v77 offset:0
    buffer_load_dwordx4 v38, s[36:39], s58 offen offset:2048 lds
    v_cmp_lt_f32 vcc, s66, v108
    v_mfma_f32_32x32x16_bf16 a[112:127], v[20:23], v[228:231], a[112:127]
    ds_read_b128 v[20:23], v78 offset:0
    s_cbranch_vccnz L1_tr6
L1_bk6:
    s_waitcnt lgkmcnt(4)
    v_mfma_f32_32x32x16_bf16 v[208:223], v[0:3], v[128:131], v[112:127]
    ds_read_b128 v[0:3], v79 offset:0
    v_exp_f32 v192, v192
    v_exp_f32 v193, v193
    v_mfma_f32_32x32x16_bf16 v[208:223], v[4:7], v[132:135], v[208:223]
    ds_read_b128 v[4:7], v80 offset:0
    buffer_load_dwordx4 v39, s[36:39], s58 offen offset:3072 lds
    v_add_f32 v98, v98, v192
    v_add_f32 v98, v98, v193
    s_waitcnt lgkmcnt(4)
    v_mfma_f32_32x32x16_bf16 v[208:223], v[8:11], v[136:139], v[208:223]
    ds_read_b128 v[8:11], v73 offset:256
    v_cvt_pk_bf16_f32 v224, v192, v193
    v_exp_f32 v194, v194
    v_mfma_f32_32x32x16_bf16 v[208:223], v[12:15], v[140:143], v[208:223]
    ds_read_b128 v[12:15], v74 offset:256
    v_exp_f32 v195, v195
    v_add_f32 v98, v98, v194
    s_waitcnt lgkmcnt(4)
    v_mfma_f32_32x32x16_bf16 v[208:223], v[16:19], v[144:147], v[208:223]
    s_add_u32 m0, s60, 102400
    ds_read_b128 v[16:19], v75 offset:256
    buffer_load_dwordx4 v40, s[36:39], s58 offen offset:0 lds
    v_add_f32 v98, v98, v195
    v_cvt_pk_bf16_f32 v225, v194, v195
    v_mfma_f32_32x32x16_bf16 v[208:223], v[20:23], v[148:151], v[208:223]
    ds_read_b128 v[20:23], v76 offset:256
    v_exp_f32 v196, v196
    v_exp_f32 v197, v197
    s_waitcnt lgkmcnt(4)
    v_mfma_f32_32x32x16_bf16 v[208:223], v[0:3], v[152:155], v[208:223]
    ds_read_b128 v[0:3], v77 offset:256
    v_add_f32 v98, v98, v196
    v_add_f32 v98, v98, v197
    v_mfma_f32_32x32x16_bf16 v[208:223], v[4:7], v[156:159], v[208:223]
    ds_read_b128 v[4:7], v78 offset:256
    buffer_load_dwordx4 v41, s[36:39], s58 offen offset:1024 lds
    v_cvt_pk_bf16_f32 v226, v196, v197
    v_exp_f32 v198, v198
    s_waitcnt lgkmcnt(4)
    v_mfma_f32_32x32x16_bf16 v[208:223], v[8:11], v[160:163], v[208:223]
    ds_read_b128 v[8:11], v79 offset:256
    v_exp_f32 v199, v199
    v_add_f32 v98, v98, v198
    v_mfma_f32_32x32x16_bf16 v[208:223], v[12:15], v[164:167], v[208:223]
    ds_read_b128 v[12:15], v80 offset:256
    v_add_f32 v98, v98, v199
    v_cvt_pk_bf16_f32 v227, v198, v199
    v_cmp_eq_u32 vcc, 0, v28
    s_nop 1
    s_cbranch_vccnz L1_spn
L1_spn_b:
    s_waitcnt vmcnt(10)
    buffer_store_dword v28, v99, s[48:51], s16 offen sc1
    s_waitcnt lgkmcnt(4)
    v_mfma_f32_32x32x16_bf16 v[208:223], v[16:19], v[168:171], v[208:223]
    ds_read_b64_tr_b16 v[16:17], v52 offset:16384
    ds_read_b64_tr_b16 v[18:19], v52 offset:18432
    buffer_load_dwordx4 v42, s[36:39], s58 offen offset:2048 lds
    v_exp_f32 v200, v200
    v_exp_f32 v201, v201
    v_mfma_f32_32x32x16_bf16 v[208:223], v[20:23], v[172:175], v[208:223]
    ds_read_b64_tr_b16 v[20:21], v53 offset:16384
    ds_read_b64_tr_b16 v[22:23], v53 offset:18432
    v_add_f32 v98, v98, v200
    v_add_f32 v98, v98, v201
    s_waitcnt lgkmcnt(6)
    v_mfma_f32_32x32x16_bf16 v[208:223], v[0:3], v[176:179], v[208:223]
    ds_read_b64_tr_b16 v[0:1], v54 offset:16384
    ds_read_b64_tr_b16 v[2:3], v54 offset:18432
    v_cvt_pk_bf16_f32 v228, v200, v201
    v_mfma_f32_32x32x16_bf16 v[208:223], v[4:7], v[180:183], v[208:223]
    ds_read_b64_tr_b16 v[4:5], v55 offset:16384
    ds_read_b64_tr_b16 v[6:7], v55 offset:18432
    buffer_load_dwordx4 v43, s[36:39], s58 offen offset:3072 lds
    s_add_u32 s58, s58, 0x4000
    v_exp_f32 v202, v202
    v_exp_f32 v203, v203
    s_waitcnt lgkmcnt(8)
    v_mfma_f32_32x32x16_bf16 v[208:223], v[8:11], v[184:187], v[208:223]
    ds_read_b64_tr_b16 v[8:9], v52 offset:16640
    ds_read_b64_tr_b16 v[10:11], v52 offset:18688
    v_add_f32 v98, v98, v202
    v_add_f32 v98, v98, v203
    v_mfma_f32_32x32x16_bf16 v[208:223], v[12:15], v[188:191], v[208:223]
    ds_read_b64_tr_b16 v[12:13], v53 offset:16640
    ds_read_b64_tr_b16 v[14:15], v53 offset:18688
    v_cvt_pk_bf16_f32 v229, v202, v203
    s_waitcnt lgkmcnt(8)
    v_mfma_f32_32x32x16_bf16 a[0:15], v[16:19], v[224:227], a[0:15]
    ds_read_b64_tr_b16 v[16:17], v54 offset:16640
    ds_read_b64_tr_b16 v[18:19], v54 offset:18688
    v_exp_f32 v204, v204
    v_exp_f32 v205, v205
    v_mfma_f32_32x32x16_bf16 a[16:31], v[20:23], v[224:227], a[16:31]
    ds_read_b64_tr_b16 v[20:21], v55 offset:16640
    ds_read_b64_tr_b16 v[22:23], v55 offset:18688
    v_add_f32 v98, v98, v204
    v_add_f32 v98, v98, v205
    s_waitcnt lgkmcnt(8)
    v_mfma_f32_32x32x16_bf16 a[32:47], v[0:3], v[224:227], a[32:47]
    ds_read_b64_tr_b16 v[0:1], v52 offset:24576
    ds_read_b64_tr_b16 v[2:3], v52 offset:26624
    v_cvt_pk_bf16_f32 v230, v204, v205
    v_mfma_f32_32x32x16_bf16 a[48:63], v[4:7], v[224:227], a[48:63]
    ds_read_b64_tr_b16 v[4:5], v53 offset:24576
    ds_read_b64_tr_b16 v[6:7], v53 offset:26624
    v_exp_f32 v206, v206
    v_exp_f32 v207, v207
    s_waitcnt lgkmcnt(8)
    v_mfma_f32_32x32x16_bf16 a[64:79], v[8:11], v[224:227], a[64:79]
    ds_read_b64_tr_b16 v[8:9], v54 offset:24576
    ds_read_b64_tr_b16 v[10:11], v54 offset:26624
    v_add_f32 v98, v98, v206
    v_add_f32 v98, v98, v207
    v_mfma_f32_32x32x16_bf16 a[80:95], v[12:15], v[224:227], a[80:95]
    ds_read_b64_tr_b16 v[12:13], v55 offset:24576
    ds_read_b64_tr_b16 v[14:15], v55 offset:26624
    v_cvt_pk_bf16_f32 v231, v206, v207
    s_waitcnt lgkmcnt(8)
    v_mfma_f32_32x32x16_bf16 a[96:111], v[16:19], v[224:227], a[96:111]
    ds_read_b64_tr_b16 v[16:17], v52 offset:24832
    ds_read_b64_tr_b16 v[18:19], v52 offset:26880
    v_max3_f32 v108, v208, v209, v210
    v_mfma_f32_32x32x16_bf16 a[112:127], v[20:23], v[224:227], a[112:127]
    ds_read_b64_tr_b16 v[20:21], v53 offset:24832
    ds_read_b64_tr_b16 v[22:23], v53 offset:26880
    v_max3_f32 v108, v108, v211, v212
    s_waitcnt lgkmcnt(8)
    v_mfma_f32_32x32x16_bf16 a[0:15], v[0:3], v[228:231], a[0:15]
    s_barrier
    s_add_u32 m0, s60, 131072
    ds_read_b64_tr_b16 v[0:1], v54 offset:24832
    ds_read_b64_tr_b16 v[2:3], v54 offset:26880
    buffer_load_dwordx4 v36, s[36:39], s58 offen offset:0 lds
    v_max3_f32 v108, v108, v213, v214
    v_mfma_f32_32x32x16_bf16 a[16:31], v[4:7], v[228:231], a[16:31]
    ds_read_b64_tr_b16 v[4:5], v55 offset:24832
    ds_read_b64_tr_b16 v[6:7], v55 offset:26880
    v_max3_f32 v108, v108, v215, v216
    s_waitcnt lgkmcnt(8)
    v_mfma_f32_32x32x16_bf16 a[32:47], v[8:11], v[228:231], a[32:47]
    ds_read_b128 v[8:11], v73 offset:32768
    v_max3_f32 v108, v108, v217, v218
    v_mfma_f32_32x32x16_bf16 a[48:63], v[12:15], v[228:231], a[48:63]
    ds_read_b128 v[12:15], v74 offset:32768
    buffer_load_dwordx4 v37, s[36:39], s58 offen offset:1024 lds
    v_max3_f32 v108, v108, v219, v220
    s_waitcnt lgkmcnt(6)
    v_mfma_f32_32x32x16_bf16 a[64:79], v[16:19], v[228:231], a[64:79]
    ds_read_b128 v[16:19], v75 offset:32768
    v_max3_f32 v108, v108, v221, v222
    v_mfma_f32_32x32x16_bf16 a[80:95], v[20:23], v[228:231], a[80:95]
    ds_read_b128 v[20:23], v76 offset:32768
    v_max_f32 v108, v108, v223
    buffer_load_dword v29, v100, s[48:51], s17 offen sc1
    s_waitcnt lgkmcnt(4)
    v_mfma_f32_32x32x16_bf16 a[96:111], v[0:3], v[228:231], a[96:111]
    ds_read_b128 v[0:3], v77 offset:32768
    buffer_load_dwordx4 v38, s[36:39], s58 offen offset:2048 lds
    v_cmp_lt_f32 vcc, s66, v108
    v_mfma_f32_32x32x16_bf16 a[112:127], v[4:7], v[228:231], a[112:127]
    ds_read_b128 v[4:7], v78 offset:32768
    s_cbranch_vccnz L1_tr7
L1_bk7:
    s_waitcnt lgkmcnt(4)
    v_mfma_f32_32x32x16_bf16 v[192:207], v[8:11], v[128:131], v[112:127]
    ds_read_b128 v[8:11], v79 offset:32768
    v_exp_f32 v208, v208
    v_exp_f32 v209, v209
    v_mfma_f32_32x32x16_bf16 v[192:207], v[12:15], v[132:135], v[192:207]
    ds_read_b128 v[12:15], v80 offset:32768
    buffer_load_dwordx4 v39, s[36:39], s58 offen offset:3072 lds
    v_add_f32 v98, v98, v208
    v_add_f32 v98, v98, v209
    s_waitcnt lgkmcnt(4)
    v_mfma_f32_32x32x16_bf16 v[192:207], v[16:19], v[136:139], v[192:207]
    ds_read_b128 v[16:19], v73 offset:33024
    v_cvt_pk_bf16_f32 v224, v208, v209
    v_exp_f32 v210, v210
    v_mfma_f32_32x32x16_bf16 v[192:207], v[20:23], v[140:143], v[192:207]
    ds_read_b128 v[20:23], v74 offset:33024
    v_exp_f32 v211, v211
    v_add_f32 v98, v98, v210
    s_waitcnt lgkmcnt(4)
    v_mfma_f32_32x32x16_bf16 v[192:207], v[0:3], v[144:147], v[192:207]
    s_add_u32 m0, s60, 135168
    ds_read_b128 v[0:3], v75 offset:33024
    buffer_load_dwordx4 v40, s[36:39], s58 offen offset:0 lds
    v_add_f32 v98, v98, v211
    v_cvt_pk_bf16_f32 v225, v210, v211
    v_mfma_f32_32x32x16_bf16 v[192:207], v[4:7], v[148:151], v[192:207]
    ds_read_b128 v[4:7], v76 offset:33024
    v_exp_f32 v212, v212
    v_exp_f32 v213, v213
    s_waitcnt lgkmcnt(4)
    v_mfma_f32_32x32x16_bf16 v[192:207], v[8:11], v[152:155], v[192:207]
    ds_read_b128 v[8:11], v77 offset:33024
    v_add_f32 v98, v98, v212
    v_add_f32 v98, v98, v213
    v_mfma_f32_32x32x16_bf16 v[192:207], v[12:15], v[156:159], v[192:207]
    ds_read_b128 v[12:15], v78 offset:33024
    buffer_load_dwordx4 v41, s[36:39], s58 offen offset:1024 lds
    v_cvt_pk_bf16_f32 v226, v212, v213
    v_exp_f32 v214, v214
    s_waitcnt lgkmcnt(4)
    v_mfma_f32_32x32x16_bf16 v[192:207], v[16:19], v[160:163], v[192:207]
    ds_read_b128 v[16:19], v79 offset:33024
    v_exp_f32 v215, v215
    v_add_f32 v98, v98, v214
    v_mfma_f32_32x32x16_bf16 v[192:207], v[20:23], v[164:167], v[192:207]
    ds_read_b128 v[20:23], v80 offset:33024
    v_add_f32 v98, v98, v215
    v_cvt_pk_bf16_f32 v227, v214, v215
    s_waitcnt lgkmcnt(4)
    v_mfma_f32_32x32x16_bf16 v[192:207], v[0:3], v[168:171], v[192:207]
    ds_read_b64_tr_b16 v[0:1], v52 offset:49152
    ds_read_b64_tr_b16 v[2:3], v52 offset:51200
    buffer_load_dwordx4 v42, s[36:39], s58 offen offset:2048 lds
    v_exp_f32 v216, v216
    v_exp_f32 v217, v217
    v_mfma_f32_32x32x16_bf16 v[192:207], v[4:7], v[172:175], v[192:207]
    ds_read_b64_tr_b16 v[4:5], v53 offset:49152
    ds_read_b64_tr_b16 v[6:7], v53 offset:51200
    v_add_f32 v98, v98, v216
    v_add_f32 v98, v98, v217
    s_waitcnt lgkmcnt(6)
    v_mfma_f32_32x32x16_bf16 v[192:207], v[8:11], v[176:179], v[192:207]
    ds_read_b64_tr_b16 v[8:9], v54 offset:49152
    ds_read_b64_tr_b16 v[10:11], v54 offset:51200
    v_cvt_pk_bf16_f32 v228, v216, v217
    v_mfma_f32_32x32x16_bf16 v[192:207], v[12:15], v[180:183], v[192:207]
    ds_read_b64_tr_b16 v[12:13], v55 offset:49152
    ds_read_b64_tr_b16 v[14:15], v55 offset:51200
    buffer_load_dwordx4 v43, s[36:39], s58 offen offset:3072 lds
    s_add_u32 s58, s58, 0x4000
    v_exp_f32 v218, v218
    v_exp_f32 v219, v219
    s_waitcnt lgkmcnt(8)
    v_mfma_f32_32x32x16_bf16 v[192:207], v[16:19], v[184:187], v[192:207]
    ds_read_b64_tr_b16 v[16:17], v52 offset:49408
    ds_read_b64_tr_b16 v[18:19], v52 offset:51456
    v_add_f32 v98, v98, v218
    v_add_f32 v98, v98, v219
    v_mfma_f32_32x32x16_bf16 v[192:207], v[20:23], v[188:191], v[192:207]
    ds_read_b64_tr_b16 v[20:21], v53 offset:49408
    ds_read_b64_tr_b16 v[22:23], v53 offset:51456
    v_cvt_pk_bf16_f32 v229, v218, v219
    s_waitcnt lgkmcnt(8)
    v_mfma_f32_32x32x16_bf16 a[0:15], v[0:3], v[224:227], a[0:15]
    ds_read_b64_tr_b16 v[0:1], v54 offset:49408
    ds_read_b64_tr_b16 v[2:3], v54 offset:51456
    v_exp_f32 v220, v220
    v_exp_f32 v221, v221
    v_mfma_f32_32x32x16_bf16 a[16:31], v[4:7], v[224:227], a[16:31]
    ds_read_b64_tr_b16 v[4:5], v55 offset:49408
    ds_read_b64_tr_b16 v[6:7], v55 offset:51456
    v_add_f32 v98, v98, v220
    v_add_f32 v98, v98, v221
    s_waitcnt lgkmcnt(8)
    v_mfma_f32_32x32x16_bf16 a[32:47], v[8:11], v[224:227], a[32:47]
    ds_read_b64_tr_b16 v[8:9], v52 offset:57344
    ds_read_b64_tr_b16 v[10:11], v52 offset:59392
    v_cvt_pk_bf16_f32 v230, v220, v221
    v_mfma_f32_32x32x16_bf16 a[48:63], v[12:15], v[224:227], a[48:63]
    ds_read_b64_tr_b16 v[12:13], v53 offset:57344
    ds_read_b64_tr_b16 v[14:15], v53 offset:59392
    v_exp_f32 v222, v222
    v_exp_f32 v223, v223
    s_waitcnt lgkmcnt(8)
    v_mfma_f32_32x32x16_bf16 a[64:79], v[16:19], v[224:227], a[64:79]
    ds_read_b64_tr_b16 v[16:17], v54 offset:57344
    ds_read_b64_tr_b16 v[18:19], v54 offset:59392
    v_add_f32 v98, v98, v222
    v_add_f32 v98, v98, v223
    v_mfma_f32_32x32x16_bf16 a[80:95], v[20:23], v[224:227], a[80:95]
    ds_read_b64_tr_b16 v[20:21], v55 offset:57344
    ds_read_b64_tr_b16 v[22:23], v55 offset:59392
    v_cvt_pk_bf16_f32 v231, v222, v223
    s_waitcnt lgkmcnt(8)
    v_mfma_f32_32x32x16_bf16 a[96:111], v[0:3], v[224:227], a[96:111]
    ds_read_b64_tr_b16 v[0:1], v52 offset:57600
    ds_read_b64_tr_b16 v[2:3], v52 offset:59648
    v_max3_f32 v108, v192, v193, v194
    v_mfma_f32_32x32x16_bf16 a[112:127], v[4:7], v[224:227], a[112:127]
    ds_read_b64_tr_b16 v[4:5], v53 offset:57600
    ds_read_b64_tr_b16 v[6:7], v53 offset:59648
    v_max3_f32 v108, v108, v195, v196
    s_waitcnt lgkmcnt(8)
    v_mfma_f32_32x32x16_bf16 a[0:15], v[8:11], v[228:231], a[0:15]
    s_waitcnt vmcnt(18)
    s_barrier
    s_add_u32 m0, s60, 0
    ds_read_b64_tr_b16 v[8:9], v54 offset:57600
    ds_read_b64_tr_b16 v[10:11], v54 offset:59648
    buffer_load_dwordx4 v36, s[36:39], s58 offen offset:0 lds
    v_max3_f32 v108, v108, v197, v198
    v_mfma_f32_32x32x16_bf16 a[16:31], v[12:15], v[228:231], a[16:31]
    ds_read_b64_tr_b16 v[12:13], v55 offset:57600
    ds_read_b64_tr_b16 v[14:15], v55 offset:59648
    v_max3_f32 v108, v108, v199, v200
    s_waitcnt lgkmcnt(8)
    v_mfma_f32_32x32x16_bf16 a[32:47], v[16:19], v[228:231], a[32:47]
    ds_read_b128 v[16:19], v81 offset:0
    v_max3_f32 v108, v108, v201, v202
    v_mfma_f32_32x32x16_bf16 a[48:63], v[20:23], v[228:231], a[48:63]
    ds_read_b128 v[20:23], v82 offset:0
    buffer_load_dwordx4 v37, s[36:39], s58 offen offset:1024 lds
    v_max3_f32 v108, v108, v203, v204
    s_waitcnt lgkmcnt(6)
    v_mfma_f32_32x32x16_bf16 a[64:79], v[0:3], v[228:231], a[64:79]
    ds_read_b128 v[0:3], v83 offset:0
    v_max3_f32 v108, v108, v205, v206
    v_mfma_f32_32x32x16_bf16 a[80:95], v[4:7], v[228:231], a[80:95]
    ds_read_b128 v[4:7], v84 offset:0
    v_max_f32 v108, v108, v207
    s_waitcnt lgkmcnt(4)
    v_mfma_f32_32x32x16_bf16 a[96:111], v[8:11], v[228:231], a[96:111]
    ds_read_b128 v[8:11], v85 offset:0
    buffer_load_dwordx4 v38, s[36:39], s58 offen offset:2048 lds
    v_cmp_lt_f32 vcc, s66, v108
    v_mfma_f32_32x32x16_bf16 a[112:127], v[12:15], v[228:231], a[112:127]
    ds_read_b128 v[12:15], v86 offset:0
    s_cbranch_vccnz L1_tr8
L1_bk8:
    s_waitcnt lgkmcnt(4)
    v_mfma_f32_32x32x16_bf16 v[208:223], v[16:19], v[128:131], v[112:127]
    ds_read_b128 v[16:19], v87 offset:0
    v_exp_f32 v192, v192
    v_exp_f32 v193, v193
    v_mfma_f32_32x32x16_bf16 v[208:223], v[20:23], v[132:135], v[208:223]
    ds_read_b128 v[20:23], v88 offset:0
    buffer_load_dwordx4 v39, s[36:39], s58 offen offset:3072 lds
    v_add_f32 v98, v98, v192
    v_add_f32 v98, v98, v193
    s_waitcnt lgkmcnt(4)
    v_mfma_f32_32x32x16_bf16 v[208:223], v[0:3], v[136:139], v[208:223]
    ds_read_b128 v[0:3], v81 offset:256
    v_cvt_pk_bf16_f32 v224, v192, v193
    v_exp_f32 v194, v194
    v_mfma_f32_32x32x16_bf16 v[208:223], v[4:7], v[140:143], v[208:223]
    ds_read_b128 v[4:7], v82 offset:256
    s_lshl_b32 s61, s3, 2
    s_add_u32 s61, s61, s52
    s_mul_i32 s61, s61, 3584
    s_mul_i32 s62, s53, 229376
    s_add_u32 s61, s61, s62
    v_mov_b32 v25, 0
    v_min_u32 v24, 432, v97
    v_lshl_add_u32 v24, v24, 3, v25
    s_nop 0
    buffer_load_dword v26, v24, s[40:43], s61 offen
    v_exp_f32 v195, v195
    v_add_f32 v98, v98, v194
    s_waitcnt lgkmcnt(4)
    v_mfma_f32_32x32x16_bf16 v[208:223], v[8:11], v[144:147], v[208:223]
    s_add_u32 m0, s60, 4096
    ds_read_b128 v[8:11], v83 offset:256
    buffer_load_dwordx4 v40, s[36:39], s58 offen offset:0 lds
    v_add_f32 v98, v98, v195
    v_cvt_pk_bf16_f32 v225, v194, v195
    v_mfma_f32_32x32x16_bf16 v[208:223], v[12:15], v[148:151], v[208:223]
    ds_read_b128 v[12:15], v84 offset:256
    v_exp_f32 v196, v196
    v_exp_f32 v197, v197
    s_waitcnt lgkmcnt(4)
    v_mfma_f32_32x32x16_bf16 v[208:223], v[16:19], v[152:155], v[208:223]
    ds_read_b128 v[16:19], v85 offset:256
    v_add_f32 v98, v98, v196
    v_add_f32 v98, v98, v197
    v_mfma_f32_32x32x16_bf16 v[208:223], v[20:23], v[156:159], v[208:223]
    ds_read_b128 v[20:23], v86 offset:256
    buffer_load_dwordx4 v41, s[36:39], s58 offen offset:1024 lds
    v_cvt_pk_bf16_f32 v226, v196, v197
    v_exp_f32 v198, v198
    s_waitcnt lgkmcnt(4)
    v_mfma_f32_32x32x16_bf16 v[208:223], v[0:3], v[160:163], v[208:223]
    ds_read_b128 v[0:3], v87 offset:256
    v_exp_f32 v199, v199
    v_add_f32 v98, v98, v198
    v_mfma_f32_32x32x16_bf16 v[208:223], v[4:7], v[164:167], v[208:223]
    ds_read_b128 v[4:7], v88 offset:256
    v_add_f32 v98, v98, v199
    v_cvt_pk_bf16_f32 v227, v198, v199
    s_waitcnt lgkmcnt(4)
    v_mfma_f32_32x32x16_bf16 v[208:223], v[8:11], v[168:171], v[208:223]
    ds_read_b64_tr_b16 v[8:9], v56 offset:16384
    ds_read_b64_tr_b16 v[10:11], v56 offset:18432
    buffer_load_dwordx4 v42, s[36:39], s58 offen offset:2048 lds
    v_exp_f32 v200, v200
    v_exp_f32 v201, v201
    v_mfma_f32_32x32x16_bf16 v[208:223], v[12:15], v[172:175], v[208:223]
    ds_read_b64_tr_b16 v[12:13], v57 offset:16384
    ds_read_b64_tr_b16 v[14:15], v57 offset:18432
    v_add_f32 v98, v98, v200
    v_add_f32 v98, v98, v201
    s_waitcnt lgkmcnt(6)
    v_mfma_f32_32x32x16_bf16 v[208:223], v[16:19], v[176:179], v[208:223]
    ds_read_b64_tr_b16 v[16:17], v58 offset:16384
    ds_read_b64_tr_b16 v[18:19], v58 offset:18432
    v_cvt_pk_bf16_f32 v228, v200, v201
    v_mfma_f32_32x32x16_bf16 v[208:223], v[20:23], v[180:183], v[208:223]
    ds_read_b64_tr_b16 v[20:21], v59 offset:16384
    ds_read_b64_tr_b16 v[22:23], v59 offset:18432
    buffer_load_dwordx4 v43, s[36:39], s58 offen offset:3072 lds
    s_add_u32 s58, s58, 0x4000
    v_exp_f32 v202, v202
    v_exp_f32 v203, v203
    s_waitcnt lgkmcnt(8)
    v_mfma_f32_32x32x16_bf16 v[208:223], v[0:3], v[184:187], v[208:223]
    ds_read_b64_tr_b16 v[0:1], v56 offset:16640
    ds_read_b64_tr_b16 v[2:3], v56 offset:18688
    v_add_f32 v98, v98, v202
    v_add_f32 v98, v98, v203
    v_mfma_f32_32x32x16_bf16 v[208:223], v[4:7], v[188:191], v[208:223]
    ds_read_b64_tr_b16 v[4:5], v57 offset:16640
    ds_read_b64_tr_b16 v[6:7], v57 offset:18688
    v_cvt_pk_bf16_f32 v229, v202, v203
    s_waitcnt lgkmcnt(8)
    v_mfma_f32_32x32x16_bf16 a[0:15], v[8:11], v[224:227], a[0:15]
    ds_read_b64_tr_b16 v[8:9], v58 offset:16640
    ds_read_b64_tr_b16 v[10:11], v58 offset:18688
    v_exp_f32 v204, v204
    v_exp_f32 v205, v205
    v_mfma_f32_32x32x16_bf16 a[16:31], v[12:15], v[224:227], a[16:31]
    ds_read_b64_tr_b16 v[12:13], v59 offset:16640
    ds_read_b64_tr_b16 v[14:15], v59 offset:18688
    v_add_f32 v98, v98, v204
    v_add_f32 v98, v98, v205
    s_waitcnt lgkmcnt(8)
    v_mfma_f32_32x32x16_bf16 a[32:47], v[16:19], v[224:227], a[32:47]
    ds_read_b64_tr_b16 v[16:17], v56 offset:24576
    ds_read_b64_tr_b16 v[18:19], v56 offset:26624
    v_cvt_pk_bf16_f32 v230, v204, v205
    v_mfma_f32_32x32x16_bf16 a[48:63], v[20:23], v[224:227], a[48:63]
    ds_read_b64_tr_b16 v[20:21], v57 offset:24576
    ds_read_b64_tr_b16 v[22:23], v57 offset:26624
    v_exp_f32 v206, v206
    v_exp_f32 v207, v207
    s_waitcnt lgkmcnt(8)
    v_mfma_f32_32x32x16_bf16 a[64:79], v[0:3], v[224:227], a[64:79]
    ds_read_b64_tr_b16 v[0:1], v58 offset:24576
    ds_read_b64_tr_b16 v[2:3], v58 offset:26624
    v_add_f32 v98, v98, v206
    v_add_f32 v98, v98, v207
    v_mfma_f32_32x32x16_bf16 a[80:95], v[4:7], v[224:227], a[80:95]
    ds_read_b64_tr_b16 v[4:5], v59 offset:24576
    ds_read_b64_tr_b16 v[6:7], v59 offset:26624
    v_cvt_pk_bf16_f32 v231, v206, v207
    s_waitcnt lgkmcnt(8)
    v_mfma_f32_32x32x16_bf16 a[96:111], v[8:11], v[224:227], a[96:111]
    ds_read_b64_tr_b16 v[8:9], v56 offset:24832
    ds_read_b64_tr_b16 v[10:11], v56 offset:26880
    v_max3_f32 v108, v208, v209, v210
    v_mfma_f32_32x32x16_bf16 a[112:127], v[12:15], v[224:227], a[112:127]
    ds_read_b64_tr_b16 v[12:13], v57 offset:24832
    ds_read_b64_tr_b16 v[14:15], v57 offset:26880
    v_max3_f32 v108, v108, v211, v212
    s_waitcnt lgkmcnt(8)
    v_mfma_f32_32x32x16_bf16 a[0:15], v[16:19], v[228:231], a[0:15]
    s_waitcnt vmcnt(18)
    s_barrier
    s_add_u32 m0, s60, 32768
    ds_read_b64_tr_b16 v[16:17], v58 offset:24832
    ds_read_b64_tr_b16 v[18:19], v58 offset:26880
    buffer_load_dwordx4 v36, s[36:39], s58 offen offset:0 lds
    v_max3_f32 v108, v108, v213, v214
    v_mfma_f32_32x32x16_bf16 a[16:31], v[20:23], v[228:231], a[16:31]
    ds_read_b64_tr_b16 v[20:21], v59 offset:24832
    ds_read_b64_tr_b16 v[22:23], v59 offset:26880
    v_max3_f32 v108, v108, v215, v216
    s_waitcnt lgkmcnt(8)
    v_mfma_f32_32x32x16_bf16 a[32:47], v[0:3], v[228:231], a[32:47]
    ds_read_b128 v[0:3], v81 offset:32768
    v_max3_f32 v108, v108, v217, v218
    v_mfma_f32_32x32x16_bf16 a[48:63], v[4:7], v[228:231], a[48:63]
    ds_read_b128 v[4:7], v82 offset:32768
    buffer_load_dwordx4 v37, s[36:39], s58 offen offset:1024 lds
    v_max3_f32 v108, v108, v219, v220
    s_waitcnt lgkmcnt(6)
    v_mfma_f32_32x32x16_bf16 a[64:79], v[8:11], v[228:231], a[64:79]
    ds_read_b128 v[8:11], v83 offset:32768
    v_max3_f32 v108, v108, v221, v222
    v_mfma_f32_32x32x16_bf16 a[80:95], v[12:15], v[228:231], a[80:95]
    ds_read_b128 v[12:15], v84 offset:32768
    v_max_f32 v108, v108, v223
    s_waitcnt lgkmcnt(4)
    v_mfma_f32_32x32x16_bf16 a[96:111], v[16:19], v[228:231], a[96:111]
    ds_read_b128 v[16:19], v85 offset:32768
    buffer_load_dwordx4 v38, s[36:39], s58 offen offset:2048 lds
    v_cmp_lt_f32 vcc, s66, v108
    v_mfma_f32_32x32x16_bf16 a[112:127], v[20:23], v[228:231], a[112:127]
    ds_read_b128 v[20:23], v86 offset:32768
    s_cbranch_vccnz L1_tr9
L1_bk9:
    s_waitcnt lgkmcnt(4)
    v_mfma_f32_32x32x16_bf16 v[192:207], v[0:3], v[128:131], v[112:127]
    ds_read_b128 v[0:3], v87 offset:32768
    v_exp_f32 v208, v208
    v_exp_f32 v209, v209
    v_mfma_f32_32x32x16_bf16 v[192:207], v[4:7], v[132:135], v[192:207]
    ds_read_b128 v[4:7], v88 offset:32768
    buffer_load_dwordx4 v39, s[36:39], s58 offen offset:3072 lds
    v_add_f32 v98, v98, v208
    v_add_f32 v98, v98, v209
    s_waitcnt lgkmcnt(4)
    v_mfma_f32_32x32x16_bf16 v[192:207], v[8:11], v[136:139], v[192:207]
    ds_read_b128 v[8:11], v81 offset:33024
    v_cvt_pk_bf16_f32 v224, v208, v209
    v_exp_f32 v210, v210
    v_mfma_f32_32x32x16_bf16 v[192:207], v[12:15], v[140:143], v[192:207]
    ds_read_b128 v[12:15], v82 offset:33024
    v_exp_f32 v211, v211
    v_add_f32 v98, v98, v210
    s_waitcnt lgkmcnt(4)
    v_mfma_f32_32x32x16_bf16 v[192:207], v[16:19], v[144:147], v[192:207]
    s_add_u32 m0, s60, 36864
    ds_read_b128 v[16:19], v83 offset:33024
    buffer_load_dwordx4 v40, s[36:39], s58 offen offset:0 lds
    v_add_f32 v98, v98, v211
    v_cvt_pk_bf16_f32 v225, v210, v211
    v_mfma_f32_32x32x16_bf16 v[192:207], v[20:23], v[148:151], v[192:207]
    ds_read_b128 v[20:23], v84 offset:33024
    v_exp_f32 v212, v212
    v_exp_f32 v213, v213
    s_waitcnt lgkmcnt(4)
    v_mfma_f32_32x32x16_bf16 v[192:207], v[0:3], v[152:155], v[192:207]
    ds_read_b128 v[0:3], v85 offset:33024
    v_add_f32 v98, v98, v212
    v_add_f32 v98, v98, v213
    v_mfma_f32_32x32x16_bf16 v[192:207], v[4:7], v[156:159], v[192:207]
    ds_read_b128 v[4:7], v86 offset:33024
    buffer_load_dwordx4 v41, s[36:39], s58 offen offset:1024 lds
    v_cvt_pk_bf16_f32 v226, v212, v213
    v_exp_f32 v214, v214
    s_waitcnt lgkmcnt(4)
    v_mfma_f32_32x32x16_bf16 v[192:207], v[8:11], v[160:163], v[192:207]
    ds_read_b128 v[8:11], v87 offset:33024
    v_exp_f32 v215, v215
    v_add_f32 v98, v98, v214
    v_mfma_f32_32x32x16_bf16 v[192:207], v[12:15], v[164:167], v[192:207]
    ds_read_b128 v[12:15], v88 offset:33024
    v_add_f32 v98, v98, v215
    v_cvt_pk_bf16_f32 v227, v214, v215
    s_waitcnt lgkmcnt(4)
    v_mfma_f32_32x32x16_bf16 v[192:207], v[16:19], v[168:171], v[192:207]
    ds_read_b64_tr_b16 v[16:17], v56 offset:49152
    ds_read_b64_tr_b16 v[18:19], v56 offset:51200
    buffer_load_dwordx4 v42, s[36:39], s58 offen offset:2048 lds
    v_exp_f32 v216, v216
    v_exp_f32 v217, v217
    v_mfma_f32_32x32x16_bf16 v[192:207], v[20:23], v[172:175], v[192:207]
    ds_read_b64_tr_b16 v[20:21], v57 offset:49152
    ds_read_b64_tr_b16 v[22:23], v57 offset:51200
    v_add_f32 v98, v98, v216
    v_add_f32 v98, v98, v217
    s_waitcnt lgkmcnt(6)
    v_mfma_f32_32x32x16_bf16 v[192:207], v[0:3], v[176:179], v[192:207]
    ds_read_b64_tr_b16 v[0:1], v58 offset:49152
    ds_read_b64_tr_b16 v[2:3], v58 offset:51200
    v_cvt_pk_bf16_f32 v228, v216, v217
    v_mfma_f32_32x32x16_bf16 v[192:207], v[4:7], v[180:183], v[192:207]
    ds_read_b64_tr_b16 v[4:5], v59 offset:49152
    ds_read_b64_tr_b16 v[6:7], v59 offset:51200
    buffer_load_dwordx4 v43, s[36:39], s58 offen offset:3072 lds
    s_add_u32 s58, s58, 0x4000
    v_exp_f32 v218, v218
    v_exp_f32 v219, v219
    s_waitcnt lgkmcnt(8)
    v_mfma_f32_32x32x16_bf16 v[192:207], v[8:11], v[184:187], v[192:207]
    ds_read_b64_tr_b16 v[8:9], v56 offset:49408
    ds_read_b64_tr_b16 v[10:11], v56 offset:51456
    v_add_f32 v98, v98, v218
    v_add_f32 v98, v98, v219
    v_mfma_f32_32x32x16_bf16 v[192:207], v[12:15], v[188:191], v[192:207]
    ds_read_b64_tr_b16 v[12:13], v57 offset:49408
    ds_read_b64_tr_b16 v[14:15], v57 offset:51456
    v_cvt_pk_bf16_f32 v229, v218, v219
    s_waitcnt lgkmcnt(8)
    v_mfma_f32_32x32x16_bf16 a[0:15], v[16:19], v[224:227], a[0:15]
    ds_read_b64_tr_b16 v[16:17], v58 offset:49408
    ds_read_b64_tr_b16 v[18:19], v58 offset:51456
    v_exp_f32 v220, v220
    v_exp_f32 v221, v221
    v_mfma_f32_32x32x16_bf16 a[16:31], v[20:23], v[224:227], a[16:31]
    ds_read_b64_tr_b16 v[20:21], v59 offset:49408
    ds_read_b64_tr_b16 v[22:23], v59 offset:51456
    v_add_f32 v98, v98, v220
    v_add_f32 v98, v98, v221
    s_waitcnt lgkmcnt(8)
    v_mfma_f32_32x32x16_bf16 a[32:47], v[0:3], v[224:227], a[32:47]
    ds_read_b64_tr_b16 v[0:1], v56 offset:57344
    ds_read_b64_tr_b16 v[2:3], v56 offset:59392
    v_cvt_pk_bf16_f32 v230, v220, v221
    v_mfma_f32_32x32x16_bf16 a[48:63], v[4:7], v[224:227], a[48:63]
    ds_read_b64_tr_b16 v[4:5], v57 offset:57344
    ds_read_b64_tr_b16 v[6:7], v57 offset:59392
    v_exp_f32 v222, v222
    v_exp_f32 v223, v223
    s_waitcnt lgkmcnt(8)
    v_mfma_f32_32x32x16_bf16 a[64:79], v[8:11], v[224:227], a[64:79]
    ds_read_b64_tr_b16 v[8:9], v58 offset:57344
    ds_read_b64_tr_b16 v[10:11], v58 offset:59392
    v_add_f32 v98, v98, v222
    v_add_f32 v98, v98, v223
    v_mfma_f32_32x32x16_bf16 a[80:95], v[12:15], v[224:227], a[80:95]
    ds_read_b64_tr_b16 v[12:13], v59 offset:57344
    ds_read_b64_tr_b16 v[14:15], v59 offset:59392
    v_cvt_pk_bf16_f32 v231, v222, v223
    s_waitcnt lgkmcnt(8)
    v_mfma_f32_32x32x16_bf16 a[96:111], v[16:19], v[224:227], a[96:111]
    ds_read_b64_tr_b16 v[16:17], v56 offset:57600
    ds_read_b64_tr_b16 v[18:19], v56 offset:59648
    v_max3_f32 v108, v192, v193, v194
    v_mfma_f32_32x32x16_bf16 a[112:127], v[20:23], v[224:227], a[112:127]
    ds_read_b64_tr_b16 v[20:21], v57 offset:57600
    ds_read_b64_tr_b16 v[22:23], v57 offset:59648
    v_max3_f32 v108, v108, v195, v196
    s_waitcnt vmcnt(23)
    v_cmp_ne_u32 vcc, v29, v28
    s_nop 1
    s_cbranch_vccnz L1_sph
L1_sph_b:
    s_waitcnt lgkmcnt(8)
    v_mfma_f32_32x32x16_bf16 a[0:15], v[0:3], v[228:231], a[0:15]
    s_waitcnt vmcnt(17)
    s_barrier
    s_add_u32 m0, s60, 65536
    ds_read_b64_tr_b16 v[0:1], v58 offset:57600
    ds_read_b64_tr_b16 v[2:3], v58 offset:59648
    buffer_load_dwordx4 v36, s[36:39], s58 offen offset:0 lds
    v_max3_f32 v108, v108, v197, v198
    buffer_load_dwordx4 a[192:195], v97, s[48:51], s18 offen offset:0 sc1
    v_mfma_f32_32x32x16_bf16 a[16:31], v[4:7], v[228:231], a[16:31]
    ds_read_b64_tr_b16 v[4:5], v59 offset:57600
    ds_read_b64_tr_b16 v[6:7], v59 offset:59648
    v_max3_f32 v108, v108, v199, v200
    s_waitcnt lgkmcnt(8)
    v_mfma_f32_32x32x16_bf16 a[32:47], v[8:11], v[228:231], a[32:47]
    ds_read_b128 v[8:11], v89 offset:0
    v_max3_f32 v108, v108, v201, v202
    v_mfma_f32_32x32x16_bf16 a[48:63], v[12:15], v[228:231], a[48:63]
    ds_read_b128 v[12:15], v90 offset:0
    buffer_load_dwordx4 v37, s[36:39], s58 offen offset:1024 lds
    v_max3_f32 v108, v108, v203, v204
    s_waitcnt lgkmcnt(6)
    v_mfma_f32_32x32x16_bf16 a[64:79], v[16:19], v[228:231], a[64:79]
    ds_read_b128 v[16:19], v91 offset:0
    v_max3_f32 v108, v108, v205, v206
    v_mfma_f32_32x32x16_bf16 a[80:95], v[20:23], v[228:231], a[80:95]
    ds_read_b128 v[20:23], v92 offset:0
    v_max_f32 v108, v108, v207
    buffer_load_dwordx4 a[196:199], v97, s[48:51], s18 offen offset:1024 sc1
    s_add_u32 s18, s18, 1835008
    s_waitcnt lgkmcnt(4)
    v_mfma_f32_32x32x16_bf16 a[96:111], v[0:3], v[228:231], a[96:111]
    ds_read_b128 v[0:3], v93 offset:0
    buffer_load_dwordx4 v38, s[36:39], s58 offen offset:2048 lds
    v_cmp_lt_f32 vcc, s66, v108
    v_mfma_f32_32x32x16_bf16 a[112:127], v[4:7], v[228:231], a[112:127]
    ds_read_b128 v[4:7], v94 offset:0
    s_cbranch_vccnz L1_tr10
L1_bk10:
    s_waitcnt lgkmcnt(4)
    v_mfma_f32_32x32x16_bf16 v[208:223], v[8:11], v[128:131], v[112:127]
    ds_read_b128 v[8:11], v95 offset:0
    v_exp_f32 v192, v192
    v_exp_f32 v193, v193
    v_mfma_f32_32x32x16_bf16 v[208:223], v[12:15], v[132:135], v[208:223]
    ds_read_b128 v[12:15], v96 offset:0
    buffer_load_dwordx4 v39, s[36:39], s58 offen offset:3072 lds
    v_add_f32 v98, v98, v192
    v_add_f32 v98, v98, v193
    s_waitcnt lgkmcnt(4)
    v_mfma_f32_32x32x16_bf16 v[208:223], v[16:19], v[136:139], v[208:223]
    ds_read_b128 v[16:19], v89 offset:256
    v_cvt_pk_bf16_f32 v224, v192, v193
    v_exp_f32 v194, v194
    v_mfma_f32_32x32x16_bf16 v[208:223], v[20:23], v[140:143], v[208:223]
    ds_read_b128 v[20:23], v90 offset:256
    v_exp_f32 v195, v195
    v_add_f32 v98, v98, v194
    buffer_load_dwordx4 a[200:203], v97, s[48:51], s18 offen offset:0 sc1
    s_waitcnt lgkmcnt(4)
    v_mfma_f32_32x32x16_bf16 v[208:223], v[0:3], v[144:147], v[208:223]
    s_add_u32 m0, s60, 69632
    ds_read_b128 v[0:3], v91 offset:256
    buffer_load_dwordx4 v40, s[36:39], s58 offen offset:0 lds
    v_add_f32 v98, v98, v195
    v_cvt_pk_bf16_f32 v225, v194, v195
    v_mfma_f32_32x32x16_bf16 v[208:223], v[4:7], v[148:151], v[208:223]
    ds_read_b128 v[4:7], v92 offset:256
    v_exp_f32 v196, v196
    v_exp_f32 v197, v197
    s_waitcnt lgkmcnt(4)
    v_mfma_f32_32x32x16_bf16 v[208:223], v[8:11], v[152:155], v[208:223]
    ds_read_b128 v[8:11], v93 offset:256
    v_add_f32 v98, v98, v196
    v_add_f32 v98, v98, v197
    v_mfma_f32_32x32x16_bf16 v[208:223], v[12:15], v[156:159], v[208:223]
    ds_read_b128 v[12:15], v94 offset:256
    buffer_load_dwordx4 v41, s[36:39], s58 offen offset:1024 lds
    v_cvt_pk_bf16_f32 v226, v196, v197
    v_exp_f32 v198, v198
    s_waitcnt lgkmcnt(4)
    v_mfma_f32_32x32x16_bf16 v[208:223], v[16:19], v[160:163], v[208:223]
    ds_read_b128 v[16:19], v95 offset:256
    v_exp_f32 v199, v199
    v_add_f32 v98, v98, v198
    v_mfma_f32_32x32x16_bf16 v[208:223], v[20:23], v[164:167], v[208:223]
    ds_read_b128 v[20:23], v96 offset:256
    v_add_f32 v98, v98, v199
    v_cvt_pk_bf16_f32 v227, v198, v199
    buffer_load_dwordx4 a[204:207], v97, s[48:51], s18 offen offset:1024 sc1
    s_add_u32 s18, s18, 1835008
    s_waitcnt lgkmcnt(4)
    v_mfma_f32_32x32x16_bf16 v[208:223], v[0:3], v[168:171], v[208:223]
    ds_read_b64_tr_b16 v[0:1], v60 offset:16384
    ds_read_b64_tr_b16 v[2:3], v60 offset:18432
    buffer_load_dwordx4 v42, s[36:39], s58 offen offset:2048 lds
    v_exp_f32 v200, v200
    v_exp_f32 v201, v201
    v_mfma_f32_32x32x16_bf16 v[208:223], v[4:7], v[172:175], v[208:223]
    ds_read_b64_tr_b16 v[4:5], v61 offset:16384
    ds_read_b64_tr_b16 v[6:7], v61 offset:18432
    v_add_f32 v98, v98, v200
    v_add_f32 v98, v98, v201
    s_waitcnt lgkmcnt(6)
    v_mfma_f32_32x32x16_bf16 v[208:223], v[8:11], v[176:179], v[208:223]
    ds_read_b64_tr_b16 v[8:9], v62 offset:16384
    ds_read_b64_tr_b16 v[10:11], v62 offset:18432
    v_cvt_pk_bf16_f32 v228, v200, v201
    v_mfma_f32_32x32x16_bf16 v[208:223], v[12:15], v[180:183], v[208:223]
    ds_read_b64_tr_b16 v[12:13], v63 offset:16384
    ds_read_b64_tr_b16 v[14:15], v63 offset:18432
    buffer_load_dwordx4 v43, s[36:39], s58 offen offset:3072 lds
    s_add_u32 s58, s58, 0x4000
    v_exp_f32 v202, v202
    v_exp_f32 v203, v203
    s_waitcnt lgkmcnt(8)
    v_mfma_f32_32x32x16_bf16 v[208:223], v[16:19], v[184:187], v[208:223]
    ds_read_b64_tr_b16 v[16:17], v60 offset:16640
    ds_read_b64_tr_b16 v[18:19], v60 offset:18688
    v_add_f32 v98, v98, v202
    v_add_f32 v98, v98, v203
    v_mfma_f32_32x32x16_bf16 v[208:223], v[20:23], v[188:191], v[208:223]
    ds_read_b64_tr_b16 v[20:21], v61 offset:16640
    ds_read_b64_tr_b16 v[22:23], v61 offset:18688
    v_cvt_pk_bf16_f32 v229, v202, v203
    buffer_load_dwordx4 a[208:211], v97, s[48:51], s18 offen offset:0 sc1
    s_waitcnt lgkmcnt(8)
    v_mfma_f32_32x32x16_bf16 a[0:15], v[0:3], v[224:227], a[0:15]
    ds_read_b64_tr_b16 v[0:1], v62 offset:16640
    ds_read_b64_tr_b16 v[2:3], v62 offset:18688
    v_exp_f32 v204, v204
    v_exp_f32 v205, v205
    v_mfma_f32_32x32x16_bf16 a[16:31], v[4:7], v[224:227], a[16:31]
    ds_read_b64_tr_b16 v[4:5], v63 offset:16640
    ds_read_b64_tr_b16 v[6:7], v63 offset:18688
    v_add_f32 v98, v98, v204
    v_add_f32 v98, v98, v205
    s_waitcnt lgkmcnt(8)
    v_mfma_f32_32x32x16_bf16 a[32:47], v[8:11], v[224:227], a[32:47]
    ds_read_b64_tr_b16 v[8:9], v60 offset:24576
    ds_read_b64_tr_b16 v[10:11], v60 offset:26624
    v_cvt_pk_bf16_f32 v230, v204, v205
    v_mfma_f32_32x32x16_bf16 a[48:63], v[12:15], v[224:227], a[48:63]
    ds_read_b64_tr_b16 v[12:13], v61 offset:24576
    ds_read_b64_tr_b16 v[14:15], v61 offset:26624
    v_exp_f32 v206, v206
    v_exp_f32 v207, v207
    s_waitcnt lgkmcnt(8)
    v_mfma_f32_32x32x16_bf16 a[64:79], v[16:19], v[224:227], a[64:79]
    ds_read_b64_tr_b16 v[16:17], v62 offset:24576
    ds_read_b64_tr_b16 v[18:19], v62 offset:26624
    v_add_f32 v98, v98, v206
    v_add_f32 v98, v98, v207
    buffer_load_dwordx4 a[212:215], v97, s[48:51], s18 offen offset:1024 sc1
    s_add_u32 s18, s18, 1835008
    v_mfma_f32_32x32x16_bf16 a[80:95], v[20:23], v[224:227], a[80:95]
    ds_read_b64_tr_b16 v[20:21], v63 offset:24576
    ds_read_b64_tr_b16 v[22:23], v63 offset:26624
    v_cvt_pk_bf16_f32 v231, v206, v207
    s_waitcnt lgkmcnt(8)
    v_mfma_f32_32x32x16_bf16 a[96:111], v[0:3], v[224:227], a[96:111]
    ds_read_b64_tr_b16 v[0:1], v60 offset:24832
    ds_read_b64_tr_b16 v[2:3], v60 offset:26880
    v_max3_f32 v108, v208, v209, v210
    v_mfma_f32_32x32x16_bf16 a[112:127], v[4:7], v[224:227], a[112:127]
    ds_read_b64_tr_b16 v[4:5], v61 offset:24832
    ds_read_b64_tr_b16 v[6:7], v61 offset:26880
    v_max3_f32 v108, v108, v211, v212
    s_waitcnt lgkmcnt(8)
    v_mfma_f32_32x32x16_bf16 a[0:15], v[8:11], v[228:231], a[0:15]
    s_waitcnt vmcnt(22)
    s_barrier
    s_add_u32 m0, s60, 98304
    ds_read_b64_tr_b16 v[8:9], v62 offset:24832
    ds_read_b64_tr_b16 v[10:11], v62 offset:26880
    buffer_load_dwordx4 v36, s[36:39], s58 offen offset:0 lds
    v_max3_f32 v108, v108, v213, v214
    v_mfma_f32_32x32x16_bf16 a[16:31], v[12:15], v[228:231], a[16:31]
    ds_read_b64_tr_b16 v[12:13], v63 offset:24832
    ds_read_b64_tr_b16 v[14:15], v63 offset:26880
    v_max3_f32 v108, v108, v215, v216
    s_waitcnt lgkmcnt(8)
    v_mfma_f32_32x32x16_bf16 a[32:47], v[16:19], v[228:231], a[32:47]
    ds_read_b128 v[16:19], v73 offset:0
    v_max3_f32 v108, v108, v217, v218
    buffer_load_dwordx4 a[216:219], v97, s[48:51], s18 offen offset:0 sc1
    v_mfma_f32_32x32x16_bf16 a[48:63], v[20:23], v[228:231], a[48:63]
    ds_read_b128 v[20:23], v74 offset:0
    buffer_load_dwordx4 v37, s[36:39], s58 offen offset:1024 lds
    v_max3_f32 v108, v108, v219, v220
    s_waitcnt lgkmcnt(6)
    v_mfma_f32_32x32x16_bf16 a[64:79], v[0:3], v[228:231], a[64:79]
    ds_read_b128 v[0:3], v75 offset:0
    v_max3_f32 v108, v108, v221, v222
    v_mfma_f32_32x32x16_bf16 a[80:95], v[4:7], v[228:231], a[80:95]
    ds_read_b128 v[4:7], v76 offset:0
    v_max_f32 v108, v108, v223
    s_waitcnt lgkmcnt(4)
    v_mfma_f32_32x32x16_bf16 a[96:111], v[8:11], v[228:231], a[96:111]
    ds_read_b128 v[8:11], v77 offset:0
    buffer_load_dwordx4 v38, s[36:39], s58 offen offset:2048 lds
    v_cmp_lt_f32 vcc, s66, v108
    v_mfma_f32_32x32x16_bf16 a[112:127], v[12:15], v[228:231], a[112:127]
    ds_read_b128 v[12:15], v78 offset:0
    s_cbranch_vccnz L1_tr11
L1_bk11:
    s_waitcnt lgkmcnt(4)
    v_mfma_f32_32x32x16_bf16 v[192:207], v[16:19], v[128:131], v[112:127]
    ds_read_b128 v[16:19], v79 offset:0
    v_exp_f32 v208, v208
    v_exp_f32 v209, v209
    buffer_load_dwordx4 a[220:223], v97, s[48:51], s18 offen offset:1024 sc1
    s_add_u32 s18, s18, 1835008
    v_mfma_f32_32x32x16_bf16 v[192:207], v[20:23], v[132:135], v[192:207]
    ds_read_b128 v[20:23], v80 offset:0
    buffer_load_dwordx4 v39, s[36:39], s58 offen offset:3072 lds
    v_add_f32 v98, v98, v208
    v_add_f32 v98, v98, v209
    s_waitcnt lgkmcnt(4)
    v_mfma_f32_32x32x16_bf16 v[192:207], v[0:3], v[136:139], v[192:207]
    ds_read_b128 v[0:3], v73 offset:256
    v_cvt_pk_bf16_f32 v224, v208, v209
    v_exp_f32 v210, v210
    v_mfma_f32_32x32x16_bf16 v[192:207], v[4:7], v[140:143], v[192:207]
    ds_read_b128 v[4:7], v74 offset:256
    v_exp_f32 v211, v211
    v_add_f32 v98, v98, v210
    s_waitcnt lgkmcnt(4)
    v_mfma_f32_32x32x16_bf16 v[192:207], v[8:11], v[144:147], v[192:207]
    s_add_u32 m0, s60, 102400
    ds_read_b128 v[8:11], v75 offset:256
    buffer_load_dwordx4 v40, s[36:39], s58 offen offset:0 lds
    v_add_f32 v98, v98, v211
    v_cvt_pk_bf16_f32 v225, v210, v211
    v_mfma_f32_32x32x16_bf16 v[192:207], v[12:15], v[148:151], v[192:207]
    ds_read_b128 v[12:15], v76 offset:256
    v_exp_f32 v212, v212
    v_exp_f32 v213, v213
    s_waitcnt lgkmcnt(4)
    v_mfma_f32_32x32x16_bf16 v[192:207], v[16:19], v[152:155], v[192:207]
    ds_read_b128 v[16:19], v77 offset:256
    v_add_f32 v98, v98, v212
    v_add_f32 v98, v98, v213
    buffer_load_dwordx4 a[224:227], v97, s[48:51], s18 offen offset:0 sc1
    v_mfma_f32_32x32x16_bf16 v[192:207], v[20:23], v[156:159], v[192:207]
    ds_read_b128 v[20:23], v78 offset:256
    buffer_load_dwordx4 v41, s[36:39], s58 offen offset:1024 lds
    v_cvt_pk_bf16_f32 v226, v212, v213
    v_exp_f32 v214, v214
    s_waitcnt lgkmcnt(4)
    v_mfma_f32_32x32x16_bf16 v[192:207], v[0:3], v[160:163], v[192:207]
    ds_read_b128 v[0:3], v79 offset:256
    v_exp_f32 v215, v215
    v_add_f32 v98, v98, v214
    v_mfma_f32_32x32x16_bf16 v[192:207], v[4:7], v[164:167], v[192:207]
    ds_read_b128 v[4:7], v80 offset:256
    v_add_f32 v98, v98, v215
    v_cvt_pk_bf16_f32 v227, v214, v215
    s_waitcnt lgkmcnt(4)
    v_mfma_f32_32x32x16_bf16 v[192:207], v[8:11], v[168:171], v[192:207]
    ds_read_b64_tr_b16 v[8:9], v52 offset:16384
    ds_read_b64_tr_b16 v[10:11], v52 offset:18432
    buffer_load_dwordx4 v42, s[36:39], s58 offen offset:2048 lds
    v_exp_f32 v216, v216
    v_exp_f32 v217, v217
    v_mfma_f32_32x32x16_bf16 v[192:207], v[12:15], v[172:175], v[192:207]
    ds_read_b64_tr_b16 v[12:13], v53 offset:16384
    ds_read_b64_tr_b16 v[14:15], v53 offset:18432
    v_add_f32 v98, v98, v216
    v_add_f32 v98, v98, v217
    buffer_load_dwordx4 a[228:231], v97, s[48:51], s18 offen offset:1024 sc1
    s_add_u32 s18, s18, 1835008
    s_waitcnt lgkmcnt(6)
    v_mfma_f32_32x32x16_bf16 v[192:207], v[16:19], v[176:179], v[192:207]
    ds_read_b64_tr_b16 v[16:17], v54 offset:16384
    ds_read_b64_tr_b16 v[18:19], v54 offset:18432
    v_cvt_pk_bf16_f32 v228, v216, v217
    v_mfma_f32_32x32x16_bf16 v[192:207], v[20:23], v[180:183], v[192:207]
    ds_read_b64_tr_b16 v[20:21], v55 offset:16384
    ds_read_b64_tr_b16 v[22:23], v55 offset:18432
    buffer_load_dwordx4 v43, s[36:39], s58 offen offset:3072 lds
    s_add_u32 s58, s58, 0x4000
    v_exp_f32 v218, v218
    v_exp_f32 v219, v219
    s_waitcnt lgkmcnt(8)
    v_mfma_f32_32x32x16_bf16 v[192:207], v[0:3], v[184:187], v[192:207]
    ds_read_b64_tr_b16 v[0:1], v52 offset:16640
    ds_read_b64_tr_b16 v[2:3], v52 offset:18688
    v_add_f32 v98, v98, v218
    v_add_f32 v98, v98, v219
    v_mfma_f32_32x32x16_bf16 v[192:207], v[4:7], v[188:191], v[192:207]
    ds_read_b64_tr_b16 v[4:5], v53 offset:16640
    ds_read_b64_tr_b16 v[6:7], v53 offset:18688
    v_cvt_pk_bf16_f32 v229, v218, v219
    s_waitcnt lgkmcnt(8)
    v_mfma_f32_32x32x16_bf16 a[0:15], v[8:11], v[224:227], a[0:15]
    ds_read_b64_tr_b16 v[8:9], v54 offset:16640
    ds_read_b64_tr_b16 v[10:11], v54 offset:18688
    v_exp_f32 v220, v220
    v_exp_f32 v221, v221
    v_mfma_f32_32x32x16_bf16 a[16:31], v[12:15], v[224:227], a[16:31]
    ds_read_b64_tr_b16 v[12:13], v55 offset:16640
    ds_read_b64_tr_b16 v[14:15], v55 offset:18688
    v_add_f32 v98, v98, v220
    v_add_f32 v98, v98, v221
    buffer_load_dwordx4 a[232:235], v97, s[48:51], s18 offen offset:0 sc1
    s_waitcnt lgkmcnt(8)
    v_mfma_f32_32x32x16_bf16 a[32:47], v[16:19], v[224:227], a[32:47]
    ds_read_b64_tr_b16 v[16:17], v52 offset:24576
    ds_read_b64_tr_b16 v[18:19], v52 offset:26624
    v_cvt_pk_bf16_f32 v230, v220, v221
    v_mfma_f32_32x32x16_bf16 a[48:63], v[20:23], v[224:227], a[48:63]
    ds_read_b64_tr_b16 v[20:21], v53 offset:24576
    ds_read_b64_tr_b16 v[22:23], v53 offset:26624
    v_exp_f32 v222, v222
    v_exp_f32 v223, v223
    s_waitcnt lgkmcnt(8)
    v_mfma_f32_32x32x16_bf16 a[64:79], v[0:3], v[224:227], a[64:79]
    ds_read_b64_tr_b16 v[0:1], v54 offset:24576
    ds_read_b64_tr_b16 v[2:3], v54 offset:26624
    v_add_f32 v98, v98, v222
    v_add_f32 v98, v98, v223
    v_mfma_f32_32x32x16_bf16 a[80:95], v[4:7], v[224:227], a[80:95]
    ds_read_b64_tr_b16 v[4:5], v55 offset:24576
    ds_read_b64_tr_b16 v[6:7], v55 offset:26624
    v_cvt_pk_bf16_f32 v231, v222, v223
    s_waitcnt lgkmcnt(8)
    v_mfma_f32_32x32x16_bf16 a[96:111], v[8:11], v[224:227], a[96:111]
    ds_read_b64_tr_b16 v[8:9], v52 offset:24832
    ds_read_b64_tr_b16 v[10:11], v52 offset:26880
    v_max3_f32 v108, v192, v193, v194
    v_mfma_f32_32x32x16_bf16 a[112:127], v[12:15], v[224:227], a[112:127]
    ds_read_b64_tr_b16 v[12:13], v53 offset:24832
    ds_read_b64_tr_b16 v[14:15], v53 offset:26880
    v_max3_f32 v108, v108, v195, v196
    buffer_load_dwordx4 a[236:239], v97, s[48:51], s18 offen offset:1024 sc1
    s_add_u32 s18, s18, 1835008
    s_waitcnt lgkmcnt(8)
    v_mfma_f32_32x32x16_bf16 a[0:15], v[16:19], v[228:231], a[0:15]
    s_waitcnt vmcnt(28)
    s_barrier
    s_add_u32 m0, s60, 131072
    ds_read_b64_tr_b16 v[16:17], v54 offset:24832
    ds_read_b64_tr_b16 v[18:19], v54 offset:26880
    buffer_load_dwordx4 v36, s[36:39], s58 offen offset:0 lds
    v_max3_f32 v108, v108, v197, v198
    v_mfma_f32_32x32x16_bf16 a[16:31], v[20:23], v[228:231], a[16:31]
    ds_read_b64_tr_b16 v[20:21], v55 offset:24832
    ds_read_b64_tr_b16 v[22:23], v55 offset:26880
    v_max3_f32 v108, v108, v199, v200
    s_waitcnt lgkmcnt(8)
    v_mfma_f32_32x32x16_bf16 a[32:47], v[0:3], v[228:231], a[32:47]
    ds_read_b128 v[0:3], v73 offset:32768
    v_max3_f32 v108, v108, v201, v202
    v_mfma_f32_32x32x16_bf16 a[48:63], v[4:7], v[228:231], a[48:63]
    ds_read_b128 v[4:7], v74 offset:32768
    buffer_load_dwordx4 v37, s[36:39], s58 offen offset:1024 lds
    v_max3_f32 v108, v108, v203, v204
    s_waitcnt lgkmcnt(6)
    v_mfma_f32_32x32x16_bf16 a[64:79], v[8:11], v[228:231], a[64:79]
    ds_read_b128 v[8:11], v75 offset:32768
    v_max3_f32 v108, v108, v205, v206
    v_mfma_f32_32x32x16_bf16 a[80:95], v[12:15], v[228:231], a[80:95]
    ds_read_b128 v[12:15], v76 offset:32768
    v_max_f32 v108, v108, v207
    buffer_load_dwordx4 a[240:243], v97, s[48:51], s18 offen offset:0 sc1
    s_waitcnt lgkmcnt(4)
    v_mfma_f32_32x32x16_bf16 a[96:111], v[16:19], v[228:231], a[96:111]
    ds_read_b128 v[16:19], v77 offset:32768
    buffer_load_dwordx4 v38, s[36:39], s58 offen offset:2048 lds
    v_cmp_lt_f32 vcc, s66, v108
    v_mfma_f32_32x32x16_bf16 a[112:127], v[20:23], v[228:231], a[112:127]
    ds_read_b128 v[20:23], v78 offset:32768
    s_cbranch_vccnz L1_tr12
L1_bk12:
    s_waitcnt lgkmcnt(4)
    v_mfma_f32_32x32x16_bf16 v[208:223], v[0:3], v[128:131], v[112:127]
    ds_read_b128 v[0:3], v79 offset:32768
    v_exp_f32 v192, v192
    v_exp_f32 v193, v193
    v_mfma_f32_32x32x16_bf16 v[208:223], v[4:7], v[132:135], v[208:223]
    ds_read_b128 v[4:7], v80 offset:32768
    buffer_load_dwordx4 v39, s[36:39], s58 offen offset:3072 lds
    v_add_f32 v98, v98, v192
    v_add_f32 v98, v98, v193
    s_waitcnt lgkmcnt(4)
    v_mfma_f32_32x32x16_bf16 v[208:223], v[8:11], v[136:139], v[208:223]
    ds_read_b128 v[8:11], v73 offset:33024
    v_cvt_pk_bf16_f32 v224, v192, v193
    v_exp_f32 v194, v194
    buffer_load_dwordx4 a[244:247], v97, s[48:51], s18 offen offset:1024 sc1
    s_add_u32 s18, s18, 1835008
    v_mfma_f32_32x32x16_bf16 v[208:223], v[12:15], v[140:143], v[208:223]
    ds_read_b128 v[12:15], v74 offset:33024
    v_exp_f32 v195, v195
    v_add_f32 v98, v98, v194
    s_waitcnt lgkmcnt(4)
    v_mfma_f32_32x32x16_bf16 v[208:223], v[16:19], v[144:147], v[208:223]
    s_add_u32 m0, s60, 135168
    ds_read_b128 v[16:19], v75 offset:33024
    buffer_load_dwordx4 v40, s[36:39], s58 offen offset:0 lds
    v_add_f32 v98, v98, v195
    v_cvt_pk_bf16_f32 v225, v194, v195
    v_mfma_f32_32x32x16_bf16 v[208:223], v[20:23], v[148:151], v[208:223]
    ds_read_b128 v[20:23], v76 offset:33024
    v_exp_f32 v196, v196
    v_exp_f32 v197, v197
    s_waitcnt lgkmcnt(4)
    v_mfma_f32_32x32x16_bf16 v[208:223], v[0:3], v[152:155], v[208:223]
    ds_read_b128 v[0:3], v77 offset:33024
    v_add_f32 v98, v98, v196
    v_add_f32 v98, v98, v197
    v_mfma_f32_32x32x16_bf16 v[208:223], v[4:7], v[156:159], v[208:223]
    ds_read_b128 v[4:7], v78 offset:33024
    buffer_load_dwordx4 v41, s[36:39], s58 offen offset:1024 lds
    v_cvt_pk_bf16_f32 v226, v196, v197
    v_exp_f32 v198, v198
    s_waitcnt lgkmcnt(4)
    v_mfma_f32_32x32x16_bf16 v[208:223], v[8:11], v[160:163], v[208:223]
    ds_read_b128 v[8:11], v79 offset:33024
    v_exp_f32 v199, v199
    v_add_f32 v98, v98, v198
    buffer_load_dwordx4 a[248:251], v97, s[48:51], s18 offen offset:0 sc1
    v_mfma_f32_32x32x16_bf16 v[208:223], v[12:15], v[164:167], v[208:223]
    ds_read_b128 v[12:15], v80 offset:33024
    v_add_f32 v98, v98, v199
    v_cvt_pk_bf16_f32 v227, v198, v199
    s_waitcnt lgkmcnt(4)
    v_mfma_f32_32x32x16_bf16 v[208:223], v[16:19], v[168:171], v[208:223]
    ds_read_b64_tr_b16 v[16:17], v52 offset:49152
    ds_read_b64_tr_b16 v[18:19], v52 offset:51200
    buffer_load_dwordx4 v42, s[36:39], s58 offen offset:2048 lds
    v_exp_f32 v200, v200
    v_exp_f32 v201, v201
    v_mfma_f32_32x32x16_bf16 v[208:223], v[20:23], v[172:175], v[208:223]
    ds_read_b64_tr_b16 v[20:21], v53 offset:49152
    ds_read_b64_tr_b16 v[22:23], v53 offset:51200
    v_add_f32 v98, v98, v200
    v_add_f32 v98, v98, v201
    s_waitcnt lgkmcnt(6)
    v_mfma_f32_32x32x16_bf16 v[208:223], v[0:3], v[176:179], v[208:223]
    ds_read_b64_tr_b16 v[0:1], v54 offset:49152
    ds_read_b64_tr_b16 v[2:3], v54 offset:51200
    v_cvt_pk_bf16_f32 v228, v200, v201
    v_mfma_f32_32x32x16_bf16 v[208:223], v[4:7], v[180:183], v[208:223]
    ds_read_b64_tr_b16 v[4:5], v55 offset:49152
    ds_read_b64_tr_b16 v[6:7], v55 offset:51200
    buffer_load_dwordx4 v43, s[36:39], s58 offen offset:3072 lds
    s_add_u32 s58, s58, 0x4000
    v_exp_f32 v202, v202
    v_exp_f32 v203, v203
    s_waitcnt lgkmcnt(8)
    v_mfma_f32_32x32x16_bf16 v[208:223], v[8:11], v[184:187], v[208:223]
    ds_read_b64_tr_b16 v[8:9], v52 offset:49408
    ds_read_b64_tr_b16 v[10:11], v52 offset:51456
    v_add_f32 v98, v98, v202
    v_add_f32 v98, v98, v203
    buffer_load_dwordx4 a[252:255], v97, s[48:51], s18 offen offset:1024 sc1
    s_add_u32 s18, s18, 1835008
    v_mfma_f32_32x32x16_bf16 v[208:223], v[12:15], v[188:191], v[208:223]
    ds_read_b64_tr_b16 v[12:13], v53 offset:49408
    ds_read_b64_tr_b16 v[14:15], v53 offset:51456
    v_cvt_pk_bf16_f32 v229, v202, v203
    s_waitcnt lgkmcnt(8)
    v_mfma_f32_32x32x16_bf16 a[0:15], v[16:19], v[224:227], a[0:15]
    ds_read_b64_tr_b16 v[16:17], v54 offset:49408
    ds_read_b64_tr_b16 v[18:19], v54 offset:51456
    v_exp_f32 v204, v204
    v_exp_f32 v205, v205
    v_mfma_f32_32x32x16_bf16 a[16:31], v[20:23], v[224:227], a[16:31]
    ds_read_b64_tr_b16 v[20:21], v55 offset:49408
    ds_read_b64_tr_b16 v[22:23], v55 offset:51456
    v_add_f32 v98, v98, v204
    v_add_f32 v98, v98, v205
    s_waitcnt lgkmcnt(8)
    v_mfma_f32_32x32x16_bf16 a[32:47], v[0:3], v[224:227], a[32:47]
    ds_read_b64_tr_b16 v[0:1], v52 offset:57344
    ds_read_b64_tr_b16 v[2:3], v52 offset:59392
    v_cvt_pk_bf16_f32 v230, v204, v205
    v_mfma_f32_32x32x16_bf16 a[48:63], v[4:7], v[224:227], a[48:63]
    ds_read_b64_tr_b16 v[4:5], v53 offset:57344
    ds_read_b64_tr_b16 v[6:7], v53 offset:59392
    v_exp_f32 v206, v206
    v_exp_f32 v207, v207
    s_waitcnt lgkmcnt(8)
    v_mfma_f32_32x32x16_bf16 a[64:79], v[8:11], v[224:227], a[64:79]
    ds_read_b64_tr_b16 v[8:9], v54 offset:57344
    ds_read_b64_tr_b16 v[10:11], v54 offset:59392
    v_add_f32 v98, v98, v206
    v_add_f32 v98, v98, v207
    buffer_load_dwordx4 a[128:131], v97, s[48:51], s18 offen offset:0 sc1
    v_mfma_f32_32x32x16_bf16 a[80:95], v[12:15], v[224:227], a[80:95]
    ds_read_b64_tr_b16 v[12:13], v55 offset:57344
    ds_read_b64_tr_b16 v[14:15], v55 offset:59392
    v_cvt_pk_bf16_f32 v231, v206, v207
    s_waitcnt lgkmcnt(8)
    v_mfma_f32_32x32x16_bf16 a[96:111], v[16:19], v[224:227], a[96:111]
    ds_read_b64_tr_b16 v[16:17], v52 offset:57600
    ds_read_b64_tr_b16 v[18:19], v52 offset:59648
    v_max3_f32 v108, v208, v209, v210
    v_mfma_f32_32x32x16_bf16 a[112:127], v[20:23], v[224:227], a[112:127]
    ds_read_b64_tr_b16 v[20:21], v53 offset:57600
    ds_read_b64_tr_b16 v[22:23], v53 offset:59648
    v_max3_f32 v108, v108, v211, v212
    s_waitcnt lgkmcnt(8)
    v_mfma_f32_32x32x16_bf16 a[0:15], v[0:3], v[228:231], a[0:15]
    s_waitcnt vmcnt(29)
    s_barrier
    s_add_u32 m0, s60, 0
    ds_read_b64_tr_b16 v[0:1], v54 offset:57600
    ds_read_b64_tr_b16 v[2:3], v54 offset:59648
    buffer_load_dwordx4 v44, s[40:43], s59 offen offset:0 lds
    v_max3_f32 v108, v108, v213, v214
    v_mfma_f32_32x32x16_bf16 a[16:31], v[4:7], v[228:231], a[16:31]
    ds_read_b64_tr_b16 v[4:5], v55 offset:57600
    ds_read_b64_tr_b16 v[6:7], v55 offset:59648
    v_max3_f32 v108, v108, v215, v216
    buffer_load_dwordx4 a[132:135], v97, s[48:51], s18 offen offset:1024 sc1
    s_add_u32 s18, s18, 1835008
    s_waitcnt lgkmcnt(8)
    v_mfma_f32_32x32x16_bf16 a[32:47], v[8:11], v[228:231], a[32:47]
    ds_read_b128 v[8:11], v81 offset:0
    v_max3_f32 v108, v108, v217, v218
    v_mfma_f32_32x32x16_bf16 a[48:63], v[12:15], v[228:231], a[48:63]
    ds_read_b128 v[12:15], v82 offset:0
    buffer_load_dwordx4 v45, s[40:43], s59 offen offset:1024 lds
    v_max3_f32 v108, v108, v219, v220
    s_waitcnt lgkmcnt(6)
    v_mfma_f32_32x32x16_bf16 a[64:79], v[16:19], v[228:231], a[64:79]
    ds_read_b128 v[16:19], v83 offset:0
    v_max3_f32 v108, v108, v221, v222
    v_mfma_f32_32x32x16_bf16 a[80:95], v[20:23], v[228:231], a[80:95]
    ds_read_b128 v[20:23], v84 offset:0
    v_max_f32 v108, v108, v223
    s_waitcnt lgkmcnt(4)
    v_mfma_f32_32x32x16_bf16 a[96:111], v[0:3], v[228:231], a[96:111]
    ds_read_b128 v[0:3], v85 offset:0
    buffer_load_dwordx4 v46, s[40:43], s59 offen offset:2048 lds
    v_cmp_lt_f32 vcc, s66, v108
    v_mfma_f32_32x32x16_bf16 a[112:127], v[4:7], v[228:231], a[112:127]
    ds_read_b128 v[4:7], v86 offset:0
    s_cbranch_vccnz L1_tr13
L1_bk13:
    buffer_load_dwordx4 a[136:139], v97, s[48:51], s18 offen offset:0 sc1
    s_waitcnt lgkmcnt(4)
    v_mfma_f32_32x32x16_bf16 v[192:207], v[8:11], v[128:131], v[112:127]
    ds_read_b128 v[8:11], v87 offset:0
    v_exp_f32 v208, v208
    v_exp_f32 v209, v209
    v_mfma_f32_32x32x16_bf16 v[192:207], v[12:15], v[132:135], v[192:207]
    ds_read_b128 v[12:15], v88 offset:0
    buffer_load_dwordx4 v47, s[40:43], s59 offen offset:3072 lds
    v_add_f32 v98, v98, v208
    v_add_f32 v98, v98, v209
    s_waitcnt lgkmcnt(4)
    v_mfma_f32_32x32x16_bf16 v[192:207], v[16:19], v[136:139], v[192:207]
    ds_read_b128 v[16:19], v81 offset:256
    v_cvt_pk_bf16_f32 v224, v208, v209
    v_exp_f32 v210, v210
    v_mfma_f32_32x32x16_bf16 v[192:207], v[20:23], v[140:143], v[192:207]
    ds_read_b128 v[20:23], v82 offset:256
    v_exp_f32 v211, v211
    v_add_f32 v98, v98, v210
    s_waitcnt lgkmcnt(4)
    v_mfma_f32_32x32x16_bf16 v[192:207], v[0:3], v[144:147], v[192:207]
    s_add_u32 m0, s60, 4096
    ds_read_b128 v[0:3], v83 offset:256
    buffer_load_dwordx4 v48, s[40:43], s59 offen offset:0 lds
    v_add_f32 v98, v98, v211
    v_cvt_pk_bf16_f32 v225, v210, v211
    v_mfma_f32_32x32x16_bf16 v[192:207], v[4:7], v[148:151], v[192:207]
    ds_read_b128 v[4:7], v84 offset:256
    v_exp_f32 v212, v212
    v_exp_f32 v213, v213
    buffer_load_dwordx4 a[140:143], v97, s[48:51], s18 offen offset:1024 sc1
    s_add_u32 s18, s18, 1835008
    s_waitcnt lgkmcnt(4)
    v_mfma_f32_32x32x16_bf16 v[192:207], v[8:11], v[152:155], v[192:207]
    ds_read_b128 v[8:11], v85 offset:256
    v_add_f32 v98, v98, v212
    v_add_f32 v98, v98, v213
    v_mfma_f32_32x32x16_bf16 v[192:207], v[12:15], v[156:159], v[192:207]
    ds_read_b128 v[12:15], v86 offset:256
    buffer_load_dwordx4 v49, s[40:43], s59 offen offset:1024 lds
    v_cvt_pk_bf16_f32 v226, v212, v213
    v_exp_f32 v214, v214
    s_waitcnt lgkmcnt(4)
    v_mfma_f32_32x32x16_bf16 v[192:207], v[16:19], v[160:163], v[192:207]
    ds_read_b128 v[16:19], v87 offset:256
    v_exp_f32 v215, v215
    v_add_f32 v98, v98, v214
    v_mfma_f32_32x32x16_bf16 v[192:207], v[20:23], v[164:167], v[192:207]
    ds_read_b128 v[20:23], v88 offset:256
    v_add_f32 v98, v98, v215
    v_cvt_pk_bf16_f32 v227, v214, v215
    s_waitcnt lgkmcnt(4)
    v_mfma_f32_32x32x16_bf16 v[192:207], v[0:3], v[168:171], v[192:207]
    ds_read_b64_tr_b16 v[0:1], v56 offset:16384
    ds_read_b64_tr_b16 v[2:3], v56 offset:18432
    buffer_load_dwordx4 v50, s[40:43], s59 offen offset:2048 lds
    v_exp_f32 v216, v216
    v_exp_f32 v217, v217
    v_mfma_f32_32x32x16_bf16 v[192:207], v[4:7], v[172:175], v[192:207]
    ds_read_b64_tr_b16 v[4:5], v57 offset:16384
    ds_read_b64_tr_b16 v[6:7], v57 offset:18432
    v_add_f32 v98, v98, v216
    v_add_f32 v98, v98, v217
    buffer_load_dwordx4 a[144:147], v97, s[48:51], s18 offen offset:0 sc1
    s_waitcnt lgkmcnt(6)
    v_mfma_f32_32x32x16_bf16 v[192:207], v[8:11], v[176:179], v[192:207]
    ds_read_b64_tr_b16 v[8:9], v58 offset:16384
    ds_read_b64_tr_b16 v[10:11], v58 offset:18432
    v_cvt_pk_bf16_f32 v228, v216, v217
    v_mfma_f32_32x32x16_bf16 v[192:207], v[12:15], v[180:183], v[192:207]
    ds_read_b64_tr_b16 v[12:13], v59 offset:16384
    ds_read_b64_tr_b16 v[14:15], v59 offset:18432
    buffer_load_dwordx4 v51, s[40:43], s59 offen offset:3072 lds
    s_add_u32 s59, s59, 128
    s_cmp_eq_u32 s59, s23
    s_cselect_b32 s63, 896, 0
    s_sub_u32 s59, s59, s63
    v_exp_f32 v218, v218
    v_exp_f32 v219, v219
    s_waitcnt lgkmcnt(8)
    v_mfma_f32_32x32x16_bf16 v[192:207], v[16:19], v[184:187], v[192:207]
    ds_read_b64_tr_b16 v[16:17], v56 offset:16640
    ds_read_b64_tr_b16 v[18:19], v56 offset:18688
    v_add_f32 v98, v98, v218
    v_add_f32 v98, v98, v219
    v_mfma_f32_32x32x16_bf16 v[192:207], v[20:23], v[188:191], v[192:207]
    ds_read_b64_tr_b16 v[20:21], v57 offset:16640
    ds_read_b64_tr_b16 v[22:23], v57 offset:18688
    v_cvt_pk_bf16_f32 v229, v218, v219
    s_waitcnt lgkmcnt(8)
    v_mfma_f32_32x32x16_bf16 a[0:15], v[0:3], v[224:227], a[0:15]
    ds_read_b64_tr_b16 v[0:1], v58 offset:16640
    ds_read_b64_tr_b16 v[2:3], v58 offset:18688
    v_exp_f32 v220, v220
    v_exp_f32 v221, v221
    buffer_load_dwordx4 a[148:151], v97, s[48:51], s18 offen offset:1024 sc1
    s_add_u32 s18, s18, 1835008
    v_mfma_f32_32x32x16_bf16 a[16:31], v[4:7], v[224:227], a[16:31]
    ds_read_b64_tr_b16 v[4:5], v59 offset:16640
    ds_read_b64_tr_b16 v[6:7], v59 offset:18688
    v_add_f32 v98, v98, v220
    v_add_f32 v98, v98, v221
    s_waitcnt lgkmcnt(8)
    v_mfma_f32_32x32x16_bf16 a[32:47], v[8:11], v[224:227], a[32:47]
    ds_read_b64_tr_b16 v[8:9], v56 offset:24576
    ds_read_b64_tr_b16 v[10:11], v56 offset:26624
    v_cvt_pk_bf16_f32 v230, v220, v221
    v_mfma_f32_32x32x16_bf16 a[48:63], v[12:15], v[224:227], a[48:63]
    ds_read_b64_tr_b16 v[12:13], v57 offset:24576
    ds_read_b64_tr_b16 v[14:15], v57 offset:26624
    v_exp_f32 v222, v222
    v_exp_f32 v223, v223
    s_waitcnt lgkmcnt(8)
    v_mfma_f32_32x32x16_bf16 a[64:79], v[16:19], v[224:227], a[64:79]
    ds_read_b64_tr_b16 v[16:17], v58 offset:24576
    ds_read_b64_tr_b16 v[18:19], v58 offset:26624
    v_add_f32 v98, v98, v222
    v_add_f32 v98, v98, v223
    v_mfma_f32_32x32x16_bf16 a[80:95], v[20:23], v[224:227], a[80:95]
    ds_read_b64_tr_b16 v[20:21], v59 offset:24576
    ds_read_b64_tr_b16 v[22:23], v59 offset:26624
    v_cvt_pk_bf16_f32 v231, v222, v223
    s_waitcnt lgkmcnt(8)
    v_mfma_f32_32x32x16_bf16 a[96:111], v[0:3], v[224:227], a[96:111]
    ds_read_b64_tr_b16 v[0:1], v56 offset:24832
    ds_read_b64_tr_b16 v[2:3], v56 offset:26880
    v_max3_f32 v108, v192, v193, v194
    buffer_load_dwordx4 a[152:155], v97, s[48:51], s18 offen offset:0 sc1
    v_mfma_f32_32x32x16_bf16 a[112:127], v[4:7], v[224:227], a[112:127]
    ds_read_b64_tr_b16 v[4:5], v57 offset:24832
    ds_read_b64_tr_b16 v[6:7], v57 offset:26880
    v_max3_f32 v108, v108, v195, v196
    s_waitcnt lgkmcnt(8)
    v_mfma_f32_32x32x16_bf16 a[0:15], v[8:11], v[228:231], a[0:15]
    s_waitcnt vmcnt(29)
    s_barrier
    s_add_u32 m0, s60, 32768
    ds_read_b64_tr_b16 v[8:9], v58 offset:24832
    ds_read_b64_tr_b16 v[10:11], v58 offset:26880
    buffer_load_dwordx4 v44, s[40:43], s59 offen offset:0 lds
    v_max3_f32 v108, v108, v197, v198
    v_mfma_f32_32x32x16_bf16 a[16:31], v[12:15], v[228:231], a[16:31]
    ds_read_b64_tr_b16 v[12:13], v59 offset:24832
    ds_read_b64_tr_b16 v[14:15], v59 offset:26880
    v_max3_f32 v108, v108, v199, v200
    s_waitcnt lgkmcnt(8)
    v_mfma_f32_32x32x16_bf16 a[32:47], v[16:19], v[228:231], a[32:47]
    ds_read_b128 v[16:19], v81 offset:32768
    v_max3_f32 v108, v108, v201, v202
    v_mfma_f32_32x32x16_bf16 a[48:63], v[20:23], v[228:231], a[48:63]
    ds_read_b128 v[20:23], v82 offset:32768
    buffer_load_dwordx4 v45, s[40:43], s59 offen offset:1024 lds
    v_max3_f32 v108, v108, v203, v204
    s_waitcnt lgkmcnt(6)
    v_mfma_f32_32x32x16_bf16 a[64:79], v[0:3], v[228:231], a[64:79]
    ds_read_b128 v[0:3], v83 offset:32768
    v_max3_f32 v108, v108, v205, v206
    buffer_load_dwordx4 a[156:159], v97, s[48:51], s18 offen offset:1024 sc1
    s_add_u32 s18, s18, 1835008
    v_mfma_f32_32x32x16_bf16 a[80:95], v[4:7], v[228:231], a[80:95]
    ds_read_b128 v[4:7], v84 offset:32768
    v_max_f32 v108, v108, v207
    s_waitcnt lgkmcnt(4)
    v_mfma_f32_32x32x16_bf16 a[96:111], v[8:11], v[228:231], a[96:111]
    ds_read_b128 v[8:11], v85 offset:32768
    buffer_load_dwordx4 v46, s[40:43], s59 offen offset:2048 lds
    v_cmp_lt_f32 vcc, s66, v108
    v_mfma_f32_32x32x16_bf16 a[112:127], v[12:15], v[228:231], a[112:127]
    ds_read_b128 v[12:15], v86 offset:32768
    s_cbranch_vccnz L1_tr14
L1_bk14:
    s_waitcnt lgkmcnt(4)
    v_mfma_f32_32x32x16_bf16 v[208:223], v[16:19], v[128:131], v[112:127]
    ds_read_b128 v[16:19], v87 offset:32768
    v_exp_f32 v192, v192
    v_exp_f32 v193, v193
    v_mfma_f32_32x32x16_bf16 v[208:223], v[20:23], v[132:135], v[208:223]
    ds_read_b128 v[20:23], v88 offset:32768
    buffer_load_dwordx4 v47, s[40:43], s59 offen offset:3072 lds
    v_add_f32 v98, v98, v192
    v_add_f32 v98, v98, v193
    s_waitcnt lgkmcnt(4)
    v_mfma_f32_32x32x16_bf16 v[208:223], v[0:3], v[136:139], v[208:223]
    ds_read_b128 v[0:3], v81 offset:33024
    v_cvt_pk_bf16_f32 v224, v192, v193
    v_exp_f32 v194, v194
    buffer_load_dwordx4 a[160:163], v97, s[48:51], s18 offen offset:0 sc1
    v_mfma_f32_32x32x16_bf16 v[208:223], v[4:7], v[140:143], v[208:223]
    ds_read_b128 v[4:7], v82 offset:33024
    v_exp_f32 v195, v195
    v_add_f32 v98, v98, v194
    s_waitcnt lgkmcnt(4)
    v_mfma_f32_32x32x16_bf16 v[208:223], v[8:11], v[144:147], v[208:223]
    s_add_u32 m0, s60, 36864
    ds_read_b128 v[8:11], v83 offset:33024
    buffer_load_dwordx4 v48, s[40:43], s59 offen offset:0 lds
    v_add_f32 v98, v98, v195
    v_cvt_pk_bf16_f32 v225, v194, v195
    v_mfma_f32_32x32x16_bf16 v[208:223], v[12:15], v[148:151], v[208:223]
    ds_read_b128 v[12:15], v84 offset:33024
    v_exp_f32 v196, v196
    v_exp_f32 v197, v197
    s_waitcnt lgkmcnt(4)
    v_mfma_f32_32x32x16_bf16 v[208:223], v[16:19], v[152:155], v[208:223]
    ds_read_b128 v[16:19], v85 offset:33024
    v_add_f32 v98, v98, v196
    v_add_f32 v98, v98, v197
    v_mfma_f32_32x32x16_bf16 v[208:223], v[20:23], v[156:159], v[208:223]
    ds_read_b128 v[20:23], v86 offset:33024
    buffer_load_dwordx4 v49, s[40:43], s59 offen offset:1024 lds
    v_cvt_pk_bf16_f32 v226, v196, v197
    v_exp_f32 v198, v198
    buffer_load_dwordx4 a[164:167], v97, s[48:51], s18 offen offset:1024 sc1
    s_add_u32 s18, s18, 1835008
    s_waitcnt lgkmcnt(4)
    v_mfma_f32_32x32x16_bf16 v[208:223], v[0:3], v[160:163], v[208:223]
    ds_read_b128 v[0:3], v87 offset:33024
    v_exp_f32 v199, v199
    v_add_f32 v98, v98, v198
    v_mfma_f32_32x32x16_bf16 v[208:223], v[4:7], v[164:167], v[208:223]
    ds_read_b128 v[4:7], v88 offset:33024
    v_add_f32 v98, v98, v199
    v_cvt_pk_bf16_f32 v227, v198, v199
    s_waitcnt lgkmcnt(4)
    v_mfma_f32_32x32x16_bf16 v[208:223], v[8:11], v[168:171], v[208:223]
    ds_read_b64_tr_b16 v[8:9], v56 offset:49152
    ds_read_b64_tr_b16 v[10:11], v56 offset:51200
    buffer_load_dwordx4 v50, s[40:43], s59 offen offset:2048 lds
    v_exp_f32 v200, v200
    v_exp_f32 v201, v201
    v_mfma_f32_32x32x16_bf16 v[208:223], v[12:15], v[172:175], v[208:223]
    ds_read_b64_tr_b16 v[12:13], v57 offset:49152
    ds_read_b64_tr_b16 v[14:15], v57 offset:51200
    v_add_f32 v98, v98, v200
    v_add_f32 v98, v98, v201
    s_waitcnt lgkmcnt(6)
    v_mfma_f32_32x32x16_bf16 v[208:223], v[16:19], v[176:179], v[208:223]
    ds_read_b64_tr_b16 v[16:17], v58 offset:49152
    ds_read_b64_tr_b16 v[18:19], v58 offset:51200
    v_cvt_pk_bf16_f32 v228, v200, v201
    v_mfma_f32_32x32x16_bf16 v[208:223], v[20:23], v[180:183], v[208:223]
    ds_read_b64_tr_b16 v[20:21], v59 offset:49152
    ds_read_b64_tr_b16 v[22:23], v59 offset:51200
    buffer_load_dwordx4 v51, s[40:43], s59 offen offset:3072 lds
    s_add_u32 s59, s59, 128
    s_cmp_eq_u32 s59, s23
    s_cselect_b32 s63, 896, 0
    s_sub_u32 s59, s59, s63
    v_exp_f32 v202, v202
    v_exp_f32 v203, v203
    buffer_load_dwordx4 a[168:171], v97, s[48:51], s18 offen offset:0 sc1
    s_waitcnt lgkmcnt(8)
    v_mfma_f32_32x32x16_bf16 v[208:223], v[0:3], v[184:187], v[208:223]
    ds_read_b64_tr_b16 v[0:1], v56 offset:49408
    ds_read_b64_tr_b16 v[2:3], v56 offset:51456
    v_add_f32 v98, v98, v202
    v_add_f32 v98, v98, v203
    v_mfma_f32_32x32x16_bf16 v[208:223], v[4:7], v[188:191], v[208:223]
    ds_read_b64_tr_b16 v[4:5], v57 offset:49408
    ds_read_b64_tr_b16 v[6:7], v57 offset:51456
    v_cvt_pk_bf16_f32 v229, v202, v203
    s_waitcnt lgkmcnt(8)
    v_mfma_f32_32x32x16_bf16 a[0:15], v[8:11], v[224:227], a[0:15]
    ds_read_b64_tr_b16 v[8:9], v58 offset:49408
    ds_read_b64_tr_b16 v[10:11], v58 offset:51456
    v_exp_f32 v204, v204
    v_exp_f32 v205, v205
    v_mfma_f32_32x32x16_bf16 a[16:31], v[12:15], v[224:227], a[16:31]
    ds_read_b64_tr_b16 v[12:13], v59 offset:49408
    ds_read_b64_tr_b16 v[14:15], v59 offset:51456
    v_add_f32 v98, v98, v204
    v_add_f32 v98, v98, v205
    s_waitcnt lgkmcnt(8)
    v_mfma_f32_32x32x16_bf16 a[32:47], v[16:19], v[224:227], a[32:47]
    ds_read_b64_tr_b16 v[16:17], v56 offset:57344
    ds_read_b64_tr_b16 v[18:19], v56 offset:59392
    v_cvt_pk_bf16_f32 v230, v204, v205
    v_mfma_f32_32x32x16_bf16 a[48:63], v[20:23], v[224:227], a[48:63]
    ds_read_b64_tr_b16 v[20:21], v57 offset:57344
    ds_read_b64_tr_b16 v[22:23], v57 offset:59392
    v_exp_f32 v206, v206
    v_exp_f32 v207, v207
    buffer_load_dwordx4 a[172:175], v97, s[48:51], s18 offen offset:1024 sc1
    s_add_u32 s18, s18, 1835008
    s_waitcnt lgkmcnt(8)
    v_mfma_f32_32x32x16_bf16 a[64:79], v[0:3], v[224:227], a[64:79]
    ds_read_b64_tr_b16 v[0:1], v58 offset:57344
    ds_read_b64_tr_b16 v[2:3], v58 offset:59392
    v_add_f32 v98, v98, v206
    v_add_f32 v98, v98, v207
    v_mfma_f32_32x32x16_bf16 a[80:95], v[4:7], v[224:227], a[80:95]
    ds_read_b64_tr_b16 v[4:5], v59 offset:57344
    ds_read_b64_tr_b16 v[6:7], v59 offset:59392
    v_cvt_pk_bf16_f32 v231, v206, v207
    s_waitcnt lgkmcnt(8)
    v_mfma_f32_32x32x16_bf16 a[96:111], v[8:11], v[224:227], a[96:111]
    ds_read_b64_tr_b16 v[8:9], v56 offset:57600
    ds_read_b64_tr_b16 v[10:11], v56 offset:59648
    v_max3_f32 v108, v208, v209, v210
    v_mfma_f32_32x32x16_bf16 a[112:127], v[12:15], v[224:227], a[112:127]
    ds_read_b64_tr_b16 v[12:13], v57 offset:57600
    ds_read_b64_tr_b16 v[14:15], v57 offset:59648
    v_max3_f32 v108, v108, v211, v212
    s_waitcnt lgkmcnt(8)
    v_mfma_f32_32x32x16_bf16 a[0:15], v[16:19], v[228:231], a[0:15]
    s_waitcnt vmcnt(29)
    s_barrier
    s_add_u32 m0, s60, 65536
    ds_read_b64_tr_b16 v[16:17], v58 offset:57600
    ds_read_b64_tr_b16 v[18:19], v58 offset:59648
    buffer_load_dwordx4 v44, s[40:43], s59 offen offset:0 lds
    v_max3_f32 v108, v108, v213, v214
    v_mfma_f32_32x32x16_bf16 a[16:31], v[20:23], v[228:231], a[16:31]
    ds_read_b64_tr_b16 v[20:21], v59 offset:57600
    ds_read_b64_tr_b16 v[22:23], v59 offset:59648
    v_max3_f32 v108, v108, v215, v216
    buffer_load_dwordx4 a[176:179], v97, s[48:51], s18 offen offset:0 sc1
    s_waitcnt lgkmcnt(8)
    v_mfma_f32_32x32x16_bf16 a[32:47], v[0:3], v[228:231], a[32:47]
    ds_read_b64_tr_b16 v[0:1], v60 offset:16384
    ds_read_b64_tr_b16 v[2:3], v60 offset:18432
    v_max3_f32 v108, v108, v217, v218
    v_mfma_f32_32x32x16_bf16 a[48:63], v[4:7], v[228:231], a[48:63]
    ds_read_b64_tr_b16 v[4:5], v61 offset:16384
    ds_read_b64_tr_b16 v[6:7], v61 offset:18432
    buffer_load_dwordx4 v45, s[40:43], s59 offen offset:1024 lds
    v_max3_f32 v108, v108, v219, v220
    s_waitcnt lgkmcnt(8)
    v_mfma_f32_32x32x16_bf16 a[64:79], v[8:11], v[228:231], a[64:79]
    ds_read_b64_tr_b16 v[8:9], v62 offset:16384
    ds_read_b64_tr_b16 v[10:11], v62 offset:18432
    v_max3_f32 v108, v108, v221, v222
    v_mfma_f32_32x32x16_bf16 a[80:95], v[12:15], v[228:231], a[80:95]
    ds_read_b64_tr_b16 v[12:13], v63 offset:16384
    ds_read_b64_tr_b16 v[14:15], v63 offset:18432
    v_max_f32 v108, v108, v223
    s_waitcnt lgkmcnt(8)
    v_mfma_f32_32x32x16_bf16 a[96:111], v[16:19], v[228:231], a[96:111]
    ds_read_b64_tr_b16 v[16:17], v60 offset:16640
    ds_read_b64_tr_b16 v[18:19], v60 offset:18688
    buffer_load_dwordx4 v46, s[40:43], s59 offen offset:2048 lds
    v_cmp_lt_f32 vcc, s66, v108
    buffer_load_dwordx4 a[180:183], v97, s[48:51], s18 offen offset:1024 sc1
    s_add_u32 s18, s18, 1835008
    v_mfma_f32_32x32x16_bf16 a[112:127], v[20:23], v[228:231], a[112:127]
    ds_read_b64_tr_b16 v[20:21], v61 offset:16640
    ds_read_b64_tr_b16 v[22:23], v61 offset:18688
    s_cbranch_vccnz L1_tr15
L1_bk15:
    v_exp_f32 v208, v208
    v_exp_f32 v209, v209
    v_add_f32 v98, v98, v208
    v_add_f32 v98, v98, v209
    v_cvt_pk_bf16_f32 v224, v208, v209
    v_exp_f32 v210, v210
    v_exp_f32 v211, v211
    v_add_f32 v98, v98, v210
    v_add_f32 v98, v98, v211
    v_cvt_pk_bf16_f32 v225, v210, v211
    v_exp_f32 v212, v212
    v_exp_f32 v213, v213
    v_add_f32 v98, v98, v212
    v_add_f32 v98, v98, v213
    v_cvt_pk_bf16_f32 v226, v212, v213
    v_exp_f32 v214, v214
    v_exp_f32 v215, v215
    v_add_f32 v98, v98, v214
    v_add_f32 v98, v98, v215
    v_cvt_pk_bf16_f32 v227, v214, v215
    s_waitcnt lgkmcnt(8)
    s_nop 0
    v_mfma_f32_32x32x16_bf16 a[0:15], v[0:3], v[224:227], a[0:15]
    ds_read_b64_tr_b16 v[0:1], v62 offset:16640
    ds_read_b64_tr_b16 v[2:3], v62 offset:18688
    v_exp_f32 v216, v216
    v_exp_f32 v217, v217
    v_add_f32 v98, v98, v216
    v_mfma_f32_32x32x16_bf16 a[16:31], v[4:7], v[224:227], a[16:31]
    ds_read_b64_tr_b16 v[4:5], v63 offset:16640
    ds_read_b64_tr_b16 v[6:7], v63 offset:18688
    buffer_load_dwordx4 v47, s[40:43], s59 offen offset:3072 lds
    v_add_f32 v98, v98, v217
    v_cvt_pk_bf16_f32 v228, v216, v217
    v_exp_f32 v218, v218
    s_waitcnt lgkmcnt(8)
    v_mfma_f32_32x32x16_bf16 a[32:47], v[8:11], v[224:227], a[32:47]
    ds_read_b64_tr_b16 v[8:9], v60 offset:24576
    ds_read_b64_tr_b16 v[10:11], v60 offset:26624
    v_exp_f32 v219, v219
    v_add_f32 v98, v98, v218
    v_add_f32 v98, v98, v219
    v_mfma_f32_32x32x16_bf16 a[48:63], v[12:15], v[224:227], a[48:63]
    ds_read_b64_tr_b16 v[12:13], v61 offset:24576
    ds_read_b64_tr_b16 v[14:15], v61 offset:26624
    v_cvt_pk_bf16_f32 v229, v218, v219
    v_exp_f32 v220, v220
    v_exp_f32 v221, v221
    s_waitcnt lgkmcnt(8)
    v_mfma_f32_32x32x16_bf16 a[64:79], v[16:19], v[224:227], a[64:79]
    s_add_u32 m0, s60, 69632
    ds_read_b64_tr_b16 v[16:17], v62 offset:24576
    ds_read_b64_tr_b16 v[18:19], v62 offset:26624
    buffer_load_dwordx4 v48, s[40:43], s59 offen offset:0 lds
    v_add_f32 v98, v98, v220
    v_add_f32 v98, v98, v221
    v_cvt_pk_bf16_f32 v230, v220, v221
    buffer_load_dwordx4 a[184:187], v97, s[48:51], s18 offen offset:0 sc1
    v_mfma_f32_32x32x16_bf16 a[80:95], v[20:23], v[224:227], a[80:95]
    ds_read_b64_tr_b16 v[20:21], v63 offset:24576
    ds_read_b64_tr_b16 v[22:23], v63 offset:26624
    v_exp_f32 v222, v222
    v_exp_f32 v223, v223
    v_add_f32 v98, v98, v222
    s_waitcnt lgkmcnt(8)
    v_mfma_f32_32x32x16_bf16 a[96:111], v[0:3], v[224:227], a[96:111]
    ds_read_b64_tr_b16 v[0:1], v60 offset:24832
    ds_read_b64_tr_b16 v[2:3], v60 offset:26880
    v_add_f32 v98, v98, v223
    v_cvt_pk_bf16_f32 v231, v222, v223
    v_mfma_f32_32x32x16_bf16 a[112:127], v[4:7], v[224:227], a[112:127]
    ds_read_b64_tr_b16 v[4:5], v61 offset:24832
    ds_read_b64_tr_b16 v[6:7], v61 offset:26880
    buffer_load_dwordx4 v49, s[40:43], s59 offen offset:1024 lds
    s_waitcnt lgkmcnt(8)
    v_mfma_f32_32x32x16_bf16 a[0:15], v[8:11], v[228:231], a[0:15]
    s_waitcnt vmcnt(24)
    s_barrier
    ds_read_b64_tr_b16 v[8:9], v62 offset:24832
    ds_read_b64_tr_b16 v[10:11], v62 offset:26880
    buffer_load_dwordx4 v50, s[40:43], s59 offen offset:2048 lds
    v_mfma_f32_32x32x16_bf16 a[16:31], v[12:15], v[228:231], a[16:31]
    ds_read_b64_tr_b16 v[12:13], v63 offset:24832
    ds_read_b64_tr_b16 v[14:15], v63 offset:26880
    buffer_load_dwordx4 v51, s[40:43], s59 offen offset:3072 lds
    s_add_u32 s59, s59, 128
    s_cmp_eq_u32 s59, s23
    s_cselect_b32 s63, 896, 0
    s_sub_u32 s59, s59, s63
    s_waitcnt lgkmcnt(8)
    v_mfma_f32_32x32x16_bf16 a[32:47], v[16:19], v[228:231], a[32:47]
    ds_read_b64_tr_b16 v[16:17], v67 offset:0
    ds_read_b64_tr_b16 v[18:19], v67 offset:512
    buffer_load_dwordx4 a[188:191], v97, s[48:51], s18 offen offset:1024 sc1
    s_add_u32 s18, s18, 1835008
    v_accvgpr_read_b32 v103, a0
    v_accvgpr_read_b32 v104, a1
    v_cvt_pk_bf16_f32 v128, v103, v104
    v_accvgpr_read_b32 v105, a2
    v_accvgpr_read_b32 v106, a3
    v_cvt_pk_bf16_f32 v129, v105, v106
    v_accvgpr_read_b32 v103, a4
    v_accvgpr_read_b32 v104, a5
    v_mfma_f32_32x32x16_bf16 a[48:63], v[20:23], v[228:231], a[48:63]
    ds_read_b64_tr_b16 v[20:21], v68 offset:0
    ds_read_b64_tr_b16 v[22:23], v68 offset:512
    v_cvt_pk_bf16_f32 v130, v103, v104
    v_accvgpr_read_b32 v105, a6
    v_accvgpr_read_b32 v106, a7
    v_cvt_pk_bf16_f32 v131, v105, v106
    v_accvgpr_read_b32 v103, a8
    v_accvgpr_read_b32 v104, a9
    v_cvt_pk_bf16_f32 v132, v103, v104
    v_accvgpr_read_b32 v105, a10
    s_waitcnt lgkmcnt(8)
    v_mfma_f32_32x32x16_bf16 a[64:79], v[0:3], v[228:231], a[64:79]
    s_add_u32 m0, s60, 98304
    ds_read_b64_tr_b16 v[0:1], v67 offset:2048
    ds_read_b64_tr_b16 v[2:3], v67 offset:2560
    buffer_load_dwordx4 v44, s[40:43], s59 offen offset:0 lds
    v_accvgpr_read_b32 v106, a11
    v_cvt_pk_bf16_f32 v133, v105, v106
    v_accvgpr_read_b32 v103, a12
    v_accvgpr_read_b32 v104, a13
    v_cvt_pk_bf16_f32 v134, v103, v104
    v_accvgpr_read_b32 v105, a14
    v_accvgpr_read_b32 v106, a15
    v_cvt_pk_bf16_f32 v135, v105, v106
    v_mfma_f32_32x32x16_bf16 a[80:95], v[4:7], v[228:231], a[80:95]
    ds_read_b64_tr_b16 v[4:5], v68 offset:2048
    ds_read_b64_tr_b16 v[6:7], v68 offset:2560
    v_accvgpr_read_b32 v103, a16
    v_accvgpr_read_b32 v104, a17
    v_cvt_pk_bf16_f32 v136, v103, v104
    v_accvgpr_read_b32 v105, a18
    v_accvgpr_read_b32 v106, a19
    v_cvt_pk_bf16_f32 v137, v105, v106
    v_accvgpr_read_b32 v103, a20
    v_accvgpr_read_b32 v104, a21
    s_waitcnt lgkmcnt(8)
    v_mfma_f32_32x32x16_bf16 a[96:111], v[8:11], v[228:231], a[96:111]
    ds_read_b64_tr_b16 v[8:9], v67 offset:4096
    ds_read_b64_tr_b16 v[10:11], v67 offset:4608
    v_cvt_pk_bf16_f32 v138, v103, v104
    v_accvgpr_read_b32 v105, a22
    v_accvgpr_read_b32 v106, a23
    v_cvt_pk_bf16_f32 v139, v105, v106
    v_accvgpr_read_b32 v103, a24
    v_accvgpr_read_b32 v104, a25
    v_cvt_pk_bf16_f32 v140, v103, v104
    v_accvgpr_read_b32 v105, a26
    v_mfma_f32_32x32x16_bf16 a[112:127], v[12:15], v[228:231], a[112:127]
    ds_read_b64_tr_b16 v[12:13], v68 offset:4096
    ds_read_b64_tr_b16 v[14:15], v68 offset:4608
    buffer_load_dwordx4 v45, s[40:43], s59 offen offset:1024 lds
    v_accvgpr_read_b32 v106, a27
    v_cvt_pk_bf16_f32 v141, v105, v106
    v_accvgpr_read_b32 v103, a28
    v_accvgpr_read_b32 v104, a29
    v_cvt_pk_bf16_f32 v142, v103, v104
    v_accvgpr_read_b32 v105, a30
    v_accvgpr_read_b32 v106, a31
    v_cvt_pk_bf16_f32 v143, v105, v106
    s_waitcnt lgkmcnt(8)
    v_mfma_f32_32x32x16_bf16 v[192:207], v[16:19], v[128:131], 0
    ds_read_b64_tr_b16 v[16:17], v67 offset:6144
    ds_read_b64_tr_b16 v[18:19], v67 offset:6656
    buffer_load_dwordx4 v46, s[40:43], s59 offen offset:2048 lds
    v_accvgpr_read_b32 v103, a32
    v_accvgpr_read_b32 v104, a33
    v_cvt_pk_bf16_f32 v144, v103, v104
    v_accvgpr_read_b32 v105, a34
    v_accvgpr_read_b32 v106, a35
    v_cvt_pk_bf16_f32 v145, v105, v106
    v_mfma_f32_32x32x16_bf16 v[208:223], v[20:23], v[128:131], 0
    ds_read_b64_tr_b16 v[20:21], v68 offset:6144
    ds_read_b64_tr_b16 v[22:23], v68 offset:6656
    buffer_load_dwordx4 v47, s[40:43], s59 offen offset:3072 lds
    v_accvgpr_read_b32 v103, a36
    v_accvgpr_read_b32 v104, a37
    v_cvt_pk_bf16_f32 v146, v103, v104
    v_accvgpr_read_b32 v105, a38
    v_accvgpr_read_b32 v106, a39
    v_cvt_pk_bf16_f32 v147, v105, v106
    s_waitcnt lgkmcnt(8)
    v_mfma_f32_32x32x16_bf16 v[192:207], v[0:3], v[132:135], v[192:207]
    s_add_u32 m0, s60, 102400
    ds_read_b64_tr_b16 v[0:1], v67 offset:8192
    ds_read_b64_tr_b16 v[2:3], v67 offset:8704
    buffer_load_dwordx4 v48, s[40:43], s59 offen offset:0 lds
    v_accvgpr_read_b32 v103, a40
    v_accvgpr_read_b32 v104, a41
    v_cvt_pk_bf16_f32 v148, v103, v104
    v_accvgpr_read_b32 v105, a42
    v_accvgpr_read_b32 v106, a43
    v_cvt_pk_bf16_f32 v149, v105, v106
    v_mfma_f32_32x32x16_bf16 v[208:223], v[4:7], v[132:135], v[208:223]
    ds_read_b64_tr_b16 v[4:5], v68 offset:8192
    ds_read_b64_tr_b16 v[6:7], v68 offset:8704
    buffer_load_dwordx4 v49, s[40:43], s59 offen offset:1024 lds
    v_accvgpr_read_b32 v103, a44
    v_accvgpr_read_b32 v104, a45
    v_cvt_pk_bf16_f32 v150, v103, v104
    v_accvgpr_read_b32 v105, a46
    v_accvgpr_read_b32 v106, a47
    v_cvt_pk_bf16_f32 v151, v105, v106
    s_waitcnt lgkmcnt(8)
    v_mfma_f32_32x32x16_bf16 v[192:207], v[8:11], v[136:139], v[192:207]
    ds_read_b64_tr_b16 v[8:9], v67 offset:10240
    ds_read_b64_tr_b16 v[10:11], v67 offset:10752
    buffer_load_dwordx4 v50, s[40:43], s59 offen offset:2048 lds
    v_accvgpr_read_b32 v103, a48
    v_accvgpr_read_b32 v104, a49
    v_cvt_pk_bf16_f32 v152, v103, v104
    v_accvgpr_read_b32 v105, a50
    v_accvgpr_read_b32 v106, a51
    v_cvt_pk_bf16_f32 v153, v105, v106
    v_mfma_f32_32x32x16_bf16 v[208:223], v[12:15], v[136:139], v[208:223]
    ds_read_b64_tr_b16 v[12:13], v68 offset:10240
    ds_read_b64_tr_b16 v[14:15], v68 offset:10752
    buffer_load_dwordx4 v51, s[40:43], s59 offen offset:3072 lds
    s_add_u32 s59, s59, 128
    s_cmp_eq_u32 s59, s23
    s_cselect_b32 s63, 896, 0
    s_sub_u32 s59, s59, s63
    v_accvgpr_read_b32 v103, a52
    v_accvgpr_read_b32 v104, a53
    v_cvt_pk_bf16_f32 v154, v103, v104
    v_accvgpr_read_b32 v105, a54
    v_accvgpr_read_b32 v106, a55
    v_cvt_pk_bf16_f32 v155, v105, v106
    s_waitcnt lgkmcnt(8)
    v_mfma_f32_32x32x16_bf16 v[192:207], v[16:19], v[140:143], v[192:207]
    ds_read_b64_tr_b16 v[16:17], v67 offset:12288
    ds_read_b64_tr_b16 v[18:19], v67 offset:12800
    v_accvgpr_read_b32 v103, a56
    v_accvgpr_read_b32 v104, a57
    v_cvt_pk_bf16_f32 v156, v103, v104
    v_accvgpr_read_b32 v105, a58
    v_accvgpr_read_b32 v106, a59
    v_cvt_pk_bf16_f32 v157, v105, v106
    v_mfma_f32_32x32x16_bf16 v[208:223], v[20:23], v[140:143], v[208:223]
    ds_read_b64_tr_b16 v[20:21], v68 offset:12288
    ds_read_b64_tr_b16 v[22:23], v68 offset:12800
    v_accvgpr_read_b32 v103, a60
    v_accvgpr_read_b32 v104, a61
    v_cvt_pk_bf16_f32 v158, v103, v104
    v_accvgpr_read_b32 v105, a62
    v_accvgpr_read_b32 v106, a63
    v_cvt_pk_bf16_f32 v159, v105, v106
    s_waitcnt lgkmcnt(8)
    v_mfma_f32_32x32x16_bf16 v[192:207], v[0:3], v[144:147], v[192:207]
    ds_read_b64_tr_b16 v[0:1], v67 offset:14336
    ds_read_b64_tr_b16 v[2:3], v67 offset:14848
    v_accvgpr_read_b32 v103, a64
    v_accvgpr_read_b32 v104, a65
    v_cvt_pk_bf16_f32 v160, v103, v104
    v_accvgpr_read_b32 v105, a66
    v_accvgpr_read_b32 v106, a67
    v_cvt_pk_bf16_f32 v161, v105, v106
    v_mfma_f32_32x32x16_bf16 v[208:223], v[4:7], v[144:147], v[208:223]
    ds_read_b64_tr_b16 v[4:5], v68 offset:14336
    ds_read_b64_tr_b16 v[6:7], v68 offset:14848
    v_accvgpr_read_b32 v103, a68
    v_accvgpr_read_b32 v104, a69
    v_cvt_pk_bf16_f32 v162, v103, v104
    v_accvgpr_read_b32 v105, a70
    v_accvgpr_read_b32 v106, a71
    v_cvt_pk_bf16_f32 v163, v105, v106
    s_waitcnt lgkmcnt(8)
    v_mfma_f32_32x32x16_bf16 v[192:207], v[8:11], v[148:151], v[192:207]
    ds_read_b64_tr_b16 v[8:9], v67 offset:16384
    ds_read_b64_tr_b16 v[10:11], v67 offset:16896
    v_accvgpr_read_b32 v103, a72
    v_accvgpr_read_b32 v104, a73
    v_cvt_pk_bf16_f32 v164, v103, v104
    v_accvgpr_read_b32 v105, a74
    v_accvgpr_read_b32 v106, a75
    v_cvt_pk_bf16_f32 v165, v105, v106
    v_mfma_f32_32x32x16_bf16 v[208:223], v[12:15], v[148:151], v[208:223]
    ds_read_b64_tr_b16 v[12:13], v68 offset:16384
    ds_read_b64_tr_b16 v[14:15], v68 offset:16896
    v_accvgpr_read_b32 v103, a76
    v_accvgpr_read_b32 v104, a77
    v_cvt_pk_bf16_f32 v166, v103, v104
    v_accvgpr_read_b32 v105, a78
    v_accvgpr_read_b32 v106, a79
    v_cvt_pk_bf16_f32 v167, v105, v106
    s_waitcnt lgkmcnt(8)
    v_mfma_f32_32x32x16_bf16 v[192:207], v[16:19], v[152:155], v[192:207]
    ds_read_b64_tr_b16 v[16:17], v67 offset:18432
    ds_read_b64_tr_b16 v[18:19], v67 offset:18944
    v_accvgpr_read_b32 v103, a80
    v_accvgpr_read_b32 v104, a81
    v_cvt_pk_bf16_f32 v168, v103, v104
    v_accvgpr_read_b32 v105, a82
    v_accvgpr_read_b32 v106, a83
    v_cvt_pk_bf16_f32 v169, v105, v106
    v_mfma_f32_32x32x16_bf16 v[208:223], v[20:23], v[152:155], v[208:223]
    ds_read_b64_tr_b16 v[20:21], v68 offset:18432
    ds_read_b64_tr_b16 v[22:23], v68 offset:18944
    v_accvgpr_read_b32 v103, a84
    v_accvgpr_read_b32 v104, a85
    v_cvt_pk_bf16_f32 v170, v103, v104
    v_accvgpr_read_b32 v105, a86
    v_accvgpr_read_b32 v106, a87
    v_cvt_pk_bf16_f32 v171, v105, v106
    s_waitcnt lgkmcnt(8)
    v_mfma_f32_32x32x16_bf16 v[192:207], v[0:3], v[156:159], v[192:207]
    ds_read_b64_tr_b16 v[0:1], v67 offset:20480
    ds_read_b64_tr_b16 v[2:3], v67 offset:20992
    v_accvgpr_read_b32 v103, a88
    v_accvgpr_read_b32 v104, a89
    v_cvt_pk_bf16_f32 v172, v103, v104
    v_accvgpr_read_b32 v105, a90
    v_accvgpr_read_b32 v106, a91
    v_cvt_pk_bf16_f32 v173, v105, v106
    v_mfma_f32_32x32x16_bf16 v[208:223], v[4:7], v[156:159], v[208:223]
    ds_read_b64_tr_b16 v[4:5], v68 offset:20480
    ds_read_b64_tr_b16 v[6:7], v68 offset:20992
    v_accvgpr_read_b32 v103, a92
    v_accvgpr_read_b32 v104, a93
    v_cvt_pk_bf16_f32 v174, v103, v104
    v_accvgpr_read_b32 v105, a94
    v_accvgpr_read_b32 v106, a95
    v_cvt_pk_bf16_f32 v175, v105, v106
    s_waitcnt lgkmcnt(8)
    v_mfma_f32_32x32x16_bf16 v[192:207], v[8:11], v[160:163], v[192:207]
    ds_read_b64_tr_b16 v[8:9], v67 offset:22528
    ds_read_b64_tr_b16 v[10:11], v67 offset:23040
    v_accvgpr_read_b32 v103, a96
    v_accvgpr_read_b32 v104, a97
    v_cvt_pk_bf16_f32 v176, v103, v104
    v_accvgpr_read_b32 v105, a98
    v_accvgpr_read_b32 v106, a99
    v_cvt_pk_bf16_f32 v177, v105, v106
    v_mfma_f32_32x32x16_bf16 v[208:223], v[12:15], v[160:163], v[208:223]
    ds_read_b64_tr_b16 v[12:13], v68 offset:22528
    ds_read_b64_tr_b16 v[14:15], v68 offset:23040
    v_accvgpr_read_b32 v103, a100
    v_accvgpr_read_b32 v104, a101
    v_cvt_pk_bf16_f32 v178, v103, v104
    v_accvgpr_read_b32 v105, a102
    v_accvgpr_read_b32 v106, a103
    v_cvt_pk_bf16_f32 v179, v105, v106
    s_waitcnt lgkmcnt(8)
    v_mfma_f32_32x32x16_bf16 v[192:207], v[16:19], v[164:167], v[192:207]
    ds_read_b64_tr_b16 v[16:17], v67 offset:24576
    ds_read_b64_tr_b16 v[18:19], v67 offset:25088
    v_accvgpr_read_b32 v103, a104
    v_accvgpr_read_b32 v104, a105
    v_cvt_pk_bf16_f32 v180, v103, v104
    v_accvgpr_read_b32 v105, a106
    v_accvgpr_read_b32 v106, a107
    v_cvt_pk_bf16_f32 v181, v105, v106
    v_mfma_f32_32x32x16_bf16 v[208:223], v[20:23], v[164:167], v[208:223]
    ds_read_b64_tr_b16 v[20:21], v68 offset:24576
    ds_read_b64_tr_b16 v[22:23], v68 offset:25088
    v_accvgpr_read_b32 v103, a108
    v_accvgpr_read_b32 v104, a109
    v_cvt_pk_bf16_f32 v182, v103, v104
    v_accvgpr_read_b32 v105, a110
    v_accvgpr_read_b32 v106, a111
    v_cvt_pk_bf16_f32 v183, v105, v106
    s_waitcnt lgkmcnt(8)
    v_mfma_f32_32x32x16_bf16 v[192:207], v[0:3], v[168:171], v[192:207]
    ds_read_b64_tr_b16 v[0:1], v67 offset:26624
    ds_read_b64_tr_b16 v[2:3], v67 offset:27136
    v_accvgpr_read_b32 v103, a112
    v_accvgpr_read_b32 v104, a113
    v_cvt_pk_bf16_f32 v184, v103, v104
    v_accvgpr_read_b32 v105, a114
    v_accvgpr_read_b32 v106, a115
    v_cvt_pk_bf16_f32 v185, v105, v106
    v_mfma_f32_32x32x16_bf16 v[208:223], v[4:7], v[168:171], v[208:223]
    ds_read_b64_tr_b16 v[4:5], v68 offset:26624
    ds_read_b64_tr_b16 v[6:7], v68 offset:27136
    v_accvgpr_read_b32 v103, a116
    v_accvgpr_read_b32 v104, a117
    v_cvt_pk_bf16_f32 v186, v103, v104
    v_accvgpr_read_b32 v105, a118
    v_accvgpr_read_b32 v106, a119
    v_cvt_pk_bf16_f32 v187, v105, v106
    s_waitcnt lgkmcnt(8)
    v_mfma_f32_32x32x16_bf16 v[192:207], v[8:11], v[172:175], v[192:207]
    ds_read_b64_tr_b16 v[8:9], v67 offset:28672
    ds_read_b64_tr_b16 v[10:11], v67 offset:29184
    v_accvgpr_read_b32 v103, a120
    v_accvgpr_read_b32 v104, a121
    v_cvt_pk_bf16_f32 v188, v103, v104
    v_accvgpr_read_b32 v105, a122
    v_accvgpr_read_b32 v106, a123
    v_cvt_pk_bf16_f32 v189, v105, v106
    v_mfma_f32_32x32x16_bf16 v[208:223], v[12:15], v[172:175], v[208:223]
    ds_read_b64_tr_b16 v[12:13], v68 offset:28672
    ds_read_b64_tr_b16 v[14:15], v68 offset:29184
    v_accvgpr_read_b32 v103, a124
    v_accvgpr_read_b32 v104, a125
    v_cvt_pk_bf16_f32 v190, v103, v104
    v_accvgpr_read_b32 v105, a126
    v_accvgpr_read_b32 v106, a127
    v_cvt_pk_bf16_f32 v191, v105, v106
    s_waitcnt lgkmcnt(8)
    v_mfma_f32_32x32x16_bf16 v[192:207], v[16:19], v[176:179], v[192:207]
    s_waitcnt vmcnt(22)
    s_barrier
    s_add_u32 m0, s60, 131072
    ds_read_b64_tr_b16 v[16:17], v67 offset:30720
    ds_read_b64_tr_b16 v[18:19], v67 offset:31232
    buffer_load_dwordx4 v44, s[40:43], s59 offen offset:0 lds
    v_mfma_f32_32x32x16_bf16 v[208:223], v[20:23], v[176:179], v[208:223]
    ds_read_b64_tr_b16 v[20:21], v68 offset:30720
    ds_read_b64_tr_b16 v[22:23], v68 offset:31232
    buffer_load_dwordx4 v45, s[40:43], s59 offen offset:1024 lds
    s_waitcnt lgkmcnt(8)
    v_mfma_f32_32x32x16_bf16 v[192:207], v[0:3], v[180:183], v[192:207]
    ds_read_b64_tr_b16 v[0:1], v67 offset:32768
    ds_read_b64_tr_b16 v[2:3], v67 offset:33280
    buffer_load_dwordx4 v46, s[40:43], s59 offen offset:2048 lds
    v_mov_b32 v107, v98
    v_mov_b32 v108, v98
    v_mfma_f32_32x32x16_bf16 v[208:223], v[4:7], v[180:183], v[208:223]
    ds_read_b64_tr_b16 v[4:5], v68 offset:32768
    ds_read_b64_tr_b16 v[6:7], v68 offset:33280
    buffer_load_dwordx4 v47, s[40:43], s59 offen offset:3072 lds
    v_permlane32_swap_b32 v107, v108
    s_waitcnt lgkmcnt(8)
    v_mfma_f32_32x32x16_bf16 v[192:207], v[8:11], v[184:187], v[192:207]
    s_add_u32 m0, s60, 135168
    ds_read_b64_tr_b16 v[8:9], v67 offset:34816
    ds_read_b64_tr_b16 v[10:11], v67 offset:35328
    buffer_load_dwordx4 v48, s[40:43], s59 offen offset:0 lds
    v_add_f32 v107, v107, v108
    v_mfma_f32_32x32x16_bf16 v[208:223], v[12:15], v[184:187], v[208:223]
    ds_read_b64_tr_b16 v[12:13], v68 offset:34816
    ds_read_b64_tr_b16 v[14:15], v68 offset:35328
    buffer_load_dwordx4 v49, s[40:43], s59 offen offset:1024 lds
    v_rcp_f32 v102, v107
    s_waitcnt lgkmcnt(8)
    v_mfma_f32_32x32x16_bf16 v[192:207], v[16:19], v[188:191], v[192:207]
    ds_read_b64_tr_b16 v[16:17], v67 offset:36864
    ds_read_b64_tr_b16 v[18:19], v67 offset:37376
    buffer_load_dwordx4 v50, s[40:43], s59 offen offset:2048 lds
    v_mfma_f32_32x32x16_bf16 v[208:223], v[20:23], v[188:191], v[208:223]
    ds_read_b64_tr_b16 v[20:21], v68 offset:36864
    ds_read_b64_tr_b16 v[22:23], v68 offset:37376
    buffer_load_dwordx4 v51, s[40:43], s59 offen offset:3072 lds
    s_add_u32 s59, s59, 128
    s_cmp_eq_u32 s59, s23
    s_cselect_b32 s63, 896, 0
    s_sub_u32 s59, s59, s63
    s_waitcnt lgkmcnt(8)
    v_mfma_f32_32x32x16_bf16 v[224:239], v[0:3], v[128:131], 0
    ds_read_b64_tr_b16 v[0:1], v67 offset:38912
    ds_read_b64_tr_b16 v[2:3], v67 offset:39424
    v_mfma_f32_32x32x16_bf16 v[240:255], v[4:7], v[128:131], 0
    ds_read_b64_tr_b16 v[4:5], v68 offset:38912
    ds_read_b64_tr_b16 v[6:7], v68 offset:39424
    v_mul_f32 v192, v192, v102
    v_mul_f32 v193, v193, v102
    v_cvt_pk_bf16_f32 v112, v192, v193
    v_mul_f32 v194, v194, v102
    v_mul_f32 v195, v195, v102
    s_waitcnt lgkmcnt(8)
    v_mfma_f32_32x32x16_bf16 v[224:239], v[8:11], v[132:135], v[224:239]
    ds_read_b64_tr_b16 v[8:9], v67 offset:40960
    ds_read_b64_tr_b16 v[10:11], v67 offset:41472
    v_cvt_pk_bf16_f32 v113, v194, v195
    v_mul_f32 v196, v196, v102
    v_mul_f32 v197, v197, v102
    v_cvt_pk_bf16_f32 v114, v196, v197
    v_mfma_f32_32x32x16_bf16 v[240:255], v[12:15], v[132:135], v[240:255]
    ds_read_b64_tr_b16 v[12:13], v68 offset:40960
    ds_read_b64_tr_b16 v[14:15], v68 offset:41472
    v_mul_f32 v198, v198, v102
    v_mul_f32 v199, v199, v102
    v_cvt_pk_bf16_f32 v115, v198, v199
    buffer_store_dwordx4 v[112:115], v97, s[48:51], s68 offen offset:0 sc1
    v_mul_f32 v200, v200, v102
    s_waitcnt lgkmcnt(8)
    v_mfma_f32_32x32x16_bf16 v[224:239], v[16:19], v[136:139], v[224:239]
    ds_read_b64_tr_b16 v[16:17], v67 offset:43008
    ds_read_b64_tr_b16 v[18:19], v67 offset:43520
    v_mul_f32 v201, v201, v102
    v_cvt_pk_bf16_f32 v116, v200, v201
    v_mul_f32 v202, v202, v102
    v_mul_f32 v203, v203, v102
    v_mfma_f32_32x32x16_bf16 v[240:255], v[20:23], v[136:139], v[240:255]
    ds_read_b64_tr_b16 v[20:21], v68 offset:43008
    ds_read_b64_tr_b16 v[22:23], v68 offset:43520
    v_cvt_pk_bf16_f32 v117, v202, v203
    v_mul_f32 v204, v204, v102
    v_mul_f32 v205, v205, v102
    v_cvt_pk_bf16_f32 v118, v204, v205
    v_mul_f32 v206, v206, v102
    s_waitcnt lgkmcnt(8)
    v_mfma_f32_32x32x16_bf16 v[224:239], v[0:3], v[140:143], v[224:239]
    ds_read_b64_tr_b16 v[0:1], v67 offset:45056
    ds_read_b64_tr_b16 v[2:3], v67 offset:45568
    v_mul_f32 v207, v207, v102
    v_cvt_pk_bf16_f32 v119, v206, v207
    buffer_store_dwordx4 v[116:119], v97, s[48:51], s68 offen offset:1024 sc1
    v_mul_f32 v208, v208, v102
    v_mfma_f32_32x32x16_bf16 v[240:255], v[4:7], v[140:143], v[240:255]
    ds_read_b64_tr_b16 v[4:5], v68 offset:45056
    ds_read_b64_tr_b16 v[6:7], v68 offset:45568
    v_mul_f32 v209, v209, v102
    v_cvt_pk_bf16_f32 v120, v208, v209
    v_mul_f32 v210, v210, v102
    v_mul_f32 v211, v211, v102
    s_waitcnt lgkmcnt(8)
    v_mfma_f32_32x32x16_bf16 v[224:239], v[8:11], v[144:147], v[224:239]
    ds_read_b64_tr_b16 v[8:9], v67 offset:47104
    ds_read_b64_tr_b16 v[10:11], v67 offset:47616
    v_cvt_pk_bf16_f32 v121, v210, v211
    v_mul_f32 v212, v212, v102
    v_mul_f32 v213, v213, v102
    v_cvt_pk_bf16_f32 v122, v212, v213
    v_mul_f32 v214, v214, v102
    v_mfma_f32_32x32x16_bf16 v[240:255], v[12:15], v[144:147], v[240:255]
    ds_read_b64_tr_b16 v[12:13], v68 offset:47104
    ds_read_b64_tr_b16 v[14:15], v68 offset:47616
    v_mul_f32 v215, v215, v102
    v_cvt_pk_bf16_f32 v123, v214, v215
    buffer_store_dwordx4 v[120:123], v97, s[48:51], s68 offen offset:2048 sc1
    v_mul_f32 v216, v216, v102
    s_waitcnt lgkmcnt(8)
    v_mfma_f32_32x32x16_bf16 v[224:239], v[16:19], v[148:151], v[224:239]
    ds_read_b64_tr_b16 v[16:17], v67 offset:49152
    ds_read_b64_tr_b16 v[18:19], v67 offset:49664
    v_mul_f32 v217, v217, v102
    v_cvt_pk_bf16_f32 v124, v216, v217
    v_mul_f32 v218, v218, v102
    v_mul_f32 v219, v219, v102
    v_cvt_pk_bf16_f32 v125, v218, v219
    v_mfma_f32_32x32x16_bf16 v[240:255], v[20:23], v[148:151], v[240:255]
    ds_read_b64_tr_b16 v[20:21], v68 offset:49152
    ds_read_b64_tr_b16 v[22:23], v68 offset:49664
    v_mul_f32 v220, v220, v102
    v_mul_f32 v221, v221, v102
    v_cvt_pk_bf16_f32 v126, v220, v221
    v_mul_f32 v222, v222, v102
    s_waitcnt lgkmcnt(8)
    v_mfma_f32_32x32x16_bf16 v[224:239], v[0:3], v[152:155], v[224:239]
    ds_read_b64_tr_b16 v[0:1], v67 offset:51200
    ds_read_b64_tr_b16 v[2:3], v67 offset:51712
    v_mul_f32 v223, v223, v102
    v_cvt_pk_bf16_f32 v127, v222, v223
    buffer_store_dwordx4 v[124:127], v97, s[48:51], s68 offen offset:3072 sc1
    s_add_u32 s68, s68, 4096
    s_cmp_eq_u32 s68, s24
    s_cselect_b32 s61, 28672, 0
    s_sub_u32 s68, s68, s61
    v_mfma_f32_32x32x16_bf16 v[240:255], v[4:7], v[152:155], v[240:255]
    ds_read_b64_tr_b16 v[4:5], v68 offset:51200
    ds_read_b64_tr_b16 v[6:7], v68 offset:51712
    s_waitcnt lgkmcnt(8)
    v_mfma_f32_32x32x16_bf16 v[224:239], v[8:11], v[156:159], v[224:239]
    ds_read_b64_tr_b16 v[8:9], v67 offset:53248
    ds_read_b64_tr_b16 v[10:11], v67 offset:53760
    v_mfma_f32_32x32x16_bf16 v[240:255], v[12:15], v[156:159], v[240:255]
    ds_read_b64_tr_b16 v[12:13], v68 offset:53248
    ds_read_b64_tr_b16 v[14:15], v68 offset:53760
    s_waitcnt lgkmcnt(8)
    v_mfma_f32_32x32x16_bf16 v[224:239], v[16:19], v[160:163], v[224:239]
    ds_read_b64_tr_b16 v[16:17], v67 offset:55296
    ds_read_b64_tr_b16 v[18:19], v67 offset:55808
    s_lshr_b32 s62, s13, 1
    v_mfma_f32_32x32x16_bf16 v[240:255], v[20:23], v[160:163], v[240:255]
    ds_read_b64_tr_b16 v[20:21], v68 offset:55296
    ds_read_b64_tr_b16 v[22:23], v68 offset:55808
    s_add_u32 s62, s62, 21
    s_waitcnt lgkmcnt(8)
    v_mfma_f32_32x32x16_bf16 v[224:239], v[0:3], v[164:167], v[224:239]
    ds_read_b64_tr_b16 v[0:1], v67 offset:57344
    ds_read_b64_tr_b16 v[2:3], v67 offset:57856
    v_bfe_u32 v111, v97, 4, 4
    v_mfma_f32_32x32x16_bf16 v[240:255], v[4:7], v[164:167], v[240:255]
    ds_read_b64_tr_b16 v[4:5], v68 offset:57344
    ds_read_b64_tr_b16 v[6:7], v68 offset:57856
    v_sub_u32 v33, s62, v111
    s_waitcnt lgkmcnt(8)
    v_mfma_f32_32x32x16_bf16 v[224:239], v[8:11], v[168:171], v[224:239]
    ds_read_b64_tr_b16 v[8:9], v67 offset:59392
    ds_read_b64_tr_b16 v[10:11], v67 offset:59904
    v_mul_u32_u24 v32, 37, v33
    v_mfma_f32_32x32x16_bf16 v[240:255], v[12:15], v[168:171], v[240:255]
    ds_read_b64_tr_b16 v[12:13], v68 offset:59392
    ds_read_b64_tr_b16 v[14:15], v68 offset:59904
    v_lshrrev_b32 v32, 8, v32
    s_waitcnt lgkmcnt(8)
    v_mfma_f32_32x32x16_bf16 v[224:239], v[16:19], v[172:175], v[224:239]
    ds_read_b64_tr_b16 v[16:17], v67 offset:61440
    ds_read_b64_tr_b16 v[18:19], v67 offset:61952
    v_mfma_f32_32x32x16_bf16 v[240:255], v[20:23], v[172:175], v[240:255]
    ds_read_b64_tr_b16 v[20:21], v68 offset:61440
    ds_read_b64_tr_b16 v[22:23], v68 offset:61952
    v_mul_u32_u24 v32, 7, v32
    s_waitcnt lgkmcnt(8)
    v_mfma_f32_32x32x16_bf16 v[224:239], v[0:3], v[176:179], v[224:239]
    s_waitcnt vmcnt(21)
    s_barrier
    s_add_u32 m0, s60, 0
    ds_read_b64_tr_b16 v[0:1], v67 offset:63488
    ds_read_b64_tr_b16 v[2:3], v67 offset:64000
    buffer_load_dwordx4 v44, s[40:43], s59 offen offset:0 lds
    v_sub_u32 v33, v33, v32
    v_mfma_f32_32x32x16_bf16 v[240:255], v[4:7], v[176:179], v[240:255]
    ds_read_b64_tr_b16 v[4:5], v68 offset:63488
    ds_read_b64_tr_b16 v[6:7], v68 offset:64000
    buffer_load_dwordx4 v45, s[40:43], s59 offen offset:1024 lds
    v_add3_u32 v32, v33, v28, 1
    s_waitcnt lgkmcnt(8)
    v_mfma_f32_32x32x16_bf16 v[224:239], v[8:11], v[180:183], v[224:239]
    ds_read_b64_tr_b16 v[8:9], v69 offset:0
    ds_read_b64_tr_b16 v[10:11], v69 offset:512
    buffer_load_dwordx4 v46, s[40:43], s59 offen offset:2048 lds
    s_add_u32 s17, s17, 128
    v_mfma_f32_32x32x16_bf16 v[240:255], v[12:15], v[180:183], v[240:255]
    ds_read_b64_tr_b16 v[12:13], v70 offset:0
    ds_read_b64_tr_b16 v[14:15], v70 offset:512
    buffer_load_dwordx4 v47, s[40:43], s59 offen offset:3072 lds
    s_add_u32 s16, s16, 128
    s_waitcnt lgkmcnt(8)
    v_mfma_f32_32x32x16_bf16 v[224:239], v[16:19], v[184:187], v[224:239]
    s_add_u32 m0, s60, 4096
    ds_read_b64_tr_b16 v[16:17], v69 offset:2048
    ds_read_b64_tr_b16 v[18:19], v69 offset:2560
    buffer_load_dwordx4 v48, s[40:43], s59 offen offset:0 lds
    v_mfma_f32_32x32x16_bf16 v[240:255], v[20:23], v[184:187], v[240:255]
    ds_read_b64_tr_b16 v[20:21], v70 offset:2048
    ds_read_b64_tr_b16 v[22:23], v70 offset:2560
    buffer_load_dwordx4 v49, s[40:43], s59 offen offset:1024 lds
    s_waitcnt lgkmcnt(8)
    v_mfma_f32_32x32x16_bf16 v[224:239], v[0:3], v[188:191], v[224:239]
    ds_read_b64_tr_b16 v[0:1], v69 offset:4096
    ds_read_b64_tr_b16 v[2:3], v69 offset:4608
    buffer_load_dwordx4 v50, s[40:43], s59 offen offset:2048 lds
    v_mfma_f32_32x32x16_bf16 v[240:255], v[4:7], v[188:191], v[240:255]
    ds_read_b64_tr_b16 v[4:5], v70 offset:4096
    ds_read_b64_tr_b16 v[6:7], v70 offset:4608
    buffer_load_dwordx4 v51, s[40:43], s59 offen offset:3072 lds
    s_add_u32 s59, s59, 128
    s_cmp_eq_u32 s59, s23
    s_cselect_b32 s63, 896, 0
    s_sub_u32 s59, s59, s63
    s_waitcnt lgkmcnt(8)
    v_mfma_f32_32x32x16_bf16 v[192:207], v[8:11], v[128:131], 0
    ds_read_b64_tr_b16 v[8:9], v69 offset:6144
    ds_read_b64_tr_b16 v[10:11], v69 offset:6656
    v_mfma_f32_32x32x16_bf16 v[208:223], v[12:15], v[128:131], 0
    ds_read_b64_tr_b16 v[12:13], v70 offset:6144
    ds_read_b64_tr_b16 v[14:15], v70 offset:6656
    v_mul_f32 v224, v224, v102
    v_mul_f32 v225, v225, v102
    v_cvt_pk_bf16_f32 v112, v224, v225
    v_mul_f32 v226, v226, v102
    v_mul_f32 v227, v227, v102
    s_waitcnt lgkmcnt(8)
    v_mfma_f32_32x32x16_bf16 v[192:207], v[16:19], v[132:135], v[192:207]
    ds_read_b64_tr_b16 v[16:17], v69 offset:8192
    ds_read_b64_tr_b16 v[18:19], v69 offset:8704
    v_cvt_pk_bf16_f32 v113, v226, v227
    v_mul_f32 v228, v228, v102
    v_mul_f32 v229, v229, v102
    v_cvt_pk_bf16_f32 v114, v228, v229
    v_mfma_f32_32x32x16_bf16 v[208:223], v[20:23], v[132:135], v[208:223]
    ds_read_b64_tr_b16 v[20:21], v70 offset:8192
    ds_read_b64_tr_b16 v[22:23], v70 offset:8704
    v_mul_f32 v230, v230, v102
    v_mul_f32 v231, v231, v102
    v_cvt_pk_bf16_f32 v115, v230, v231
    buffer_store_dwordx4 v[112:115], v97, s[48:51], s68 offen offset:0 sc1
    v_mul_f32 v232, v232, v102
    s_waitcnt lgkmcnt(8)
    v_mfma_f32_32x32x16_bf16 v[192:207], v[0:3], v[136:139], v[192:207]
    ds_read_b64_tr_b16 v[0:1], v69 offset:10240
    ds_read_b64_tr_b16 v[2:3], v69 offset:10752
    v_mul_f32 v233, v233, v102
    v_cvt_pk_bf16_f32 v116, v232, v233
    v_mul_f32 v234, v234, v102
    v_mul_f32 v235, v235, v102
    v_mfma_f32_32x32x16_bf16 v[208:223], v[4:7], v[136:139], v[208:223]
    ds_read_b64_tr_b16 v[4:5], v70 offset:10240
    ds_read_b64_tr_b16 v[6:7], v70 offset:10752
    v_cvt_pk_bf16_f32 v117, v234, v235
    v_mul_f32 v236, v236, v102
    v_mul_f32 v237, v237, v102
    v_cvt_pk_bf16_f32 v118, v236, v237
    v_mul_f32 v238, v238, v102
    s_waitcnt lgkmcnt(8)
    v_mfma_f32_32x32x16_bf16 v[192:207], v[8:11], v[140:143], v[192:207]
    ds_read_b64_tr_b16 v[8:9], v69 offset:12288
    ds_read_b64_tr_b16 v[10:11], v69 offset:12800
    v_mul_f32 v239, v239, v102
    v_cvt_pk_bf16_f32 v119, v238, v239
    buffer_store_dwordx4 v[116:119], v97, s[48:51], s68 offen offset:1024 sc1
    v_mul_f32 v240, v240, v102
    v_mfma_f32_32x32x16_bf16 v[208:223], v[12:15], v[140:143], v[208:223]
    ds_read_b64_tr_b16 v[12:13], v70 offset:12288
    ds_read_b64_tr_b16 v[14:15], v70 offset:12800
    v_mul_f32 v241, v241, v102
    v_cvt_pk_bf16_f32 v120, v240, v241
    v_mul_f32 v242, v242, v102
    v_mul_f32 v243, v243, v102
    s_waitcnt lgkmcnt(8)
    v_mfma_f32_32x32x16_bf16 v[192:207], v[16:19], v[144:147], v[192:207]
    ds_read_b64_tr_b16 v[16:17], v69 offset:14336
    ds_read_b64_tr_b16 v[18:19], v69 offset:14848
    v_cvt_pk_bf16_f32 v121, v242, v243
    v_mul_f32 v244, v244, v102
    v_mul_f32 v245, v245, v102
    v_cvt_pk_bf16_f32 v122, v244, v245
    v_mul_f32 v246, v246, v102
    v_mfma_f32_32x32x16_bf16 v[208:223], v[20:23], v[144:147], v[208:223]
    ds_read_b64_tr_b16 v[20:21], v70 offset:14336
    ds_read_b64_tr_b16 v[22:23], v70 offset:14848
    v_mul_f32 v247, v247, v102
    v_cvt_pk_bf16_f32 v123, v246, v247
    buffer_store_dwordx4 v[120:123], v97, s[48:51], s68 offen offset:2048 sc1
    v_mul_f32 v248, v248, v102
    s_waitcnt lgkmcnt(8)
    v_mfma_f32_32x32x16_bf16 v[192:207], v[0:3], v[148:151], v[192:207]
    ds_read_b64_tr_b16 v[0:1], v69 offset:16384
    ds_read_b64_tr_b16 v[2:3], v69 offset:16896
    v_mul_f32 v249, v249, v102
    v_cvt_pk_bf16_f32 v124, v248, v249
    v_mul_f32 v250, v250, v102
    v_mul_f32 v251, v251, v102
    v_cvt_pk_bf16_f32 v125, v250, v251
    v_mfma_f32_32x32x16_bf16 v[208:223], v[4:7], v[148:151], v[208:223]
    ds_read_b64_tr_b16 v[4:5], v70 offset:16384
    ds_read_b64_tr_b16 v[6:7], v70 offset:16896
    v_mul_f32 v252, v252, v102
    v_mul_f32 v253, v253, v102
    v_cvt_pk_bf16_f32 v126, v252, v253
    v_mul_f32 v254, v254, v102
    s_waitcnt lgkmcnt(8)
    v_mfma_f32_32x32x16_bf16 v[192:207], v[8:11], v[152:155], v[192:207]
    ds_read_b64_tr_b16 v[8:9], v69 offset:18432
    ds_read_b64_tr_b16 v[10:11], v69 offset:18944
    v_mul_f32 v255, v255, v102
    v_cvt_pk_bf16_f32 v127, v254, v255
    buffer_store_dwordx4 v[124:127], v97, s[48:51], s68 offen offset:3072 sc1
    s_add_u32 s68, s68, 4096
    s_cmp_eq_u32 s68, s24
    s_cselect_b32 s61, 28672, 0
    s_sub_u32 s68, s68, s61
    v_mfma_f32_32x32x16_bf16 v[208:223], v[12:15], v[152:155], v[208:223]
    ds_read_b64_tr_b16 v[12:13], v70 offset:18432
    ds_read_b64_tr_b16 v[14:15], v70 offset:18944
    s_waitcnt lgkmcnt(8)
    v_mfma_f32_32x32x16_bf16 v[192:207], v[16:19], v[156:159], v[192:207]
    ds_read_b64_tr_b16 v[16:17], v69 offset:20480
    ds_read_b64_tr_b16 v[18:19], v69 offset:20992
    v_mfma_f32_32x32x16_bf16 v[208:223], v[20:23], v[156:159], v[208:223]
    ds_read_b64_tr_b16 v[20:21], v70 offset:20480
    ds_read_b64_tr_b16 v[22:23], v70 offset:20992
    s_waitcnt lgkmcnt(8)
    v_mfma_f32_32x32x16_bf16 v[192:207], v[0:3], v[160:163], v[192:207]
    ds_read_b64_tr_b16 v[0:1], v69 offset:22528
    ds_read_b64_tr_b16 v[2:3], v69 offset:23040
    v_lshrrev_b32 v109, 4, v97
    v_lshrrev_b32 v110, 3, v109
    v_mfma_f32_32x32x16_bf16 v[208:223], v[4:7], v[160:163], v[208:223]
    ds_read_b64_tr_b16 v[4:5], v70 offset:22528
    ds_read_b64_tr_b16 v[6:7], v70 offset:23040
    v_xor_b32 v110, v110, v109
    s_waitcnt lgkmcnt(8)
    v_mfma_f32_32x32x16_bf16 v[192:207], v[8:11], v[164:167], v[192:207]
    ds_read_b64_tr_b16 v[8:9], v69 offset:24576
    ds_read_b64_tr_b16 v[10:11], v69 offset:25088
    v_and_b32 v110, 4, v110
    v_lshlrev_b32 v110, 1, v110
    v_mfma_f32_32x32x16_bf16 v[208:223], v[12:15], v[164:167], v[208:223]
    ds_read_b64_tr_b16 v[12:13], v70 offset:24576
    ds_read_b64_tr_b16 v[14:15], v70 offset:25088
    v_bfe_u32 v111, v109, 3, 2
    s_waitcnt lgkmcnt(8)
    v_mfma_f32_32x32x16_bf16 v[192:207], v[16:19], v[168:171], v[192:207]
    ds_read_b64_tr_b16 v[16:17], v69 offset:26624
    ds_read_b64_tr_b16 v[18:19], v69 offset:27136
    v_lshl_or_b32 v110, v111, 1, v110
    v_mfma_f32_32x32x16_bf16 v[208:223], v[20:23], v[168:171], v[208:223]
    ds_read_b64_tr_b16 v[20:21], v70 offset:26624
    ds_read_b64_tr_b16 v[22:23], v70 offset:27136
    v_bfe_u32 v111, v109, 1, 1
    v_or_b32 v110, v110, v111
    s_waitcnt lgkmcnt(8)
    v_mfma_f32_32x32x16_bf16 v[192:207], v[0:3], v[172:175], v[192:207]
    ds_read_b64_tr_b16 v[0:1], v69 offset:28672
    ds_read_b64_tr_b16 v[2:3], v69 offset:29184
    v_and_b32 v111, 1, v109
    v_mfma_f32_32x32x16_bf16 v[208:223], v[4:7], v[172:175], v[208:223]
    ds_read_b64_tr_b16 v[4:5], v70 offset:28672
    ds_read_b64_tr_b16 v[6:7], v70 offset:29184
    v_lshlrev_b32 v111, 4, v111
    v_mov_b32 v109, 0x3f80
    s_waitcnt lgkmcnt(8)
    v_mfma_f32_32x32x16_bf16 v[192:207], v[8:11], v[176:179], v[192:207]
    s_waitcnt vmcnt(24)
    s_barrier
    s_add_u32 m0, s60, 32768
    ds_read_b64_tr_b16 v[8:9], v69 offset:30720
    ds_read_b64_tr_b16 v[10:11], v69 offset:31232
    buffer_load_dwordx4 v44, s[40:43], s59 offen offset:0 lds
    v_lshlrev_b32 v111, v111, v109
    v_mfma_f32_32x32x16_bf16 v[208:223], v[12:15], v[176:179], v[208:223]
    ds_read_b64_tr_b16 v[12:13], v70 offset:30720
    ds_read_b64_tr_b16 v[14:15], v70 offset:31232
    buffer_load_dwordx4 v45, s[40:43], s59 offen offset:1024 lds
    v_cmp_eq_u32 vcc, 0, v110
    s_nop 1
    v_cndmask_b32 v52, 0, v111, vcc
    s_waitcnt lgkmcnt(8)
    v_mfma_f32_32x32x16_bf16 v[192:207], v[16:19], v[180:183], v[192:207]
    ds_read_b64_tr_b16 v[16:17], v69 offset:32768
    ds_read_b64_tr_b16 v[18:19], v69 offset:33280
    buffer_load_dwordx4 v46, s[40:43], s59 offen offset:2048 lds
    v_cmp_eq_u32 vcc, 1, v110
    s_nop 1
    v_cndmask_b32 v53, 0, v111, vcc
    v_cmp_eq_u32 vcc, 2, v110
    s_nop 1
    v_cndmask_b32 v54, 0, v111, vcc
    v_mfma_f32_32x32x16_bf16 v[208:223], v[20:23], v[180:183], v[208:223]
    ds_read_b64_tr_b16 v[20:21], v70 offset:32768
    ds_read_b64_tr_b16 v[22:23], v70 offset:33280
    buffer_load_dwordx4 v47, s[40:43], s59 offen offset:3072 lds
    v_cmp_eq_u32 vcc, 3, v110
    s_nop 1
    v_cndmask_b32 v55, 0, v111, vcc
    s_waitcnt lgkmcnt(8)
    v_mfma_f32_32x32x16_bf16 v[192:207], v[0:3], v[184:187], v[192:207]
    s_add_u32 m0, s60, 36864
    ds_read_b64_tr_b16 v[0:1], v69 offset:34816
    ds_read_b64_tr_b16 v[2:3], v69 offset:35328
    buffer_load_dwordx4 v48, s[40:43], s59 offen offset:0 lds
    v_cmp_eq_u32 vcc, 4, v110
    s_nop 1
    v_cndmask_b32 v56, 0, v111, vcc
    v_cmp_eq_u32 vcc, 5, v110
    s_nop 1
    v_cndmask_b32 v57, 0, v111, vcc
    v_mfma_f32_32x32x16_bf16 v[208:223], v[4:7], v[184:187], v[208:223]
    ds_read_b64_tr_b16 v[4:5], v70 offset:34816
    ds_read_b64_tr_b16 v[6:7], v70 offset:35328
    buffer_load_dwordx4 v49, s[40:43], s59 offen offset:1024 lds
    v_cmp_eq_u32 vcc, 6, v110
    s_nop 1
    v_cndmask_b32 v58, 0, v111, vcc
    s_waitcnt lgkmcnt(8)
    v_mfma_f32_32x32x16_bf16 v[192:207], v[8:11], v[188:191], v[192:207]
    ds_read_b64_tr_b16 v[8:9], v69 offset:36864
    ds_read_b64_tr_b16 v[10:11], v69 offset:37376
    buffer_load_dwordx4 v50, s[40:43], s59 offen offset:2048 lds
    v_cmp_eq_u32 vcc, 7, v110
    s_nop 1
    v_cndmask_b32 v59, 0, v111, vcc
    v_mfma_f32_32x32x16_bf16 v[208:223], v[12:15], v[188:191], v[208:223]
    ds_read_b64_tr_b16 v[12:13], v70 offset:36864
    ds_read_b64_tr_b16 v[14:15], v70 offset:37376
    buffer_load_dwordx4 v51, s[40:43], s59 offen offset:3072 lds
    s_add_u32 s59, s59, 128
    s_cmp_eq_u32 s59, s23
    s_cselect_b32 s63, 896, 0
    s_sub_u32 s59, s59, s63
    s_waitcnt lgkmcnt(8)
    v_mfma_f32_32x32x16_bf16 v[224:239], v[16:19], v[128:131], 0
    ds_read_b64_tr_b16 v[16:17], v69 offset:38912
    ds_read_b64_tr_b16 v[18:19], v69 offset:39424
    v_mfma_f32_32x32x16_bf16 v[240:255], v[20:23], v[128:131], 0
    ds_read_b64_tr_b16 v[20:21], v70 offset:38912
    ds_read_b64_tr_b16 v[22:23], v70 offset:39424
    v_mul_f32 v192, v192, v102
    v_mul_f32 v193, v193, v102
    v_cvt_pk_bf16_f32 v112, v192, v193
    v_mul_f32 v194, v194, v102
    v_mul_f32 v195, v195, v102
    s_waitcnt lgkmcnt(8)
    v_mfma_f32_32x32x16_bf16 v[224:239], v[0:3], v[132:135], v[224:239]
    ds_read_b64_tr_b16 v[0:1], v69 offset:40960
    ds_read_b64_tr_b16 v[2:3], v69 offset:41472
    v_cvt_pk_bf16_f32 v113, v194, v195
    v_mul_f32 v196, v196, v102
    v_mul_f32 v197, v197, v102
    v_cvt_pk_bf16_f32 v114, v196, v197
    v_mfma_f32_32x32x16_bf16 v[240:255], v[4:7], v[132:135], v[240:255]
    ds_read_b64_tr_b16 v[4:5], v70 offset:40960
    ds_read_b64_tr_b16 v[6:7], v70 offset:41472
    v_mul_f32 v198, v198, v102
    v_mul_f32 v199, v199, v102
    v_cvt_pk_bf16_f32 v115, v198, v199
    buffer_store_dwordx4 v[112:115], v97, s[48:51], s68 offen offset:0 sc1
    v_mul_f32 v200, v200, v102
    s_waitcnt lgkmcnt(8)
    v_mfma_f32_32x32x16_bf16 v[224:239], v[8:11], v[136:139], v[224:239]
    ds_read_b64_tr_b16 v[8:9], v69 offset:43008
    ds_read_b64_tr_b16 v[10:11], v69 offset:43520
    v_mul_f32 v201, v201, v102
    v_cvt_pk_bf16_f32 v116, v200, v201
    v_mul_f32 v202, v202, v102
    v_mul_f32 v203, v203, v102
    v_mfma_f32_32x32x16_bf16 v[240:255], v[12:15], v[136:139], v[240:255]
    ds_read_b64_tr_b16 v[12:13], v70 offset:43008
    ds_read_b64_tr_b16 v[14:15], v70 offset:43520
    v_cvt_pk_bf16_f32 v117, v202, v203
    v_mul_f32 v204, v204, v102
    v_mul_f32 v205, v205, v102
    v_cvt_pk_bf16_f32 v118, v204, v205
    v_mul_f32 v206, v206, v102
    s_waitcnt lgkmcnt(8)
    v_mfma_f32_32x32x16_bf16 v[224:239], v[16:19], v[140:143], v[224:239]
    ds_read_b64_tr_b16 v[16:17], v69 offset:45056
    ds_read_b64_tr_b16 v[18:19], v69 offset:45568
    v_mul_f32 v207, v207, v102
    v_cvt_pk_bf16_f32 v119, v206, v207
    buffer_store_dwordx4 v[116:119], v97, s[48:51], s68 offen offset:1024 sc1
    v_mul_f32 v208, v208, v102
    v_mfma_f32_32x32x16_bf16 v[240:255], v[20:23], v[140:143], v[240:255]
    ds_read_b64_tr_b16 v[20:21], v70 offset:45056
    ds_read_b64_tr_b16 v[22:23], v70 offset:45568
    v_mul_f32 v209, v209, v102
    v_cvt_pk_bf16_f32 v120, v208, v209
    v_mul_f32 v210, v210, v102
    v_mul_f32 v211, v211, v102
    s_waitcnt lgkmcnt(8)
    v_mfma_f32_32x32x16_bf16 v[224:239], v[0:3], v[144:147], v[224:239]
    ds_read_b64_tr_b16 v[0:1], v69 offset:47104
    ds_read_b64_tr_b16 v[2:3], v69 offset:47616
    v_cvt_pk_bf16_f32 v121, v210, v211
    v_mul_f32 v212, v212, v102
    v_mul_f32 v213, v213, v102
    v_cvt_pk_bf16_f32 v122, v212, v213
    v_mul_f32 v214, v214, v102
    v_mfma_f32_32x32x16_bf16 v[240:255], v[4:7], v[144:147], v[240:255]
    ds_read_b64_tr_b16 v[4:5], v70 offset:47104
    ds_read_b64_tr_b16 v[6:7], v70 offset:47616
    v_mul_f32 v215, v215, v102
    v_cvt_pk_bf16_f32 v123, v214, v215
    buffer_store_dwordx4 v[120:123], v97, s[48:51], s68 offen offset:2048 sc1
    v_mul_f32 v216, v216, v102
    s_waitcnt lgkmcnt(8)
    v_mfma_f32_32x32x16_bf16 v[224:239], v[8:11], v[148:151], v[224:239]
    ds_read_b64_tr_b16 v[8:9], v69 offset:49152
    ds_read_b64_tr_b16 v[10:11], v69 offset:49664
    v_mul_f32 v217, v217, v102
    v_cvt_pk_bf16_f32 v124, v216, v217
    v_mul_f32 v218, v218, v102
    v_mul_f32 v219, v219, v102
    v_cvt_pk_bf16_f32 v125, v218, v219
    v_mfma_f32_32x32x16_bf16 v[240:255], v[12:15], v[148:151], v[240:255]
    ds_read_b64_tr_b16 v[12:13], v70 offset:49152
    ds_read_b64_tr_b16 v[14:15], v70 offset:49664
    v_mul_f32 v220, v220, v102
    v_mul_f32 v221, v221, v102
    v_cvt_pk_bf16_f32 v126, v220, v221
    v_mul_f32 v222, v222, v102
    s_waitcnt lgkmcnt(8)
    v_mfma_f32_32x32x16_bf16 v[224:239], v[16:19], v[152:155], v[224:239]
    ds_read_b64_tr_b16 v[16:17], v69 offset:51200
    ds_read_b64_tr_b16 v[18:19], v69 offset:51712
    v_mul_f32 v223, v223, v102
    v_cvt_pk_bf16_f32 v127, v222, v223
    buffer_store_dwordx4 v[124:127], v97, s[48:51], s68 offen offset:3072 sc1
    s_add_u32 s68, s68, 4096
    s_cmp_eq_u32 s68, s24
    s_cselect_b32 s61, 28672, 0
    s_sub_u32 s68, s68, s61
    v_mfma_f32_32x32x16_bf16 v[240:255], v[20:23], v[152:155], v[240:255]
    ds_read_b64_tr_b16 v[20:21], v70 offset:51200
    ds_read_b64_tr_b16 v[22:23], v70 offset:51712
    s_waitcnt lgkmcnt(8)
    v_mfma_f32_32x32x16_bf16 v[224:239], v[0:3], v[156:159], v[224:239]
    ds_read_b64_tr_b16 v[0:1], v69 offset:53248
    ds_read_b64_tr_b16 v[2:3], v69 offset:53760
    v_add_u32 v28, 1, v28
    s_waitcnt vmcnt(24)
    buffer_store_dword v28, v99, s[48:51], s16 offen sc1
    buffer_load_dwordx4 v[60:63], v101, s[28:31], s20 offen
    buffer_load_dwordx4 v[92:95], v101, s[28:31], s20 offen offset:16
    v_mfma_f32_32x32x16_bf16 v[240:255], v[4:7], v[156:159], v[240:255]
    ds_read_b64_tr_b16 v[4:5], v70 offset:53248
    ds_read_b64_tr_b16 v[6:7], v70 offset:53760
    s_waitcnt lgkmcnt(8)
    v_mfma_f32_32x32x16_bf16 v[224:239], v[8:11], v[160:163], v[224:239]
    ds_read_b64_tr_b16 v[8:9], v69 offset:55296
    ds_read_b64_tr_b16 v[10:11], v69 offset:55808
    v_mfma_f32_32x32x16_bf16 v[240:255], v[12:15], v[160:163], v[240:255]
    ds_read_b64_tr_b16 v[12:13], v70 offset:55296
    ds_read_b64_tr_b16 v[14:15], v70 offset:55808
    s_waitcnt lgkmcnt(8)
    v_mfma_f32_32x32x16_bf16 v[224:239], v[16:19], v[164:167], v[224:239]
    ds_read_b64_tr_b16 v[16:17], v69 offset:57344
    ds_read_b64_tr_b16 v[18:19], v69 offset:57856
    v_mfma_f32_32x32x16_bf16 v[240:255], v[20:23], v[164:167], v[240:255]
    ds_read_b64_tr_b16 v[20:21], v70 offset:57344
    ds_read_b64_tr_b16 v[22:23], v70 offset:57856
    s_waitcnt lgkmcnt(8)
    v_mfma_f32_32x32x16_bf16 v[224:239], v[0:3], v[168:171], v[224:239]
    ds_read_b64_tr_b16 v[0:1], v69 offset:59392
    ds_read_b64_tr_b16 v[2:3], v69 offset:59904
    v_mfma_f32_32x32x16_bf16 v[240:255], v[4:7], v[168:171], v[240:255]
    ds_read_b64_tr_b16 v[4:5], v70 offset:59392
    ds_read_b64_tr_b16 v[6:7], v70 offset:59904
    s_waitcnt lgkmcnt(8)
    v_mfma_f32_32x32x16_bf16 v[224:239], v[8:11], v[172:175], v[224:239]
    ds_read_b64_tr_b16 v[8:9], v69 offset:61440
    ds_read_b64_tr_b16 v[10:11], v69 offset:61952
    v_mfma_f32_32x32x16_bf16 v[240:255], v[12:15], v[172:175], v[240:255]
    ds_read_b64_tr_b16 v[12:13], v70 offset:61440
    ds_read_b64_tr_b16 v[14:15], v70 offset:61952
    s_waitcnt lgkmcnt(8)
    v_mfma_f32_32x32x16_bf16 v[224:239], v[16:19], v[176:179], v[224:239]
    s_barrier
    ds_read_b64_tr_b16 v[16:17], v69 offset:63488
    ds_read_b64_tr_b16 v[18:19], v69 offset:64000
    v_mfma_f32_32x32x16_bf16 v[240:255], v[20:23], v[176:179], v[240:255]
    ds_read_b64_tr_b16 v[20:21], v70 offset:63488
    ds_read_b64_tr_b16 v[22:23], v70 offset:64000
    s_waitcnt lgkmcnt(8)
    v_mfma_f32_32x32x16_bf16 v[224:239], v[0:3], v[180:183], v[224:239]
    ds_read_b64_tr_b16 v[0:1], v71 offset:0
    ds_read_b64_tr_b16 v[2:3], v71 offset:512
    v_mfma_f32_32x32x16_bf16 v[240:255], v[4:7], v[180:183], v[240:255]
    ds_read_b64_tr_b16 v[4:5], v72 offset:0
    ds_read_b64_tr_b16 v[6:7], v72 offset:512
    s_waitcnt lgkmcnt(8)
    v_mfma_f32_32x32x16_bf16 v[224:239], v[8:11], v[184:187], v[224:239]
    ds_read_b64_tr_b16 v[8:9], v71 offset:2048
    ds_read_b64_tr_b16 v[10:11], v71 offset:2560
    v_mfma_f32_32x32x16_bf16 v[240:255], v[12:15], v[184:187], v[240:255]
    ds_read_b64_tr_b16 v[12:13], v72 offset:2048
    ds_read_b64_tr_b16 v[14:15], v72 offset:2560
    s_waitcnt lgkmcnt(8)
    v_mfma_f32_32x32x16_bf16 v[224:239], v[16:19], v[188:191], v[224:239]
    ds_read_b64_tr_b16 v[16:17], v71 offset:4096
    ds_read_b64_tr_b16 v[18:19], v71 offset:4608
    v_mfma_f32_32x32x16_bf16 v[240:255], v[20:23], v[188:191], v[240:255]
    ds_read_b64_tr_b16 v[20:21], v72 offset:4096
    ds_read_b64_tr_b16 v[22:23], v72 offset:4608
    s_waitcnt lgkmcnt(8)
    v_mfma_f32_32x32x16_bf16 v[192:207], v[0:3], v[128:131], 0
    ds_read_b64_tr_b16 v[0:1], v71 offset:6144
    ds_read_b64_tr_b16 v[2:3], v71 offset:6656
    v_mfma_f32_32x32x16_bf16 v[208:223], v[4:7], v[128:131], 0
    ds_read_b64_tr_b16 v[4:5], v72 offset:6144
    ds_read_b64_tr_b16 v[6:7], v72 offset:6656
    v_mul_f32 v224, v224, v102
    v_mul_f32 v225, v225, v102
    v_cvt_pk_bf16_f32 v112, v224, v225
    v_mul_f32 v226, v226, v102
    v_mul_f32 v227, v227, v102
    s_waitcnt lgkmcnt(8)
    v_mfma_f32_32x32x16_bf16 v[192:207], v[8:11], v[132:135], v[192:207]
    ds_read_b64_tr_b16 v[8:9], v71 offset:8192
    ds_read_b64_tr_b16 v[10:11], v71 offset:8704
    v_cvt_pk_bf16_f32 v113, v226, v227
    v_mul_f32 v228, v228, v102
    v_mul_f32 v229, v229, v102
    v_cvt_pk_bf16_f32 v114, v228, v229
    v_mfma_f32_32x32x16_bf16 v[208:223], v[12:15], v[132:135], v[208:223]
    ds_read_b64_tr_b16 v[12:13], v72 offset:8192
    ds_read_b64_tr_b16 v[14:15], v72 offset:8704
    v_mul_f32 v230, v230, v102
    v_mul_f32 v231, v231, v102
    v_cvt_pk_bf16_f32 v115, v230, v231
    buffer_store_dwordx4 v[112:115], v97, s[48:51], s68 offen offset:0 sc1
    v_mul_f32 v232, v232, v102
    s_waitcnt lgkmcnt(8)
    v_mfma_f32_32x32x16_bf16 v[192:207], v[16:19], v[136:139], v[192:207]
    ds_read_b64_tr_b16 v[16:17], v71 offset:10240
    ds_read_b64_tr_b16 v[18:19], v71 offset:10752
    v_mul_f32 v233, v233, v102
    v_cvt_pk_bf16_f32 v116, v232, v233
    v_mul_f32 v234, v234, v102
    v_mul_f32 v235, v235, v102
    v_mfma_f32_32x32x16_bf16 v[208:223], v[20:23], v[136:139], v[208:223]
    ds_read_b64_tr_b16 v[20:21], v72 offset:10240
    ds_read_b64_tr_b16 v[22:23], v72 offset:10752
    v_cvt_pk_bf16_f32 v117, v234, v235
    v_mul_f32 v236, v236, v102
    v_mul_f32 v237, v237, v102
    v_cvt_pk_bf16_f32 v118, v236, v237
    v_mul_f32 v238, v238, v102
    s_waitcnt lgkmcnt(8)
    v_mfma_f32_32x32x16_bf16 v[192:207], v[0:3], v[140:143], v[192:207]
    ds_read_b64_tr_b16 v[0:1], v71 offset:12288
    ds_read_b64_tr_b16 v[2:3], v71 offset:12800
    v_mul_f32 v239, v239, v102
    v_cvt_pk_bf16_f32 v119, v238, v239
    buffer_store_dwordx4 v[116:119], v97, s[48:51], s68 offen offset:1024 sc1
    v_mul_f32 v240, v240, v102
    v_mfma_f32_32x32x16_bf16 v[208:223], v[4:7], v[140:143], v[208:223]
    ds_read_b64_tr_b16 v[4:5], v72 offset:12288
    ds_read_b64_tr_b16 v[6:7], v72 offset:12800
    v_mul_f32 v241, v241, v102
    v_cvt_pk_bf16_f32 v120, v240, v241
    v_mul_f32 v242, v242, v102
    v_mul_f32 v243, v243, v102
    s_waitcnt lgkmcnt(8)
    v_mfma_f32_32x32x16_bf16 v[192:207], v[8:11], v[144:147], v[192:207]
    ds_read_b64_tr_b16 v[8:9], v71 offset:14336
    ds_read_b64_tr_b16 v[10:11], v71 offset:14848
    v_cvt_pk_bf16_f32 v121, v242, v243
    v_mul_f32 v244, v244, v102
    v_mul_f32 v245, v245, v102
    v_cvt_pk_bf16_f32 v122, v244, v245
    v_mul_f32 v246, v246, v102
    v_mfma_f32_32x32x16_bf16 v[208:223], v[12:15], v[144:147], v[208:223]
    ds_read_b64_tr_b16 v[12:13], v72 offset:14336
    ds_read_b64_tr_b16 v[14:15], v72 offset:14848
    v_mul_f32 v247, v247, v102
    v_cvt_pk_bf16_f32 v123, v246, v247
    buffer_store_dwordx4 v[120:123], v97, s[48:51], s68 offen offset:2048 sc1
    v_mul_f32 v248, v248, v102
    s_waitcnt lgkmcnt(8)
    v_mfma_f32_32x32x16_bf16 v[192:207], v[16:19], v[148:151], v[192:207]
    ds_read_b64_tr_b16 v[16:17], v71 offset:16384
    ds_read_b64_tr_b16 v[18:19], v71 offset:16896
    v_mul_f32 v249, v249, v102
    v_cvt_pk_bf16_f32 v124, v248, v249
    v_mul_f32 v250, v250, v102
    v_mul_f32 v251, v251, v102
    v_cvt_pk_bf16_f32 v125, v250, v251
    v_mfma_f32_32x32x16_bf16 v[208:223], v[20:23], v[148:151], v[208:223]
    ds_read_b64_tr_b16 v[20:21], v72 offset:16384
    ds_read_b64_tr_b16 v[22:23], v72 offset:16896
    v_mul_f32 v252, v252, v102
    v_mul_f32 v253, v253, v102
    v_cvt_pk_bf16_f32 v126, v252, v253
    v_mul_f32 v254, v254, v102
    s_waitcnt lgkmcnt(8)
    v_mfma_f32_32x32x16_bf16 v[192:207], v[0:3], v[152:155], v[192:207]
    ds_read_b64_tr_b16 v[0:1], v71 offset:18432
    ds_read_b64_tr_b16 v[2:3], v71 offset:18944
    v_mul_f32 v255, v255, v102
    v_cvt_pk_bf16_f32 v127, v254, v255
    buffer_store_dwordx4 v[124:127], v97, s[48:51], s68 offen offset:3072 sc1
    s_add_u32 s68, s68, 4096
    s_cmp_eq_u32 s68, s24
    s_cselect_b32 s61, 28672, 0
    s_sub_u32 s68, s68, s61
    v_mfma_f32_32x32x16_bf16 v[208:223], v[4:7], v[152:155], v[208:223]
    ds_read_b64_tr_b16 v[4:5], v72 offset:18432
    ds_read_b64_tr_b16 v[6:7], v72 offset:18944
    s_waitcnt lgkmcnt(8)
    v_mfma_f32_32x32x16_bf16 v[192:207], v[8:11], v[156:159], v[192:207]
    ds_read_b64_tr_b16 v[8:9], v71 offset:20480
    ds_read_b64_tr_b16 v[10:11], v71 offset:20992
    v_add_u32 v28, 1, v28
    s_waitcnt vmcnt(19)
    buffer_store_dword v28, v99, s[48:51], s16 offen sc1
    v_mfma_f32_32x32x16_bf16 v[208:223], v[12:15], v[156:159], v[208:223]
    ds_read_b64_tr_b16 v[12:13], v72 offset:20480
    ds_read_b64_tr_b16 v[14:15], v72 offset:20992
    s_waitcnt lgkmcnt(8)
    v_mfma_f32_32x32x16_bf16 v[192:207], v[16:19], v[160:163], v[192:207]
    ds_read_b64_tr_b16 v[16:17], v71 offset:22528
    ds_read_b64_tr_b16 v[18:19], v71 offset:23040
    v_mfma_f32_32x32x16_bf16 v[208:223], v[20:23], v[160:163], v[208:223]
    ds_read_b64_tr_b16 v[20:21], v72 offset:22528
    ds_read_b64_tr_b16 v[22:23], v72 offset:23040
    s_waitcnt lgkmcnt(8)
    v_mfma_f32_32x32x16_bf16 v[192:207], v[0:3], v[164:167], v[192:207]
    ds_read_b64_tr_b16 v[0:1], v71 offset:24576
    ds_read_b64_tr_b16 v[2:3], v71 offset:25088
    v_mfma_f32_32x32x16_bf16 v[208:223], v[4:7], v[164:167], v[208:223]
    ds_read_b64_tr_b16 v[4:5], v72 offset:24576
    ds_read_b64_tr_b16 v[6:7], v72 offset:25088
    s_waitcnt lgkmcnt(8)
    v_mfma_f32_32x32x16_bf16 v[192:207], v[8:11], v[168:171], v[192:207]
    ds_read_b64_tr_b16 v[8:9], v71 offset:26624
    ds_read_b64_tr_b16 v[10:11], v71 offset:27136
    v_mfma_f32_32x32x16_bf16 v[208:223], v[12:15], v[168:171], v[208:223]
    ds_read_b64_tr_b16 v[12:13], v72 offset:26624
    ds_read_b64_tr_b16 v[14:15], v72 offset:27136
    s_waitcnt lgkmcnt(8)
    v_mfma_f32_32x32x16_bf16 v[192:207], v[16:19], v[172:175], v[192:207]
    ds_read_b64_tr_b16 v[16:17], v71 offset:28672
    ds_read_b64_tr_b16 v[18:19], v71 offset:29184
    v_mfma_f32_32x32x16_bf16 v[208:223], v[20:23], v[172:175], v[208:223]
    ds_read_b64_tr_b16 v[20:21], v72 offset:28672
    ds_read_b64_tr_b16 v[22:23], v72 offset:29184
    s_waitcnt lgkmcnt(8)
    v_mfma_f32_32x32x16_bf16 v[192:207], v[0:3], v[176:179], v[192:207]
    s_barrier
    ds_read_b64_tr_b16 v[0:1], v71 offset:30720
    ds_read_b64_tr_b16 v[2:3], v71 offset:31232
    v_mfma_f32_32x32x16_bf16 v[208:223], v[4:7], v[176:179], v[208:223]
    ds_read_b64_tr_b16 v[4:5], v72 offset:30720
    ds_read_b64_tr_b16 v[6:7], v72 offset:31232
    s_waitcnt lgkmcnt(8)
    v_mfma_f32_32x32x16_bf16 v[192:207], v[8:11], v[180:183], v[192:207]
    ds_read_b64_tr_b16 v[8:9], v67 offset:0
    ds_read_b64_tr_b16 v[10:11], v67 offset:512
    v_mfma_f32_32x32x16_bf16 v[208:223], v[12:15], v[180:183], v[208:223]
    ds_read_b64_tr_b16 v[12:13], v68 offset:0
    ds_read_b64_tr_b16 v[14:15], v68 offset:512
    s_waitcnt lgkmcnt(8)
    v_mfma_f32_32x32x16_bf16 v[192:207], v[16:19], v[184:187], v[192:207]
    ds_read_b64_tr_b16 v[16:17], v67 offset:2048
    ds_read_b64_tr_b16 v[18:19], v67 offset:2560
    v_mfma_f32_32x32x16_bf16 v[208:223], v[20:23], v[184:187], v[208:223]
    ds_read_b64_tr_b16 v[20:21], v68 offset:2048
    ds_read_b64_tr_b16 v[22:23], v68 offset:2560
    s_waitcnt lgkmcnt(8)
    v_mfma_f32_32x32x16_bf16 v[192:207], v[0:3], v[188:191], v[192:207]
    ds_read_b64_tr_b16 v[0:1], v67 offset:4096
    ds_read_b64_tr_b16 v[2:3], v67 offset:4608
    v_mfma_f32_32x32x16_bf16 v[208:223], v[4:7], v[188:191], v[208:223]
    ds_read_b64_tr_b16 v[4:5], v68 offset:4096
    ds_read_b64_tr_b16 v[6:7], v68 offset:4608
    s_waitcnt lgkmcnt(8)
    v_mfma_f32_32x32x16_bf16 v[224:239], v[8:11], v[128:131], 0
    ds_read_b64_tr_b16 v[8:9], v67 offset:6144
    ds_read_b64_tr_b16 v[10:11], v67 offset:6656
    v_mfma_f32_32x32x16_bf16 v[240:255], v[12:15], v[128:131], 0
    ds_read_b64_tr_b16 v[12:13], v68 offset:6144
    ds_read_b64_tr_b16 v[14:15], v68 offset:6656
    v_mul_f32 v192, v192, v102
    v_mul_f32 v193, v193, v102
    v_cvt_pk_bf16_f32 v112, v192, v193
    v_mul_f32 v194, v194, v102
    v_mul_f32 v195, v195, v102
    s_waitcnt lgkmcnt(8)
    v_mfma_f32_32x32x16_bf16 v[224:239], v[16:19], v[132:135], v[224:239]
    ds_read_b64_tr_b16 v[16:17], v67 offset:8192
    ds_read_b64_tr_b16 v[18:19], v67 offset:8704
    v_cvt_pk_bf16_f32 v113, v194, v195
    v_mul_f32 v196, v196, v102
    v_mul_f32 v197, v197, v102
    v_cvt_pk_bf16_f32 v114, v196, v197
    v_mfma_f32_32x32x16_bf16 v[240:255], v[20:23], v[132:135], v[240:255]
    ds_read_b64_tr_b16 v[20:21], v68 offset:8192
    ds_read_b64_tr_b16 v[22:23], v68 offset:8704
    v_mul_f32 v198, v198, v102
    v_mul_f32 v199, v199, v102
    v_cvt_pk_bf16_f32 v115, v198, v199
    buffer_store_dwordx4 v[112:115], v97, s[48:51], s68 offen offset:0 sc1
    v_mul_f32 v200, v200, v102
    s_waitcnt lgkmcnt(8)
    v_mfma_f32_32x32x16_bf16 v[224:239], v[0:3], v[136:139], v[224:239]
    ds_read_b64_tr_b16 v[0:1], v67 offset:10240
    ds_read_b64_tr_b16 v[2:3], v67 offset:10752
    v_mul_f32 v201, v201, v102
    v_cvt_pk_bf16_f32 v116, v200, v201
    v_mul_f32 v202, v202, v102
    v_mul_f32 v203, v203, v102
    v_mfma_f32_32x32x16_bf16 v[240:255], v[4:7], v[136:139], v[240:255]
    ds_read_b64_tr_b16 v[4:5], v68 offset:10240
    ds_read_b64_tr_b16 v[6:7], v68 offset:10752
    v_cvt_pk_bf16_f32 v117, v202, v203
    v_mul_f32 v204, v204, v102
    v_mul_f32 v205, v205, v102
    v_cvt_pk_bf16_f32 v118, v204, v205
    v_mul_f32 v206, v206, v102
    s_waitcnt lgkmcnt(8)
    v_mfma_f32_32x32x16_bf16 v[224:239], v[8:11], v[140:143], v[224:239]
    ds_read_b64_tr_b16 v[8:9], v67 offset:12288
    ds_read_b64_tr_b16 v[10:11], v67 offset:12800
    v_mul_f32 v207, v207, v102
    v_cvt_pk_bf16_f32 v119, v206, v207
    buffer_store_dwordx4 v[116:119], v97, s[48:51], s68 offen offset:1024 sc1
    v_mul_f32 v208, v208, v102
    v_mfma_f32_32x32x16_bf16 v[240:255], v[12:15], v[140:143], v[240:255]
    ds_read_b64_tr_b16 v[12:13], v68 offset:12288
    ds_read_b64_tr_b16 v[14:15], v68 offset:12800
    v_mul_f32 v209, v209, v102
    v_cvt_pk_bf16_f32 v120, v208, v209
    v_mul_f32 v210, v210, v102
    v_mul_f32 v211, v211, v102
    s_waitcnt lgkmcnt(8)
    v_mfma_f32_32x32x16_bf16 v[224:239], v[16:19], v[144:147], v[224:239]
    ds_read_b64_tr_b16 v[16:17], v67 offset:14336
    ds_read_b64_tr_b16 v[18:19], v67 offset:14848
    v_cvt_pk_bf16_f32 v121, v210, v211
    v_mul_f32 v212, v212, v102
    v_mul_f32 v213, v213, v102
    v_cvt_pk_bf16_f32 v122, v212, v213
    v_mul_f32 v214, v214, v102
    v_mfma_f32_32x32x16_bf16 v[240:255], v[20:23], v[144:147], v[240:255]
    ds_read_b64_tr_b16 v[20:21], v68 offset:14336
    ds_read_b64_tr_b16 v[22:23], v68 offset:14848
    v_mul_f32 v215, v215, v102
    v_cvt_pk_bf16_f32 v123, v214, v215
    buffer_store_dwordx4 v[120:123], v97, s[48:51], s68 offen offset:2048 sc1
    v_mul_f32 v216, v216, v102
    s_waitcnt lgkmcnt(8)
    v_mfma_f32_32x32x16_bf16 v[224:239], v[0:3], v[148:151], v[224:239]
    ds_read_b64_tr_b16 v[0:1], v67 offset:16384
    ds_read_b64_tr_b16 v[2:3], v67 offset:16896
    v_mul_f32 v217, v217, v102
    v_cvt_pk_bf16_f32 v124, v216, v217
    v_mul_f32 v218, v218, v102
    v_mul_f32 v219, v219, v102
    v_cvt_pk_bf16_f32 v125, v218, v219
    v_mfma_f32_32x32x16_bf16 v[240:255], v[4:7], v[148:151], v[240:255]
    ds_read_b64_tr_b16 v[4:5], v68 offset:16384
    ds_read_b64_tr_b16 v[6:7], v68 offset:16896
    v_mul_f32 v220, v220, v102
    v_mul_f32 v221, v221, v102
    v_cvt_pk_bf16_f32 v126, v220, v221
    v_mul_f32 v222, v222, v102
    s_waitcnt lgkmcnt(8)
    v_mfma_f32_32x32x16_bf16 v[224:239], v[8:11], v[152:155], v[224:239]
    ds_read_b64_tr_b16 v[8:9], v67 offset:18432
    ds_read_b64_tr_b16 v[10:11], v67 offset:18944
    v_mul_f32 v223, v223, v102
    v_cvt_pk_bf16_f32 v127, v222, v223
    buffer_store_dwordx4 v[124:127], v97, s[48:51], s68 offen offset:3072 sc1
    s_add_u32 s68, s68, 4096
    s_cmp_eq_u32 s68, s24
    s_cselect_b32 s61, 28672, 0
    s_sub_u32 s68, s68, s61
    v_mfma_f32_32x32x16_bf16 v[240:255], v[12:15], v[152:155], v[240:255]
    ds_read_b64_tr_b16 v[12:13], v68 offset:18432
    ds_read_b64_tr_b16 v[14:15], v68 offset:18944
    s_waitcnt lgkmcnt(8)
    v_mfma_f32_32x32x16_bf16 v[224:239], v[16:19], v[156:159], v[224:239]
    ds_read_b64_tr_b16 v[16:17], v67 offset:20480
    ds_read_b64_tr_b16 v[18:19], v67 offset:20992
    v_add_u32 v28, 1, v28
    s_waitcnt vmcnt(12)
    buffer_store_dword v28, v99, s[48:51], s16 offen sc1
    v_mfma_f32_32x32x16_bf16 v[240:255], v[20:23], v[156:159], v[240:255]
    ds_read_b64_tr_b16 v[20:21], v68 offset:20480
    ds_read_b64_tr_b16 v[22:23], v68 offset:20992
    s_waitcnt lgkmcnt(8)
    v_mfma_f32_32x32x16_bf16 v[224:239], v[0:3], v[160:163], v[224:239]
    ds_read_b64_tr_b16 v[0:1], v67 offset:22528
    ds_read_b64_tr_b16 v[2:3], v67 offset:23040
    v_mfma_f32_32x32x16_bf16 v[240:255], v[4:7], v[160:163], v[240:255]
    ds_read_b64_tr_b16 v[4:5], v68 offset:22528
    ds_read_b64_tr_b16 v[6:7], v68 offset:23040
    s_waitcnt lgkmcnt(8)
    v_mfma_f32_32x32x16_bf16 v[224:239], v[8:11], v[164:167], v[224:239]
    ds_read_b64_tr_b16 v[8:9], v67 offset:24576
    ds_read_b64_tr_b16 v[10:11], v67 offset:25088
    v_mfma_f32_32x32x16_bf16 v[240:255], v[12:15], v[164:167], v[240:255]
    ds_read_b64_tr_b16 v[12:13], v68 offset:24576
    ds_read_b64_tr_b16 v[14:15], v68 offset:25088
    s_waitcnt lgkmcnt(8)
    v_mfma_f32_32x32x16_bf16 v[224:239], v[16:19], v[168:171], v[224:239]
    ds_read_b64_tr_b16 v[16:17], v67 offset:26624
    ds_read_b64_tr_b16 v[18:19], v67 offset:27136
    v_mfma_f32_32x32x16_bf16 v[240:255], v[20:23], v[168:171], v[240:255]
    ds_read_b64_tr_b16 v[20:21], v68 offset:26624
    ds_read_b64_tr_b16 v[22:23], v68 offset:27136
    s_waitcnt lgkmcnt(8)
    v_mfma_f32_32x32x16_bf16 v[224:239], v[0:3], v[172:175], v[224:239]
    ds_read_b64_tr_b16 v[0:1], v67 offset:28672
    ds_read_b64_tr_b16 v[2:3], v67 offset:29184
    v_mfma_f32_32x32x16_bf16 v[240:255], v[4:7], v[172:175], v[240:255]
    ds_read_b64_tr_b16 v[4:5], v68 offset:28672
    ds_read_b64_tr_b16 v[6:7], v68 offset:29184
    s_waitcnt lgkmcnt(8)
    v_mfma_f32_32x32x16_bf16 v[224:239], v[8:11], v[176:179], v[224:239]
    s_barrier
    ds_read_b64_tr_b16 v[8:9], v67 offset:30720
    ds_read_b64_tr_b16 v[10:11], v67 offset:31232
    v_mfma_f32_32x32x16_bf16 v[240:255], v[12:15], v[176:179], v[240:255]
    ds_read_b64_tr_b16 v[12:13], v68 offset:30720
    ds_read_b64_tr_b16 v[14:15], v68 offset:31232
    s_waitcnt lgkmcnt(8)
    v_mfma_f32_32x32x16_bf16 v[224:239], v[16:19], v[180:183], v[224:239]
    ds_read_b64_tr_b16 v[16:17], v67 offset:32768
    ds_read_b64_tr_b16 v[18:19], v67 offset:33280
    v_mfma_f32_32x32x16_bf16 v[240:255], v[20:23], v[180:183], v[240:255]
    ds_read_b64_tr_b16 v[20:21], v68 offset:32768
    ds_read_b64_tr_b16 v[22:23], v68 offset:33280
    s_waitcnt lgkmcnt(8)
    v_mfma_f32_32x32x16_bf16 v[224:239], v[0:3], v[184:187], v[224:239]
    ds_read_b64_tr_b16 v[0:1], v67 offset:34816
    ds_read_b64_tr_b16 v[2:3], v67 offset:35328
    v_mfma_f32_32x32x16_bf16 v[240:255], v[4:7], v[184:187], v[240:255]
    ds_read_b64_tr_b16 v[4:5], v68 offset:34816
    ds_read_b64_tr_b16 v[6:7], v68 offset:35328
    s_waitcnt lgkmcnt(8)
    v_mfma_f32_32x32x16_bf16 v[224:239], v[8:11], v[188:191], v[224:239]
    ds_read_b64_tr_b16 v[8:9], v67 offset:36864
    ds_read_b64_tr_b16 v[10:11], v67 offset:37376
    v_mfma_f32_32x32x16_bf16 v[240:255], v[12:15], v[188:191], v[240:255]
    ds_read_b64_tr_b16 v[12:13], v68 offset:36864
    ds_read_b64_tr_b16 v[14:15], v68 offset:37376
    s_waitcnt lgkmcnt(8)
    v_mfma_f32_32x32x16_bf16 v[192:207], v[16:19], v[128:131], 0
    ds_read_b64_tr_b16 v[16:17], v67 offset:38912
    ds_read_b64_tr_b16 v[18:19], v67 offset:39424
    v_mfma_f32_32x32x16_bf16 v[208:223], v[20:23], v[128:131], 0
    ds_read_b64_tr_b16 v[20:21], v68 offset:38912
    ds_read_b64_tr_b16 v[22:23], v68 offset:39424
    v_mul_f32 v224, v224, v102
    v_mul_f32 v225, v225, v102
    v_cvt_pk_bf16_f32 v112, v224, v225
    v_mul_f32 v226, v226, v102
    v_mul_f32 v227, v227, v102
    s_waitcnt lgkmcnt(8)
    v_mfma_f32_32x32x16_bf16 v[192:207], v[0:3], v[132:135], v[192:207]
    ds_read_b64_tr_b16 v[0:1], v67 offset:40960
    ds_read_b64_tr_b16 v[2:3], v67 offset:41472
    v_cvt_pk_bf16_f32 v113, v226, v227
    v_mul_f32 v228, v228, v102
    v_mul_f32 v229, v229, v102
    v_cvt_pk_bf16_f32 v114, v228, v229
    v_mfma_f32_32x32x16_bf16 v[208:223], v[4:7], v[132:135], v[208:223]
    ds_read_b64_tr_b16 v[4:5], v68 offset:40960
    ds_read_b64_tr_b16 v[6:7], v68 offset:41472
    v_mul_f32 v230, v230, v102
    v_mul_f32 v231, v231, v102
    v_cvt_pk_bf16_f32 v115, v230, v231
    buffer_store_dwordx4 v[112:115], v97, s[48:51], s68 offen offset:0 sc1
    v_mul_f32 v232, v232, v102
    s_waitcnt lgkmcnt(8)
    v_mfma_f32_32x32x16_bf16 v[192:207], v[8:11], v[136:139], v[192:207]
    ds_read_b64_tr_b16 v[8:9], v67 offset:43008
    ds_read_b64_tr_b16 v[10:11], v67 offset:43520
    v_mul_f32 v233, v233, v102
    v_cvt_pk_bf16_f32 v116, v232, v233
    v_mul_f32 v234, v234, v102
    v_mul_f32 v235, v235, v102
    v_mfma_f32_32x32x16_bf16 v[208:223], v[12:15], v[136:139], v[208:223]
    ds_read_b64_tr_b16 v[12:13], v68 offset:43008
    ds_read_b64_tr_b16 v[14:15], v68 offset:43520
    v_cvt_pk_bf16_f32 v117, v234, v235
    v_mul_f32 v236, v236, v102
    v_mul_f32 v237, v237, v102
    v_cvt_pk_bf16_f32 v118, v236, v237
    v_mul_f32 v238, v238, v102
    s_waitcnt lgkmcnt(8)
    v_mfma_f32_32x32x16_bf16 v[192:207], v[16:19], v[140:143], v[192:207]
    ds_read_b64_tr_b16 v[16:17], v67 offset:45056
    ds_read_b64_tr_b16 v[18:19], v67 offset:45568
    v_mul_f32 v239, v239, v102
    v_cvt_pk_bf16_f32 v119, v238, v239
    buffer_store_dwordx4 v[116:119], v97, s[48:51], s68 offen offset:1024 sc1
    v_mul_f32 v240, v240, v102
    v_mfma_f32_32x32x16_bf16 v[208:223], v[20:23], v[140:143], v[208:223]
    ds_read_b64_tr_b16 v[20:21], v68 offset:45056
    ds_read_b64_tr_b16 v[22:23], v68 offset:45568
    v_mul_f32 v241, v241, v102
    v_cvt_pk_bf16_f32 v120, v240, v241
    v_mul_f32 v242, v242, v102
    v_mul_f32 v243, v243, v102
    s_waitcnt lgkmcnt(8)
    v_mfma_f32_32x32x16_bf16 v[192:207], v[0:3], v[144:147], v[192:207]
    ds_read_b64_tr_b16 v[0:1], v67 offset:47104
    ds_read_b64_tr_b16 v[2:3], v67 offset:47616
    v_cvt_pk_bf16_f32 v121, v242, v243
    v_mul_f32 v244, v244, v102
    v_mul_f32 v245, v245, v102
    v_cvt_pk_bf16_f32 v122, v244, v245
    v_mul_f32 v246, v246, v102
    v_mfma_f32_32x32x16_bf16 v[208:223], v[4:7], v[144:147], v[208:223]
    ds_read_b64_tr_b16 v[4:5], v68 offset:47104
    ds_read_b64_tr_b16 v[6:7], v68 offset:47616
    v_mul_f32 v247, v247, v102
    v_cvt_pk_bf16_f32 v123, v246, v247
    buffer_store_dwordx4 v[120:123], v97, s[48:51], s68 offen offset:2048 sc1
    v_mul_f32 v248, v248, v102
    s_waitcnt lgkmcnt(8)
    v_mfma_f32_32x32x16_bf16 v[192:207], v[8:11], v[148:151], v[192:207]
    ds_read_b64_tr_b16 v[8:9], v67 offset:49152
    ds_read_b64_tr_b16 v[10:11], v67 offset:49664
    v_mul_f32 v249, v249, v102
    v_cvt_pk_bf16_f32 v124, v248, v249
    v_mul_f32 v250, v250, v102
    v_mul_f32 v251, v251, v102
    v_cvt_pk_bf16_f32 v125, v250, v251
    v_mfma_f32_32x32x16_bf16 v[208:223], v[12:15], v[148:151], v[208:223]
    ds_read_b64_tr_b16 v[12:13], v68 offset:49152
    ds_read_b64_tr_b16 v[14:15], v68 offset:49664
    v_mul_f32 v252, v252, v102
    v_mul_f32 v253, v253, v102
    v_cvt_pk_bf16_f32 v126, v252, v253
    v_mul_f32 v254, v254, v102
    s_waitcnt lgkmcnt(8)
    v_mfma_f32_32x32x16_bf16 v[192:207], v[16:19], v[152:155], v[192:207]
    ds_read_b64_tr_b16 v[16:17], v67 offset:51200
    ds_read_b64_tr_b16 v[18:19], v67 offset:51712
    v_mul_f32 v255, v255, v102
    v_cvt_pk_bf16_f32 v127, v254, v255
    buffer_store_dwordx4 v[124:127], v97, s[48:51], s68 offen offset:3072 sc1
    s_add_u32 s68, s68, 4096
    s_cmp_eq_u32 s68, s24
    s_cselect_b32 s61, 28672, 0
    s_sub_u32 s68, s68, s61
    v_mfma_f32_32x32x16_bf16 v[208:223], v[20:23], v[152:155], v[208:223]
    ds_read_b64_tr_b16 v[20:21], v68 offset:51200
    ds_read_b64_tr_b16 v[22:23], v68 offset:51712
    s_waitcnt lgkmcnt(8)
    v_mfma_f32_32x32x16_bf16 v[192:207], v[0:3], v[156:159], v[192:207]
    ds_read_b64_tr_b16 v[0:1], v67 offset:53248
    ds_read_b64_tr_b16 v[2:3], v67 offset:53760
    v_add_u32 v28, 1, v28
    s_waitcnt vmcnt(10)
    buffer_store_dword v28, v99, s[48:51], s16 offen sc1
    v_mfma_f32_32x32x16_bf16 v[208:223], v[4:7], v[156:159], v[208:223]
    ds_read_b64_tr_b16 v[4:5], v68 offset:53248
    ds_read_b64_tr_b16 v[6:7], v68 offset:53760
    s_waitcnt lgkmcnt(8)
    v_mfma_f32_32x32x16_bf16 v[192:207], v[8:11], v[160:163], v[192:207]
    ds_read_b64_tr_b16 v[8:9], v67 offset:55296
    ds_read_b64_tr_b16 v[10:11], v67 offset:55808
    v_mfma_f32_32x32x16_bf16 v[208:223], v[12:15], v[160:163], v[208:223]
    ds_read_b64_tr_b16 v[12:13], v68 offset:55296
    ds_read_b64_tr_b16 v[14:15], v68 offset:55808
    s_waitcnt lgkmcnt(8)
    v_mfma_f32_32x32x16_bf16 v[192:207], v[16:19], v[164:167], v[192:207]
    ds_read_b64_tr_b16 v[16:17], v67 offset:57344
    ds_read_b64_tr_b16 v[18:19], v67 offset:57856
    v_mfma_f32_32x32x16_bf16 v[208:223], v[20:23], v[164:167], v[208:223]
    ds_read_b64_tr_b16 v[20:21], v68 offset:57344
    ds_read_b64_tr_b16 v[22:23], v68 offset:57856
    s_waitcnt lgkmcnt(8)
    v_mfma_f32_32x32x16_bf16 v[192:207], v[0:3], v[168:171], v[192:207]
    ds_read_b64_tr_b16 v[0:1], v67 offset:59392
    ds_read_b64_tr_b16 v[2:3], v67 offset:59904
    v_mfma_f32_32x32x16_bf16 v[208:223], v[4:7], v[168:171], v[208:223]
    ds_read_b64_tr_b16 v[4:5], v68 offset:59392
    ds_read_b64_tr_b16 v[6:7], v68 offset:59904
    s_waitcnt lgkmcnt(8)
    v_mfma_f32_32x32x16_bf16 v[192:207], v[8:11], v[172:175], v[192:207]
    ds_read_b64_tr_b16 v[8:9], v67 offset:61440
    ds_read_b64_tr_b16 v[10:11], v67 offset:61952
    v_mfma_f32_32x32x16_bf16 v[208:223], v[12:15], v[172:175], v[208:223]
    ds_read_b64_tr_b16 v[12:13], v68 offset:61440
    ds_read_b64_tr_b16 v[14:15], v68 offset:61952
    s_waitcnt lgkmcnt(8)
    v_mfma_f32_32x32x16_bf16 v[192:207], v[16:19], v[176:179], v[192:207]
    ds_read_b64_tr_b16 v[16:17], v67 offset:63488
    ds_read_b64_tr_b16 v[18:19], v67 offset:64000
    v_mfma_f32_32x32x16_bf16 v[208:223], v[20:23], v[176:179], v[208:223]
    ds_read_b64_tr_b16 v[20:21], v68 offset:63488
    ds_read_b64_tr_b16 v[22:23], v68 offset:64000
    s_waitcnt lgkmcnt(8)
    v_mfma_f32_32x32x16_bf16 v[192:207], v[0:3], v[180:183], v[192:207]
    v_mfma_f32_32x32x16_bf16 v[208:223], v[4:7], v[180:183], v[208:223]
    s_waitcnt lgkmcnt(4)
    v_mfma_f32_32x32x16_bf16 v[192:207], v[8:11], v[184:187], v[192:207]
    v_mfma_f32_32x32x16_bf16 v[208:223], v[12:15], v[184:187], v[208:223]
    s_waitcnt lgkmcnt(0)
    v_mfma_f32_32x32x16_bf16 v[192:207], v[16:19], v[188:191], v[192:207]
    v_add_u32 v28, 1, v28
    s_waitcnt vmcnt(6)
    buffer_store_dword v28, v99, s[48:51], s16 offen sc1
    v_mfma_f32_32x32x16_bf16 v[208:223], v[20:23], v[188:191], v[208:223]
    s_cmp_lt_u32 s12, 4
    s_cbranch_scc1 L1_noty
    v_mfma_f32_32x32x16_bf16 v[76:91], v[52:55], a[192:195], 0
    s_nop 4
    v_mul_f32 v192, v192, v102
    v_mul_f32 v193, v193, v102
    v_cvt_pk_bf16_f32 v112, v192, v193
    v_mul_f32 v194, v194, v102
    v_mul_f32 v195, v195, v102
    v_cvt_pk_bf16_f32 v113, v194, v195
    v_mul_f32 v196, v196, v102
    v_mul_f32 v197, v197, v102
    v_mfma_f32_32x32x16_bf16 v[76:91], v[56:59], a[196:199], v[76:91]
    v_cvt_pk_bf16_f32 v114, v196, v197
    v_mul_f32 v198, v198, v102
    v_mul_f32 v199, v199, v102
    v_cvt_pk_bf16_f32 v115, v198, v199
    buffer_store_dwordx4 v[112:115], v97, s[48:51], s68 offen offset:0 sc1
    v_mul_f32 v200, v200, v102
    v_mul_f32 v201, v201, v102
    v_mfma_f32_32x32x16_bf16 v[76:91], v[52:55], a[200:203], v[76:91]
    v_cvt_pk_bf16_f32 v116, v200, v201
    v_mul_f32 v202, v202, v102
    v_mul_f32 v203, v203, v102
    v_cvt_pk_bf16_f32 v117, v202, v203
    v_mul_f32 v204, v204, v102
    v_mul_f32 v205, v205, v102
    v_cvt_pk_bf16_f32 v118, v204, v205
    v_mul_f32 v206, v206, v102
    v_mfma_f32_32x32x16_bf16 v[76:91], v[56:59], a[204:207], v[76:91]
    v_mul_f32 v207, v207, v102
    v_cvt_pk_bf16_f32 v119, v206, v207
    buffer_store_dwordx4 v[116:119], v97, s[48:51], s68 offen offset:1024 sc1
    v_mul_f32 v208, v208, v102
    v_mul_f32 v209, v209, v102
    v_cvt_pk_bf16_f32 v120, v208, v209
    v_mul_f32 v210, v210, v102
    v_mfma_f32_32x32x16_bf16 v[76:91], v[52:55], a[208:211], v[76:91]
    v_mul_f32 v211, v211, v102
    v_cvt_pk_bf16_f32 v121, v210, v211
    v_mul_f32 v212, v212, v102
    v_mul_f32 v213, v213, v102
    v_cvt_pk_bf16_f32 v122, v212, v213
    v_mul_f32 v214, v214, v102
    v_mul_f32 v215, v215, v102
    v_cvt_pk_bf16_f32 v123, v214, v215
    v_mfma_f32_32x32x16_bf16 v[76:91], v[56:59], a[212:215], v[76:91]
    buffer_store_dwordx4 v[120:123], v97, s[48:51], s68 offen offset:2048 sc1
    v_mul_f32 v216, v216, v102
    v_mul_f32 v217, v217, v102
    v_cvt_pk_bf16_f32 v124, v216, v217
    v_mul_f32 v218, v218, v102
    v_mul_f32 v219, v219, v102
    v_cvt_pk_bf16_f32 v125, v218, v219
    v_mfma_f32_32x32x16_bf16 v[76:91], v[52:55], a[216:219], v[76:91]
    v_mul_f32 v220, v220, v102
    v_mul_f32 v221, v221, v102
    v_cvt_pk_bf16_f32 v126, v220, v221
    v_mul_f32 v222, v222, v102
    v_mul_f32 v223, v223, v102
    v_cvt_pk_bf16_f32 v127, v222, v223
    buffer_store_dwordx4 v[124:127], v97, s[48:51], s68 offen offset:3072 sc1
    v_mfma_f32_32x32x16_bf16 v[76:91], v[56:59], a[220:223], v[76:91]
    buffer_load_dword v31, v100, s[48:51], s17 offen sc1
    v_mfma_f32_32x32x16_bf16 v[76:91], v[52:55], a[224:227], v[76:91]
    v_add_u32 v28, 1, v28
    s_waitcnt vmcnt(7)
    buffer_store_dword v28, v99, s[48:51], s16 offen sc1
    v_mfma_f32_32x32x16_bf16 v[76:91], v[56:59], a[228:231], v[76:91]
    v_add_u32 v28, 1, v28
    s_waitcnt vmcnt(2)
    buffer_store_dword v28, v99, s[48:51], s16 offen sc1
    v_mfma_f32_32x32x16_bf16 v[76:91], v[52:55], a[232:235], v[76:91]
    s_waitcnt vmcnt(2)
    v_sub_u32 v31, v31, v32
    v_cmp_ge_u32 vcc, 7, v31
    s_nop 0
    s_and_b32 s26, vcc_lo, s25
    s_ff1_i32_b32 s27, s26
    s_bitset0_b32 s26, s27
    s_bitset0_b32 s25, s27
    s_min_u32 s27, s27, 255
    s_mul_i32 s27, s27, 1835008
    s_add_u32 s27, s27, s19
    buffer_load_dwordx4 a[0:3], v97, s[48:51], s27 offen offset:0 sc1
    buffer_load_dwordx4 a[4:7], v97, s[48:51], s27 offen offset:1024 sc1
    v_mfma_f32_32x32x16_bf16 v[76:91], v[56:59], a[236:239], v[76:91]
    s_ff1_i32_b32 s27, s26
    s_bitset0_b32 s26, s27
    s_bitset0_b32 s25, s27
    s_min_u32 s27, s27, 255
    s_mul_i32 s27, s27, 1835008
    s_add_u32 s27, s27, s19
    buffer_load_dwordx4 a[8:11], v97, s[48:51], s27 offen offset:0 sc1
    buffer_load_dwordx4 a[12:15], v97, s[48:51], s27 offen offset:1024 sc1
    v_mfma_f32_32x32x16_bf16 v[76:91], v[52:55], a[240:243], v[76:91]
    s_ff1_i32_b32 s27, s26
    s_bitset0_b32 s26, s27
    s_bitset0_b32 s25, s27
    s_min_u32 s27, s27, 255
    s_mul_i32 s27, s27, 1835008
    s_add_u32 s27, s27, s19
    buffer_load_dwordx4 a[16:19], v97, s[48:51], s27 offen offset:0 sc1
    buffer_load_dwordx4 a[20:23], v97, s[48:51], s27 offen offset:1024 sc1
    s_mov_b32 s71, 0x42f5fdf0
    s_mov_b32 s72, 0xc3317218
    v_mfma_f32_32x32x16_bf16 v[76:91], v[56:59], a[244:247], v[76:91]
    s_ff1_i32_b32 s27, s26
    s_bitset0_b32 s26, s27
    s_bitset0_b32 s25, s27
    s_min_u32 s27, s27, 255
    s_mul_i32 s27, s27, 1835008
    s_add_u32 s27, s27, s19
    buffer_load_dwordx4 a[24:27], v97, s[48:51], s27 offen offset:0 sc1
    buffer_load_dwordx4 a[28:31], v97, s[48:51], s27 offen offset:1024 sc1
    v_lshlrev_b32 v0, 16, v60
    v_and_b32 v1, s65, v60
    v_mfma_f32_32x32x16_bf16 v[76:91], v[52:55], a[248:251], v[76:91]
    s_ff1_i32_b32 s27, s26
    s_bitset0_b32 s26, s27
    s_bitset0_b32 s25, s27
    s_min_u32 s27, s27, 255
    s_mul_i32 s27, s27, 1835008
    s_add_u32 s27, s27, s19
    buffer_load_dwordx4 a[32:35], v97, s[48:51], s27 offen offset:0 sc1
    buffer_load_dwordx4 a[36:39], v97, s[48:51], s27 offen offset:1024 sc1
    v_lshlrev_b32 v2, 16, v61
    v_and_b32 v3, s65, v61
    v_mfma_f32_32x32x16_bf16 v[76:91], v[56:59], a[252:255], v[76:91]
    s_ff1_i32_b32 s27, s26
    s_bitset0_b32 s26, s27
    s_bitset0_b32 s25, s27
    s_min_u32 s27, s27, 255
    s_mul_i32 s27, s27, 1835008
    s_add_u32 s27, s27, s19
    buffer_load_dwordx4 a[40:43], v97, s[48:51], s27 offen offset:0 sc1
    buffer_load_dwordx4 a[44:47], v97, s[48:51], s27 offen offset:1024 sc1
    v_lshlrev_b32 v4, 16, v62
    v_and_b32 v5, s65, v62
    v_mfma_f32_32x32x16_bf16 v[76:91], v[52:55], a[128:131], v[76:91]
    s_ff1_i32_b32 s27, s26
    s_bitset0_b32 s26, s27
    s_bitset0_b32 s25, s27
    s_min_u32 s27, s27, 255
    s_mul_i32 s27, s27, 1835008
    s_add_u32 s27, s27, s19
    buffer_load_dwordx4 a[48:51], v97, s[48:51], s27 offen offset:0 sc1
    buffer_load_dwordx4 a[52:55], v97, s[48:51], s27 offen offset:1024 sc1
    v_lshlrev_b32 v6, 16, v63
    v_and_b32 v7, s65, v63
    v_mfma_f32_32x32x16_bf16 v[76:91], v[56:59], a[132:135], v[76:91]
    s_ff1_i32_b32 s27, s26
    s_bitset0_b32 s26, s27
    s_bitset0_b32 s25, s27
    s_min_u32 s27, s27, 255
    s_mul_i32 s27, s27, 1835008
    s_add_u32 s27, s27, s19
    buffer_load_dwordx4 a[56:59], v97, s[48:51], s27 offen offset:0 sc1
    buffer_load_dwordx4 a[60:63], v97, s[48:51], s27 offen offset:1024 sc1
    v_lshlrev_b32 v8, 16, v92
    v_and_b32 v9, s65, v92
    v_mfma_f32_32x32x16_bf16 v[76:91], v[52:55], a[136:139], v[76:91]
    s_ff1_i32_b32 s27, s26
    s_bitset0_b32 s26, s27
    s_bitset0_b32 s25, s27
    s_min_u32 s27, s27, 255
    s_mul_i32 s27, s27, 1835008
    s_add_u32 s27, s27, s19
    buffer_load_dwordx4 a[64:67], v97, s[48:51], s27 offen offset:0 sc1
    buffer_load_dwordx4 a[68:71], v97, s[48:51], s27 offen offset:1024 sc1
    v_lshlrev_b32 v10, 16, v93
    v_and_b32 v11, s65, v93
    v_mfma_f32_32x32x16_bf16 v[76:91], v[56:59], a[140:143], v[76:91]
    s_ff1_i32_b32 s27, s26
    s_bitset0_b32 s26, s27
    s_bitset0_b32 s25, s27
    s_min_u32 s27, s27, 255
    s_mul_i32 s27, s27, 1835008
    s_add_u32 s27, s27, s19
    buffer_load_dwordx4 a[72:75], v97, s[48:51], s27 offen offset:0 sc1
    buffer_load_dwordx4 a[76:79], v97, s[48:51], s27 offen offset:1024 sc1
    v_lshlrev_b32 v12, 16, v94
    v_and_b32 v13, s65, v94
    v_mfma_f32_32x32x16_bf16 v[76:91], v[52:55], a[144:147], v[76:91]
    s_ff1_i32_b32 s27, s26
    s_bitset0_b32 s26, s27
    s_bitset0_b32 s25, s27
    s_min_u32 s27, s27, 255
    s_mul_i32 s27, s27, 1835008
    s_add_u32 s27, s27, s19
    buffer_load_dwordx4 a[80:83], v97, s[48:51], s27 offen offset:0 sc1
    buffer_load_dwordx4 a[84:87], v97, s[48:51], s27 offen offset:1024 sc1
    v_lshlrev_b32 v14, 16, v95
    v_and_b32 v15, s65, v95
    v_mfma_f32_32x32x16_bf16 v[76:91], v[56:59], a[148:151], v[76:91]
    s_ff1_i32_b32 s27, s26
    s_bitset0_b32 s26, s27
    s_bitset0_b32 s25, s27
    s_min_u32 s27, s27, 255
    s_mul_i32 s27, s27, 1835008
    s_add_u32 s27, s27, s19
    buffer_load_dwordx4 a[88:91], v97, s[48:51], s27 offen offset:0 sc1
    buffer_load_dwordx4 a[92:95], v97, s[48:51], s27 offen offset:1024 sc1
    v_mfma_f32_32x32x16_bf16 v[76:91], v[52:55], a[152:155], v[76:91]
    s_ff1_i32_b32 s27, s26
    s_bitset0_b32 s26, s27
    s_bitset0_b32 s25, s27
    s_min_u32 s27, s27, 255
    s_mul_i32 s27, s27, 1835008
    s_add_u32 s27, s27, s19
    buffer_load_dwordx4 a[96:99], v97, s[48:51], s27 offen offset:0 sc1
    buffer_load_dwordx4 a[100:103], v97, s[48:51], s27 offen offset:1024 sc1
    v_mfma_f32_32x32x16_bf16 v[76:91], v[56:59], a[156:159], v[76:91]
    s_ff1_i32_b32 s27, s26
    s_bitset0_b32 s26, s27
    s_bitset0_b32 s25, s27
    s_min_u32 s27, s27, 255
    s_mul_i32 s27, s27, 1835008
    s_add_u32 s27, s27, s19
    buffer_load_dwordx4 a[104:107], v97, s[48:51], s27 offen offset:0 sc1
    buffer_load_dwordx4 a[108:111], v97, s[48:51], s27 offen offset:1024 sc1
    v_mfma_f32_32x32x16_bf16 v[76:91], v[52:55], a[160:163], v[76:91]
    s_ff1_i32_b32 s27, s26
    s_bitset0_b32 s26, s27
    s_bitset0_b32 s25, s27
    s_min_u32 s27, s27, 255
    s_mul_i32 s27, s27, 1835008
    s_add_u32 s27, s27, s19
    buffer_load_dwordx4 a[112:115], v97, s[48:51], s27 offen offset:0 sc1
    buffer_load_dwordx4 a[116:119], v97, s[48:51], s27 offen offset:1024 sc1
    v_mfma_f32_32x32x16_bf16 v[76:91], v[56:59], a[164:167], v[76:91]
    s_ff1_i32_b32 s27, s26
    s_bitset0_b32 s26, s27
    s_bitset0_b32 s25, s27
    s_min_u32 s27, s27, 255
    s_mul_i32 s27, s27, 1835008
    s_add_u32 s27, s27, s19
    buffer_load_dwordx4 a[120:123], v97, s[48:51], s27 offen offset:0 sc1
    buffer_load_dwordx4 a[124:127], v97, s[48:51], s27 offen offset:1024 sc1
    v_mfma_f32_32x32x16_bf16 v[76:91], v[52:55], a[168:171], v[76:91]
    buffer_load_dword v30, v100, s[48:51], s17 offen sc1
    v_mfma_f32_32x32x16_bf16 v[76:91], v[56:59], a[172:175], v[76:91]
    v_mfma_f32_32x32x16_bf16 v[76:91], v[52:55], a[176:179], v[76:91]
    v_mfma_f32_32x32x16_bf16 v[76:91], v[56:59], a[180:183], v[76:91]
    v_mfma_f32_32x32x16_bf16 v[76:91], v[52:55], a[184:187], v[76:91]
    v_mfma_f32_32x32x16_bf16 v[76:91], v[56:59], a[188:191], v[76:91]
    s_waitcnt vmcnt(32)
    v_mfma_f32_32x32x16_bf16 v[36:51], v[52:55], a[0:3], 0
    s_waitcnt vmcnt(31)
    v_mfma_f32_32x32x16_bf16 v[36:51], v[56:59], a[4:7], v[36:51]
    s_nop 7
    v_mul_f32 v112, s72, v76
    v_mul_f32 v113, s72, v77
    v_mul_f32 v114, s72, v78
    v_mul_f32 v115, s72, v79
    v_mul_f32 v116, s72, v80
    v_mul_f32 v117, s72, v81
    v_mul_f32 v118, s72, v82
    s_waitcnt vmcnt(30)
    v_mfma_f32_32x32x16_bf16 v[36:51], v[52:55], a[8:11], v[36:51]
    v_mul_f32 v119, s72, v83
    v_mul_f32 v120, s72, v84
    v_mul_f32 v121, s72, v85
    v_mul_f32 v122, s72, v86
    v_mul_f32 v123, s72, v87
    v_mul_f32 v124, s72, v88
    v_mul_f32 v125, s72, v89
    s_waitcnt vmcnt(29)
    v_mfma_f32_32x32x16_bf16 v[36:51], v[56:59], a[12:15], v[36:51]
    v_mul_f32 v126, s72, v90
    v_mul_f32 v127, s72, v91
    v_exp_f32 v112, v112
    v_exp_f32 v113, v113
    v_exp_f32 v114, v114
    v_exp_f32 v115, v115
    v_exp_f32 v116, v116
    s_waitcnt vmcnt(28)
    v_mfma_f32_32x32x16_bf16 v[36:51], v[52:55], a[16:19], v[36:51]
    v_exp_f32 v117, v117
    v_exp_f32 v118, v118
    v_exp_f32 v119, v119
    v_exp_f32 v120, v120
    v_exp_f32 v121, v121
    v_exp_f32 v122, v122
    v_exp_f32 v123, v123
    s_waitcnt vmcnt(27)
    v_mfma_f32_32x32x16_bf16 v[36:51], v[56:59], a[20:23], v[36:51]
    v_exp_f32 v124, v124
    v_exp_f32 v125, v125
    v_exp_f32 v126, v126
    v_exp_f32 v127, v127
    v_mul_f32 v76, s71, v76
    v_add_f32 v112, 1.0, v112
    v_mul_f32 v77, s71, v77
    s_waitcnt vmcnt(26)
    v_mfma_f32_32x32x16_bf16 v[36:51], v[52:55], a[24:27], v[36:51]
    v_add_f32 v113, 1.0, v113
    v_mul_f32 v78, s71, v78
    v_add_f32 v114, 1.0, v114
    v_mul_f32 v79, s71, v79
    v_add_f32 v115, 1.0, v115
    v_mul_f32 v80, s71, v80
    v_add_f32 v116, 1.0, v116
    s_waitcnt vmcnt(25)
    v_mfma_f32_32x32x16_bf16 v[36:51], v[56:59], a[28:31], v[36:51]
    v_mul_f32 v81, s71, v81
    v_add_f32 v117, 1.0, v117
    v_mul_f32 v82, s71, v82
    v_add_f32 v118, 1.0, v118
    v_mul_f32 v83, s71, v83
    v_add_f32 v119, 1.0, v119
    s_waitcnt vmcnt(24)
    v_mfma_f32_32x32x16_bf16 v[36:51], v[52:55], a[32:35], v[36:51]
    v_mul_f32 v84, s71, v84
    v_add_f32 v120, 1.0, v120
    v_mul_f32 v85, s71, v85
    v_add_f32 v121, 1.0, v121
    v_mul_f32 v86, s71, v86
    v_add_f32 v122, 1.0, v122
    v_mul_f32 v87, s71, v87
    s_waitcnt vmcnt(23)
    v_mfma_f32_32x32x16_bf16 v[36:51], v[56:59], a[36:39], v[36:51]
    v_add_f32 v123, 1.0, v123
    v_mul_f32 v88, s71, v88
    v_add_f32 v124, 1.0, v124
    v_mul_f32 v89, s71, v89
    v_add_f32 v125, 1.0, v125
    v_mul_f32 v90, s71, v90
    v_add_f32 v126, 1.0, v126
    s_waitcnt vmcnt(22)
    v_mfma_f32_32x32x16_bf16 v[36:51], v[52:55], a[40:43], v[36:51]
    v_mul_f32 v91, s71, v91
    v_add_f32 v127, 1.0, v127
    v_rcp_f32 v112, v112
    v_rcp_f32 v113, v113
    v_rcp_f32 v114, v114
    v_rcp_f32 v115, v115
    v_rcp_f32 v116, v116
    s_waitcnt vmcnt(21)
    v_mfma_f32_32x32x16_bf16 v[36:51], v[56:59], a[44:47], v[36:51]
    v_rcp_f32 v117, v117
    v_rcp_f32 v118, v118
    v_rcp_f32 v119, v119
    v_rcp_f32 v120, v120
    v_rcp_f32 v121, v121
    v_rcp_f32 v122, v122
    v_rcp_f32 v123, v123
    s_waitcnt vmcnt(20)
    v_mfma_f32_32x32x16_bf16 v[36:51], v[52:55], a[48:51], v[36:51]
    v_rcp_f32 v124, v124
    v_rcp_f32 v125, v125
    v_rcp_f32 v126, v126
    v_rcp_f32 v127, v127
    v_mul_f32 v76, v76, v112
    v_mul_f32 v77, v77, v113
    v_mul_f32 v78, v78, v114
    s_waitcnt vmcnt(19)
    v_mfma_f32_32x32x16_bf16 v[36:51], v[56:59], a[52:55], v[36:51]
    v_mul_f32 v79, v79, v115
    v_mul_f32 v80, v80, v116
    v_mul_f32 v81, v81, v117
    v_mul_f32 v82, v82, v118
    v_mul_f32 v83, v83, v119
    v_mul_f32 v84, v84, v120
    v_mul_f32 v85, v85, v121
    s_waitcnt vmcnt(18)
    v_mfma_f32_32x32x16_bf16 v[36:51], v[52:55], a[56:59], v[36:51]
    v_mul_f32 v86, v86, v122
    v_mul_f32 v87, v87, v123
    v_mul_f32 v88, v88, v124
    v_mul_f32 v89, v89, v125
    v_mul_f32 v90, v90, v126
    v_mul_f32 v91, v91, v127
    s_waitcnt vmcnt(17)
    v_mfma_f32_32x32x16_bf16 v[36:51], v[56:59], a[60:63], v[36:51]
    s_waitcnt vmcnt(16)
    v_mfma_f32_32x32x16_bf16 v[36:51], v[52:55], a[64:67], v[36:51]
    s_waitcnt vmcnt(15)
    v_mfma_f32_32x32x16_bf16 v[36:51], v[56:59], a[68:71], v[36:51]
    s_waitcnt vmcnt(14)
    v_mfma_f32_32x32x16_bf16 v[36:51], v[52:55], a[72:75], v[36:51]
    s_waitcnt vmcnt(13)
    v_mfma_f32_32x32x16_bf16 v[36:51], v[56:59], a[76:79], v[36:51]
    s_waitcnt vmcnt(12)
    v_mfma_f32_32x32x16_bf16 v[36:51], v[52:55], a[80:83], v[36:51]
    s_waitcnt vmcnt(11)
    v_mfma_f32_32x32x16_bf16 v[36:51], v[56:59], a[84:87], v[36:51]
    s_waitcnt vmcnt(10)
    v_mfma_f32_32x32x16_bf16 v[36:51], v[52:55], a[88:91], v[36:51]
    s_waitcnt vmcnt(9)
    v_mfma_f32_32x32x16_bf16 v[36:51], v[56:59], a[92:95], v[36:51]
    s_waitcnt vmcnt(8)
    v_mfma_f32_32x32x16_bf16 v[36:51], v[52:55], a[96:99], v[36:51]
    s_waitcnt vmcnt(7)
    v_mfma_f32_32x32x16_bf16 v[36:51], v[56:59], a[100:103], v[36:51]
    s_waitcnt vmcnt(6)
    v_mfma_f32_32x32x16_bf16 v[36:51], v[52:55], a[104:107], v[36:51]
    s_waitcnt vmcnt(5)
    v_mfma_f32_32x32x16_bf16 v[36:51], v[56:59], a[108:111], v[36:51]
    s_waitcnt vmcnt(4)
    v_mfma_f32_32x32x16_bf16 v[36:51], v[52:55], a[112:115], v[36:51]
    s_waitcnt vmcnt(3)
    v_mfma_f32_32x32x16_bf16 v[36:51], v[56:59], a[116:119], v[36:51]
    s_waitcnt vmcnt(2)
    v_mfma_f32_32x32x16_bf16 v[36:51], v[52:55], a[120:123], v[36:51]
    s_waitcnt vmcnt(1)
    v_mfma_f32_32x32x16_bf16 v[36:51], v[56:59], a[124:127], v[36:51]
    s_waitcnt vmcnt(0)
    v_sub_u32 v30, v30, v32
    v_cmp_ge_u32 vcc, 7, v30
    s_nop 0
    s_and_b32 s26, vcc_lo, s25
    s_mov_b32 s22, 0
    s_cmp_eq_u32 s25, 0
    s_cbranch_scc1 L1_sum0
L1_r0:
    s_cmp_lg_u32 s26, 0
    s_cbranch_scc1 L1_g0
    s_mov_b32 exec_lo, s25
    s_mov_b32 exec_hi, 0
    buffer_load_dword v30, v100, s[48:51], s17 offen sc1
    s_mov_b64 exec, -1
    s_add_u32 s22, s22, 1
    s_cmp_gt_u32 s22, 131072
    s_cbranch_scc1 L1_sum0
    s_waitcnt vmcnt(0)
    v_sub_u32 v30, v30, v32
    s_nop 1
    v_cmp_ge_u32 vcc, 7, v30
    s_nop 1
    s_and_b32 s26, vcc_lo, s25
    s_nop 1
    s_branch L1_r0
L1_g0:
    s_ff1_i32_b32 s27, s26
    s_bitset0_b32 s26, s27
    s_bitset0_b32 s25, s27
    s_min_u32 s27, s27, 255
    s_mul_i32 s27, s27, 1835008
    s_add_u32 s27, s27, s19
    buffer_load_dwordx4 v[128:131], v97, s[48:51], s27 offen offset:0 sc1
    buffer_load_dwordx4 v[132:135], v97, s[48:51], s27 offen offset:1024 sc1
    s_cmp_eq_u32 s25, 0
    s_cbranch_scc1 L1_sum1
L1_r1:
    s_cmp_lg_u32 s26, 0
    s_cbranch_scc1 L1_g1
    s_mov_b32 exec_lo, s25
    s_mov_b32 exec_hi, 0
    buffer_load_dword v30, v100, s[48:51], s17 offen sc1
    s_mov_b64 exec, -1
    s_add_u32 s22, s22, 1
    s_cmp_gt_u32 s22, 131072
    s_cbranch_scc1 L1_sum1
    s_waitcnt vmcnt(0)
    v_sub_u32 v30, v30, v32
    s_nop 1
    v_cmp_ge_u32 vcc, 7, v30
    s_nop 1
    s_and_b32 s26, vcc_lo, s25
    s_nop 1
    s_branch L1_r1
L1_g1:
    s_ff1_i32_b32 s27, s26
    s_bitset0_b32 s26, s27
    s_bitset0_b32 s25, s27
    s_min_u32 s27, s27, 255
    s_mul_i32 s27, s27, 1835008
    s_add_u32 s27, s27, s19
    buffer_load_dwordx4 v[136:139], v97, s[48:51], s27 offen offset:0 sc1
    buffer_load_dwordx4 v[140:143], v97, s[48:51], s27 offen offset:1024 sc1
    s_cmp_eq_u32 s25, 0
    s_cbranch_scc1 L1_sum2
L1_r2:
    s_cmp_lg_u32 s26, 0
    s_cbranch_scc1 L1_g2
    s_mov_b32 exec_lo, s25
    s_mov_b32 exec_hi, 0
    buffer_load_dword v30, v100, s[48:51], s17 offen sc1
    s_mov_b64 exec, -1
    s_add_u32 s22, s22, 1
    s_cmp_gt_u32 s22, 131072
    s_cbranch_scc1 L1_sum2
    s_waitcnt vmcnt(0)
    v_sub_u32 v30, v30, v32
    s_nop 1
    v_cmp_ge_u32 vcc, 7, v30
    s_nop 1
    s_and_b32 s26, vcc_lo, s25
    s_nop 1
    s_branch L1_r2
L1_g2:
    s_ff1_i32_b32 s27, s26
    s_bitset0_b32 s26, s27
    s_bitset0_b32 s25, s27
    s_min_u32 s27, s27, 255
    s_mul_i32 s27, s27, 1835008
    s_add_u32 s27, s27, s19
    buffer_load_dwordx4 v[144:147], v97, s[48:51], s27 offen offset:0 sc1
    buffer_load_dwordx4 v[148:151], v97, s[48:51], s27 offen offset:1024 sc1
    s_cmp_eq_u32 s25, 0
    s_cbranch_scc1 L1_sum3
L1_r3:
    s_cmp_lg_u32 s26, 0
    s_cbranch_scc1 L1_g3
    s_mov_b32 exec_lo, s25
    s_mov_b32 exec_hi, 0
    buffer_load_dword v30, v100, s[48:51], s17 offen sc1
    s_mov_b64 exec, -1
    s_add_u32 s22, s22, 1
    s_cmp_gt_u32 s22, 131072
    s_cbranch_scc1 L1_sum3
    s_waitcnt vmcnt(0)
    v_sub_u32 v30, v30, v32
    s_nop 1
    v_cmp_ge_u32 vcc, 7, v30
    s_nop 1
    s_and_b32 s26, vcc_lo, s25
    s_nop 1
    s_branch L1_r3
L1_g3:
    s_ff1_i32_b32 s27, s26
    s_bitset0_b32 s26, s27
    s_bitset0_b32 s25, s27
    s_min_u32 s27, s27, 255
    s_mul_i32 s27, s27, 1835008
    s_add_u32 s27, s27, s19
    buffer_load_dwordx4 v[152:155], v97, s[48:51], s27 offen offset:0 sc1
    buffer_load_dwordx4 v[156:159], v97, s[48:51], s27 offen offset:1024 sc1
    s_cmp_eq_u32 s25, 0
    s_cbranch_scc1 L1_sum4
L1_r4:
    s_cmp_lg_u32 s26, 0
    s_cbranch_scc1 L1_g4
    s_mov_b32 exec_lo, s25
    s_mov_b32 exec_hi, 0
    buffer_load_dword v30, v100, s[48:51], s17 offen sc1
    s_mov_b64 exec, -1
    s_add_u32 s22, s22, 1
    s_cmp_gt_u32 s22, 131072
    s_cbranch_scc1 L1_sum4
    s_waitcnt vmcnt(0)
    v_sub_u32 v30, v30, v32
    s_nop 1
    v_cmp_ge_u32 vcc, 7, v30
    s_nop 1
    s_and_b32 s26, vcc_lo, s25
    s_nop 1
    s_branch L1_r4
L1_g4:
    s_ff1_i32_b32 s27, s26
    s_bitset0_b32 s26, s27
    s_bitset0_b32 s25, s27
    s_min_u32 s27, s27, 255
    s_mul_i32 s27, s27, 1835008
    s_add_u32 s27, s27, s19
    buffer_load_dwordx4 v[160:163], v97, s[48:51], s27 offen offset:0 sc1
    buffer_load_dwordx4 v[164:167], v97, s[48:51], s27 offen offset:1024 sc1
    s_cmp_eq_u32 s25, 0
    s_cbranch_scc1 L1_sum5
L1_r5:
    s_cmp_lg_u32 s26, 0
    s_cbranch_scc1 L1_g5
    s_mov_b32 exec_lo, s25
    s_mov_b32 exec_hi, 0
    buffer_load_dword v30, v100, s[48:51], s17 offen sc1
    s_mov_b64 exec, -1
    s_add_u32 s22, s22, 1
    s_cmp_gt_u32 s22, 131072
    s_cbranch_scc1 L1_sum5
    s_waitcnt vmcnt(0)
    v_sub_u32 v30, v30, v32
    s_nop 1
    v_cmp_ge_u32 vcc, 7, v30
    s_nop 1
    s_and_b32 s26, vcc_lo, s25
    s_nop 1
    s_branch L1_r5
L1_g5:
    s_ff1_i32_b32 s27, s26
    s_bitset0_b32 s26, s27
    s_bitset0_b32 s25, s27
    s_min_u32 s27, s27, 255
    s_mul_i32 s27, s27, 1835008
    s_add_u32 s27, s27, s19
    buffer_load_dwordx4 v[168:171], v97, s[48:51], s27 offen offset:0 sc1
    buffer_load_dwordx4 v[172:175], v97, s[48:51], s27 offen offset:1024 sc1
    s_cmp_eq_u32 s25, 0
    s_cbranch_scc1 L1_sum6
L1_r6:
    s_cmp_lg_u32 s26, 0
    s_cbranch_scc1 L1_g6
    s_mov_b32 exec_lo, s25
    s_mov_b32 exec_hi, 0
    buffer_load_dword v30, v100, s[48:51], s17 offen sc1
    s_mov_b64 exec, -1
    s_add_u32 s22, s22, 1
    s_cmp_gt_u32 s22, 131072
    s_cbranch_scc1 L1_sum6
    s_waitcnt vmcnt(0)
    v_sub_u32 v30, v30, v32
    s_nop 1
    v_cmp_ge_u32 vcc, 7, v30
    s_nop 1
    s_and_b32 s26, vcc_lo, s25
    s_nop 1
    s_branch L1_r6
L1_g6:
    s_ff1_i32_b32 s27, s26
    s_bitset0_b32 s26, s27
    s_bitset0_b32 s25, s27
    s_min_u32 s27, s27, 255
    s_mul_i32 s27, s27, 1835008
    s_add_u32 s27, s27, s19
    buffer_load_dwordx4 v[176:179], v97, s[48:51], s27 offen offset:0 sc1
    buffer_load_dwordx4 v[180:183], v97, s[48:51], s27 offen offset:1024 sc1
    s_cmp_eq_u32 s25, 0
    s_cbranch_scc1 L1_sum7
L1_r7:
    s_cmp_lg_u32 s26, 0
    s_cbranch_scc1 L1_g7
    s_mov_b32 exec_lo, s25
    s_mov_b32 exec_hi, 0
    buffer_load_dword v30, v100, s[48:51], s17 offen sc1
    s_mov_b64 exec, -1
    s_add_u32 s22, s22, 1
    s_cmp_gt_u32 s22, 131072
    s_cbranch_scc1 L1_sum7
    s_waitcnt vmcnt(0)
    v_sub_u32 v30, v30, v32
    s_nop 1
    v_cmp_ge_u32 vcc, 7, v30
    s_nop 1
    s_and_b32 s26, vcc_lo, s25
    s_nop 1
    s_branch L1_r7
L1_g7:
    s_ff1_i32_b32 s27, s26
    s_bitset0_b32 s26, s27
    s_bitset0_b32 s25, s27
    s_min_u32 s27, s27, 255
    s_mul_i32 s27, s27, 1835008
    s_add_u32 s27, s27, s19
    buffer_load_dwordx4 v[184:187], v97, s[48:51], s27 offen offset:0 sc1
    buffer_load_dwordx4 v[188:191], v97, s[48:51], s27 offen offset:1024 sc1
    s_cmp_eq_u32 s25, 0
    s_cbranch_scc1 L1_sum8
L1_r8:
    s_cmp_lg_u32 s26, 0
    s_cbranch_scc1 L1_g8
    s_mov_b32 exec_lo, s25
    s_mov_b32 exec_hi, 0
    buffer_load_dword v30, v100, s[48:51], s17 offen sc1
    s_mov_b64 exec, -1
    s_add_u32 s22, s22, 1
    s_cmp_gt_u32 s22, 131072
    s_cbranch_scc1 L1_sum8
    s_waitcnt vmcnt(0)
    v_sub_u32 v30, v30, v32
    s_nop 1
    v_cmp_ge_u32 vcc, 7, v30
    s_nop 1
    s_and_b32 s26, vcc_lo, s25
    s_nop 1
    s_branch L1_r8
L1_g8:
    s_ff1_i32_b32 s27, s26
    s_bitset0_b32 s26, s27
    s_bitset0_b32 s25, s27
    s_min_u32 s27, s27, 255
    s_mul_i32 s27, s27, 1835008
    s_add_u32 s27, s27, s19
    buffer_load_dwordx4 v[192:195], v97, s[48:51], s27 offen offset:0 sc1
    buffer_load_dwordx4 v[196:199], v97, s[48:51], s27 offen offset:1024 sc1
    s_cmp_eq_u32 s25, 0
    s_cbranch_scc1 L1_sum9
L1_r9:
    s_cmp_lg_u32 s26, 0
    s_cbranch_scc1 L1_g9
    s_mov_b32 exec_lo, s25
    s_mov_b32 exec_hi, 0
    buffer_load_dword v30, v100, s[48:51], s17 offen sc1
    s_mov_b64 exec, -1
    s_add_u32 s22, s22, 1
    s_cmp_gt_u32 s22, 131072
    s_cbranch_scc1 L1_sum9
    s_waitcnt vmcnt(0)
    v_sub_u32 v30, v30, v32
    s_nop 1
    v_cmp_ge_u32 vcc, 7, v30
    s_nop 1
    s_and_b32 s26, vcc_lo, s25
    s_nop 1
    s_branch L1_r9
L1_g9:
    s_ff1_i32_b32 s27, s26
    s_bitset0_b32 s26, s27
    s_bitset0_b32 s25, s27
    s_min_u32 s27, s27, 255
    s_mul_i32 s27, s27, 1835008
    s_add_u32 s27, s27, s19
    buffer_load_dwordx4 v[200:203], v97, s[48:51], s27 offen offset:0 sc1
    buffer_load_dwordx4 v[204:207], v97, s[48:51], s27 offen offset:1024 sc1
    s_cmp_eq_u32 s25, 0
    s_cbranch_scc1 L1_sum10
L1_r10:
    s_cmp_lg_u32 s26, 0
    s_cbranch_scc1 L1_g10
    s_mov_b32 exec_lo, s25
    s_mov_b32 exec_hi, 0
    buffer_load_dword v30, v100, s[48:51], s17 offen sc1
    s_mov_b64 exec, -1
    s_add_u32 s22, s22, 1
    s_cmp_gt_u32 s22, 131072
    s_cbranch_scc1 L1_sum10
    s_waitcnt vmcnt(0)
    v_sub_u32 v30, v30, v32
    s_nop 1
    v_cmp_ge_u32 vcc, 7, v30
    s_nop 1
    s_and_b32 s26, vcc_lo, s25
    s_nop 1
    s_branch L1_r10
L1_g10:
    s_ff1_i32_b32 s27, s26
    s_bitset0_b32 s26, s27
    s_bitset0_b32 s25, s27
    s_min_u32 s27, s27, 255
    s_mul_i32 s27, s27, 1835008
    s_add_u32 s27, s27, s19
    buffer_load_dwordx4 v[208:211], v97, s[48:51], s27 offen offset:0 sc1
    buffer_load_dwordx4 v[212:215], v97, s[48:51], s27 offen offset:1024 sc1
    s_cmp_eq_u32 s25, 0
    s_cbranch_scc1 L1_sum11
L1_r11:
    s_cmp_lg_u32 s26, 0
    s_cbranch_scc1 L1_g11
    s_mov_b32 exec_lo, s25
    s_mov_b32 exec_hi, 0
    buffer_load_dword v30, v100, s[48:51], s17 offen sc1
    s_mov_b64 exec, -1
    s_add_u32 s22, s22, 1
    s_cmp_gt_u32 s22, 131072
    s_cbranch_scc1 L1_sum11
    s_waitcnt vmcnt(0)
    v_sub_u32 v30, v30, v32
    s_nop 1
    v_cmp_ge_u32 vcc, 7, v30
    s_nop 1
    s_and_b32 s26, vcc_lo, s25
    s_nop 1
    s_branch L1_r11
L1_g11:
    s_ff1_i32_b32 s27, s26
    s_bitset0_b32 s26, s27
    s_bitset0_b32 s25, s27
    s_min_u32 s27, s27, 255
    s_mul_i32 s27, s27, 1835008
    s_add_u32 s27, s27, s19
    buffer_load_dwordx4 v[216:219], v97, s[48:51], s27 offen offset:0 sc1
    buffer_load_dwordx4 v[220:223], v97, s[48:51], s27 offen offset:1024 sc1
    s_cmp_eq_u32 s25, 0
    s_cbranch_scc1 L1_sum12
L1_r12:
    s_cmp_lg_u32 s26, 0
    s_cbranch_scc1 L1_g12
    s_mov_b32 exec_lo, s25
    s_mov_b32 exec_hi, 0
    buffer_load_dword v30, v100, s[48:51], s17 offen sc1
    s_mov_b64 exec, -1
    s_add_u32 s22, s22, 1
    s_cmp_gt_u32 s22, 131072
    s_cbranch_scc1 L1_sum12
    s_waitcnt vmcnt(0)
    v_sub_u32 v30, v30, v32
    s_nop 1
    v_cmp_ge_u32 vcc, 7, v30
    s_nop 1
    s_and_b32 s26, vcc_lo, s25
    s_nop 1
    s_branch L1_r12
L1_g12:
    s_ff1_i32_b32 s27, s26
    s_bitset0_b32 s26, s27
    s_bitset0_b32 s25, s27
    s_min_u32 s27, s27, 255
    s_mul_i32 s27, s27, 1835008
    s_add_u32 s27, s27, s19
    buffer_load_dwordx4 v[224:227], v97, s[48:51], s27 offen offset:0 sc1
    buffer_load_dwordx4 v[228:231], v97, s[48:51], s27 offen offset:1024 sc1
    s_cmp_eq_u32 s25, 0
    s_cbranch_scc1 L1_sum13
L1_r13:
    s_cmp_lg_u32 s26, 0
    s_cbranch_scc1 L1_g13
    s_mov_b32 exec_lo, s25
    s_mov_b32 exec_hi, 0
    buffer_load_dword v30, v100, s[48:51], s17 offen sc1
    s_mov_b64 exec, -1
    s_add_u32 s22, s22, 1
    s_cmp_gt_u32 s22, 131072
    s_cbranch_scc1 L1_sum13
    s_waitcnt vmcnt(0)
    v_sub_u32 v30, v30, v32
    s_nop 1
    v_cmp_ge_u32 vcc, 7, v30
    s_nop 1
    s_and_b32 s26, vcc_lo, s25
    s_nop 1
    s_branch L1_r13
L1_g13:
    s_ff1_i32_b32 s27, s26
    s_bitset0_b32 s26, s27
    s_bitset0_b32 s25, s27
    s_min_u32 s27, s27, 255
    s_mul_i32 s27, s27, 1835008
    s_add_u32 s27, s27, s19
    buffer_load_dwordx4 v[232:235], v97, s[48:51], s27 offen offset:0 sc1
    buffer_load_dwordx4 v[236:239], v97, s[48:51], s27 offen offset:1024 sc1
    s_cmp_eq_u32 s25, 0
    s_cbranch_scc1 L1_sum14
L1_r14:
    s_cmp_lg_u32 s26, 0
    s_cbranch_scc1 L1_g14
    s_mov_b32 exec_lo, s25
    s_mov_b32 exec_hi, 0
    buffer_load_dword v30, v100, s[48:51], s17 offen sc1
    s_mov_b64 exec, -1
    s_add_u32 s22, s22, 1
    s_cmp_gt_u32 s22, 131072
    s_cbranch_scc1 L1_sum14
    s_waitcnt vmcnt(0)
    v_sub_u32 v30, v30, v32
    s_nop 1
    v_cmp_ge_u32 vcc, 7, v30
    s_nop 1
    s_and_b32 s26, vcc_lo, s25
    s_nop 1
    s_branch L1_r14
L1_g14:
    s_ff1_i32_b32 s27, s26
    s_bitset0_b32 s26, s27
    s_bitset0_b32 s25, s27
    s_min_u32 s27, s27, 255
    s_mul_i32 s27, s27, 1835008
    s_add_u32 s27, s27, s19
    buffer_load_dwordx4 v[240:243], v97, s[48:51], s27 offen offset:0 sc1
    buffer_load_dwordx4 v[244:247], v97, s[48:51], s27 offen offset:1024 sc1
    s_cmp_eq_u32 s25, 0
    s_cbranch_scc1 L1_sum15
L1_r15:
    s_cmp_lg_u32 s26, 0
    s_cbranch_scc1 L1_g15
    s_mov_b32 exec_lo, s25
    s_mov_b32 exec_hi, 0
    buffer_load_dword v30, v100, s[48:51], s17 offen sc1
    s_mov_b64 exec, -1
    s_add_u32 s22, s22, 1
    s_cmp_gt_u32 s22, 131072
    s_cbranch_scc1 L1_sum15
    s_waitcnt vmcnt(0)
    v_sub_u32 v30, v30, v32
    s_nop 1
    v_cmp_ge_u32 vcc, 7, v30
    s_nop 1
    s_and_b32 s26, vcc_lo, s25
    s_nop 1
    s_branch L1_r15
L1_g15:
    s_ff1_i32_b32 s27, s26
    s_bitset0_b32 s26, s27
    s_bitset0_b32 s25, s27
    s_min_u32 s27, s27, 255
    s_mul_i32 s27, s27, 1835008
    s_add_u32 s27, s27, s19
    buffer_load_dwordx4 v[248:251], v97, s[48:51], s27 offen offset:0 sc1
    buffer_load_dwordx4 v[252:255], v97, s[48:51], s27 offen offset:1024 sc1
L1_sum16:
    s_waitcnt vmcnt(0)
    v_mfma_f32_32x32x16_bf16 v[36:51], v[52:55], v[248:251], v[36:51]
    v_mfma_f32_32x32x16_bf16 v[36:51], v[56:59], v[252:255], v[36:51]
L1_sum15:
    s_waitcnt vmcnt(0)
    v_mfma_f32_32x32x16_bf16 v[36:51], v[52:55], v[240:243], v[36:51]
    v_mfma_f32_32x32x16_bf16 v[36:51], v[56:59], v[244:247], v[36:51]
L1_sum14:
    s_waitcnt vmcnt(0)
    v_mfma_f32_32x32x16_bf16 v[36:51], v[52:55], v[232:235], v[36:51]
    v_mfma_f32_32x32x16_bf16 v[36:51], v[56:59], v[236:239], v[36:51]
L1_sum13:
    s_waitcnt vmcnt(0)
    v_mfma_f32_32x32x16_bf16 v[36:51], v[52:55], v[224:227], v[36:51]
    v_mfma_f32_32x32x16_bf16 v[36:51], v[56:59], v[228:231], v[36:51]
L1_sum12:
    s_waitcnt vmcnt(0)
    v_mfma_f32_32x32x16_bf16 v[36:51], v[52:55], v[216:219], v[36:51]
    v_mfma_f32_32x32x16_bf16 v[36:51], v[56:59], v[220:223], v[36:51]
L1_sum11:
    s_waitcnt vmcnt(0)
    v_mfma_f32_32x32x16_bf16 v[36:51], v[52:55], v[208:211], v[36:51]
    v_mfma_f32_32x32x16_bf16 v[36:51], v[56:59], v[212:215], v[36:51]
L1_sum10:
    s_waitcnt vmcnt(0)
    v_mfma_f32_32x32x16_bf16 v[36:51], v[52:55], v[200:203], v[36:51]
    v_mfma_f32_32x32x16_bf16 v[36:51], v[56:59], v[204:207], v[36:51]
L1_sum9:
    s_waitcnt vmcnt(0)
    v_mfma_f32_32x32x16_bf16 v[36:51], v[52:55], v[192:195], v[36:51]
    v_mfma_f32_32x32x16_bf16 v[36:51], v[56:59], v[196:199], v[36:51]
L1_sum8:
    s_waitcnt vmcnt(0)
    v_mfma_f32_32x32x16_bf16 v[36:51], v[52:55], v[184:187], v[36:51]
    v_mfma_f32_32x32x16_bf16 v[36:51], v[56:59], v[188:191], v[36:51]
L1_sum7:
    s_waitcnt vmcnt(0)
    v_mfma_f32_32x32x16_bf16 v[36:51], v[52:55], v[176:179], v[36:51]
    v_mfma_f32_32x32x16_bf16 v[36:51], v[56:59], v[180:183], v[36:51]
L1_sum6:
    s_waitcnt vmcnt(0)
    v_mfma_f32_32x32x16_bf16 v[36:51], v[52:55], v[168:171], v[36:51]
    v_mfma_f32_32x32x16_bf16 v[36:51], v[56:59], v[172:175], v[36:51]
L1_sum5:
    s_waitcnt vmcnt(0)
    v_mfma_f32_32x32x16_bf16 v[36:51], v[52:55], v[160:163], v[36:51]
    v_mfma_f32_32x32x16_bf16 v[36:51], v[56:59], v[164:167], v[36:51]
L1_sum4:
    s_waitcnt vmcnt(0)
    v_mfma_f32_32x32x16_bf16 v[36:51], v[52:55], v[152:155], v[36:51]
    v_mfma_f32_32x32x16_bf16 v[36:51], v[56:59], v[156:159], v[36:51]
L1_sum3:
    s_waitcnt vmcnt(0)
    v_mfma_f32_32x32x16_bf16 v[36:51], v[52:55], v[144:147], v[36:51]
    v_mfma_f32_32x32x16_bf16 v[36:51], v[56:59], v[148:151], v[36:51]
L1_sum2:
    s_waitcnt vmcnt(0)
    v_mfma_f32_32x32x16_bf16 v[36:51], v[52:55], v[136:139], v[36:51]
    v_mfma_f32_32x32x16_bf16 v[36:51], v[56:59], v[140:143], v[36:51]
L1_sum1:
    s_waitcnt vmcnt(0)
    v_mfma_f32_32x32x16_bf16 v[36:51], v[52:55], v[128:131], v[36:51]
    v_mfma_f32_32x32x16_bf16 v[36:51], v[56:59], v[132:135], v[36:51]
L1_sum0:
    s_nop 15
    v_fma_f32 v0, v76, v36, v0
    v_fma_f32 v1, v77, v37, v1
    v_fma_f32 v2, v78, v38, v2
    v_fma_f32 v3, v79, v39, v3
    v_fma_f32 v4, v80, v40, v4
    v_fma_f32 v5, v81, v41, v5
    v_fma_f32 v6, v82, v42, v6
    v_fma_f32 v7, v83, v43, v7
    v_fma_f32 v8, v84, v44, v8
    v_fma_f32 v9, v85, v45, v9
    v_fma_f32 v10, v86, v46, v10
    v_fma_f32 v11, v87, v47, v11
    v_fma_f32 v12, v88, v48, v12
    v_fma_f32 v13, v89, v49, v13
    v_fma_f32 v14, v90, v50, v14
    v_fma_f32 v15, v91, v51, v15
    v_cvt_pk_bf16_f32 v112, v0, v1
    v_cvt_pk_bf16_f32 v113, v2, v3
    v_cvt_pk_bf16_f32 v114, v4, v5
    v_cvt_pk_bf16_f32 v115, v6, v7
    v_cvt_pk_bf16_f32 v116, v8, v9
    v_cvt_pk_bf16_f32 v117, v10, v11
    v_cvt_pk_bf16_f32 v118, v12, v13
    v_cvt_pk_bf16_f32 v119, v14, v15
    buffer_store_dwordx4 v[112:115], v101, s[8:11], s20 offen
    buffer_store_dwordx4 v[116:119], v101, s[8:11], s20 offen offset:16
L1_end:
    s_endpgm
L1_noty:
    s_nop 15
    v_mul_f32 v192, v192, v102
    v_mul_f32 v193, v193, v102
    v_cvt_pk_bf16_f32 v112, v192, v193
    v_mul_f32 v194, v194, v102
    v_mul_f32 v195, v195, v102
    v_cvt_pk_bf16_f32 v113, v194, v195
    v_mul_f32 v196, v196, v102
    v_mul_f32 v197, v197, v102
    v_cvt_pk_bf16_f32 v114, v196, v197
    v_mul_f32 v198, v198, v102
    v_mul_f32 v199, v199, v102
    v_cvt_pk_bf16_f32 v115, v198, v199
    buffer_store_dwordx4 v[112:115], v97, s[48:51], s68 offen offset:0 sc1
    v_mul_f32 v200, v200, v102
    v_mul_f32 v201, v201, v102
    v_cvt_pk_bf16_f32 v116, v200, v201
    v_mul_f32 v202, v202, v102
    v_mul_f32 v203, v203, v102
    v_cvt_pk_bf16_f32 v117, v202, v203
    v_mul_f32 v204, v204, v102
    v_mul_f32 v205, v205, v102
    v_cvt_pk_bf16_f32 v118, v204, v205
    v_mul_f32 v206, v206, v102
    v_mul_f32 v207, v207, v102
    v_cvt_pk_bf16_f32 v119, v206, v207
    buffer_store_dwordx4 v[116:119], v97, s[48:51], s68 offen offset:1024 sc1
    v_mul_f32 v208, v208, v102
    v_mul_f32 v209, v209, v102
    v_cvt_pk_bf16_f32 v120, v208, v209
    v_mul_f32 v210, v210, v102
    v_mul_f32 v211, v211, v102
    v_cvt_pk_bf16_f32 v121, v210, v211
    v_mul_f32 v212, v212, v102
    v_mul_f32 v213, v213, v102
    v_cvt_pk_bf16_f32 v122, v212, v213
    v_mul_f32 v214, v214, v102
    v_mul_f32 v215, v215, v102
    v_cvt_pk_bf16_f32 v123, v214, v215
    buffer_store_dwordx4 v[120:123], v97, s[48:51], s68 offen offset:2048 sc1
    v_mul_f32 v216, v216, v102
    v_mul_f32 v217, v217, v102
    v_cvt_pk_bf16_f32 v124, v216, v217
    v_mul_f32 v218, v218, v102
    v_mul_f32 v219, v219, v102
    v_cvt_pk_bf16_f32 v125, v218, v219
    v_mul_f32 v220, v220, v102
    v_mul_f32 v221, v221, v102
    v_cvt_pk_bf16_f32 v126, v220, v221
    v_mul_f32 v222, v222, v102
    v_mul_f32 v223, v223, v102
    v_cvt_pk_bf16_f32 v127, v222, v223
    buffer_store_dwordx4 v[124:127], v97, s[48:51], s68 offen offset:3072 sc1
    v_add_u32 v28, 2, v28
    s_waitcnt vmcnt(0) lgkmcnt(0)
    buffer_store_dword v28, v99, s[48:51], s16 offen sc1
    s_endpgm
L1_spn:
    s_mov_b32 s22, 0
L1_spn_l:
    buffer_load_dword v28, v29, s[4:7], 0 offen sc1
    s_add_u32 s22, s22, 1
    s_cmp_gt_u32 s22, 131072
    s_cbranch_scc1 L1_spn_b
    s_waitcnt vmcnt(0)
    v_cmp_eq_u32 vcc, 0, v28
    s_nop 1
    s_cbranch_vccnz L1_spn_l
    s_branch L1_spn_b
L1_sph:
    s_cmp_lt_u32 s12, 4
    s_cbranch_scc1 L1_sph_b
    s_mov_b32 s22, 0
L1_sph_l:
    buffer_load_dword v29, v100, s[48:51], s17 offen sc1
    s_add_u32 s22, s22, 1
    s_cmp_gt_u32 s22, 131072
    s_cbranch_scc1 L1_sph_b
    s_waitcnt vmcnt(0)
    v_cmp_ne_u32 vcc, v29, v28
    s_nop 1
    s_cbranch_vccnz L1_sph_l
    s_branch L1_sph_b
L1_tr1:
    s_mov_b32 s67, 1
    s_branch L1_rare1
L1_tr2:
    s_mov_b32 s67, 2
    s_branch L1_rare0
L1_tr3:
    s_mov_b32 s67, 3
    s_branch L1_rare1
L1_tr4:
    s_mov_b32 s67, 4
    s_branch L1_rare0
L1_tr5:
    s_mov_b32 s67, 5
    s_branch L1_rare1
L1_tr6:
    s_mov_b32 s67, 6
    s_branch L1_rare0
L1_tr7:
    s_mov_b32 s67, 7
    s_branch L1_rare1
L1_tr8:
    s_mov_b32 s67, 8
    s_branch L1_rare0
L1_tr9:
    s_mov_b32 s67, 9
    s_branch L1_rare1
L1_tr10:
    s_mov_b32 s67, 10
    s_branch L1_rare0
L1_tr11:
    s_mov_b32 s67, 11
    s_branch L1_rare1
L1_tr12:
    s_mov_b32 s67, 12
    s_branch L1_rare0
L1_tr13:
    s_mov_b32 s67, 13
    s_branch L1_rare1
L1_tr14:
    s_mov_b32 s67, 14
    s_branch L1_rare0
L1_tr15:
    s_mov_b32 s67, 15
    s_branch L1_rare1
L1_rare0:
    s_nop 15
    v_mov_b32 v107, v108
    s_nop 1
    v_permlane32_swap_b32 v108, v107
    v_max3_f32 v108, v108, v107, 0
    v_exp_f32 v107, -v108
    v_sub_f32 v192, v192, v108
    v_sub_f32 v112, v112, v108
    v_sub_f32 v193, v193, v108
    v_sub_f32 v113, v113, v108
    v_sub_f32 v194, v194, v108
    v_sub_f32 v114, v114, v108
    v_sub_f32 v195, v195, v108
    v_sub_f32 v115, v115, v108
    v_sub_f32 v196, v196, v108
    v_sub_f32 v116, v116, v108
    v_sub_f32 v197, v197, v108
    v_sub_f32 v117, v117, v108
    v_sub_f32 v198, v198, v108
    v_sub_f32 v118, v118, v108
    v_sub_f32 v199, v199, v108
    v_sub_f32 v119, v119, v108
    v_sub_f32 v200, v200, v108
    v_sub_f32 v120, v120, v108
    v_sub_f32 v201, v201, v108
    v_sub_f32 v121, v121, v108
    v_sub_f32 v202, v202, v108
    v_sub_f32 v122, v122, v108
    v_sub_f32 v203, v203, v108
    v_sub_f32 v123, v123, v108
    v_sub_f32 v204, v204, v108
    v_sub_f32 v124, v124, v108
    v_sub_f32 v205, v205, v108
    v_sub_f32 v125, v125, v108
    v_sub_f32 v206, v206, v108
    v_sub_f32 v126, v126, v108
    v_sub_f32 v207, v207, v108
    v_sub_f32 v127, v127, v108
    v_mul_f32 v98, v98, v107
    v_accvgpr_read_b32 v103, a0
    v_mul_f32 v103, v103, v107
    v_accvgpr_write_b32 a0, v103
    v_accvgpr_read_b32 v104, a1
    v_mul_f32 v104, v104, v107
    v_accvgpr_write_b32 a1, v104
    v_accvgpr_read_b32 v103, a2
    v_mul_f32 v103, v103, v107
    v_accvgpr_write_b32 a2, v103
    v_accvgpr_read_b32 v104, a3
    v_mul_f32 v104, v104, v107
    v_accvgpr_write_b32 a3, v104
    v_accvgpr_read_b32 v103, a4
    v_mul_f32 v103, v103, v107
    v_accvgpr_write_b32 a4, v103
    v_accvgpr_read_b32 v104, a5
    v_mul_f32 v104, v104, v107
    v_accvgpr_write_b32 a5, v104
    v_accvgpr_read_b32 v103, a6
    v_mul_f32 v103, v103, v107
    v_accvgpr_write_b32 a6, v103
    v_accvgpr_read_b32 v104, a7
    v_mul_f32 v104, v104, v107
    v_accvgpr_write_b32 a7, v104
    v_accvgpr_read_b32 v103, a8
    v_mul_f32 v103, v103, v107
    v_accvgpr_write_b32 a8, v103
    v_accvgpr_read_b32 v104, a9
    v_mul_f32 v104, v104, v107
    v_accvgpr_write_b32 a9, v104
    v_accvgpr_read_b32 v103, a10
    v_mul_f32 v103, v103, v107
    v_accvgpr_write_b32 a10, v103
    v_accvgpr_read_b32 v104, a11
    v_mul_f32 v104, v104, v107
    v_accvgpr_write_b32 a11, v104
    v_accvgpr_read_b32 v103, a12
    v_mul_f32 v103, v103, v107
    v_accvgpr_write_b32 a12, v103
    v_accvgpr_read_b32 v104, a13
    v_mul_f32 v104, v104, v107
    v_accvgpr_write_b32 a13, v104
    v_accvgpr_read_b32 v103, a14
    v_mul_f32 v103, v103, v107
    v_accvgpr_write_b32 a14, v103
    v_accvgpr_read_b32 v104, a15
    v_mul_f32 v104, v104, v107
    v_accvgpr_write_b32 a15, v104
    v_accvgpr_read_b32 v103, a16
    v_mul_f32 v103, v103, v107
    v_accvgpr_write_b32 a16, v103
    v_accvgpr_read_b32 v104, a17
    v_mul_f32 v104, v104, v107
    v_accvgpr_write_b32 a17, v104
    v_accvgpr_read_b32 v103, a18
    v_mul_f32 v103, v103, v107
    v_accvgpr_write_b32 a18, v103
    v_accvgpr_read_b32 v104, a19
    v_mul_f32 v104, v104, v107
    v_accvgpr_write_b32 a19, v104
    v_accvgpr_read_b32 v103, a20
    v_mul_f32 v103, v103, v107
    v_accvgpr_write_b32 a20, v103
    v_accvgpr_read_b32 v104, a21
    v_mul_f32 v104, v104, v107
    v_accvgpr_write_b32 a21, v104
    v_accvgpr_read_b32 v103, a22
    v_mul_f32 v103, v103, v107
    v_accvgpr_write_b32 a22, v103
    v_accvgpr_read_b32 v104, a23
    v_mul_f32 v104, v104, v107
    v_accvgpr_write_b32 a23, v104
    v_accvgpr_read_b32 v103, a24
    v_mul_f32 v103, v103, v107
    v_accvgpr_write_b32 a24, v103
    v_accvgpr_read_b32 v104, a25
    v_mul_f32 v104, v104, v107
    v_accvgpr_write_b32 a25, v104
    v_accvgpr_read_b32 v103, a26
    v_mul_f32 v103, v103, v107
    v_accvgpr_write_b32 a26, v103
    v_accvgpr_read_b32 v104, a27
    v_mul_f32 v104, v104, v107
    v_accvgpr_write_b32 a27, v104
    v_accvgpr_read_b32 v103, a28
    v_mul_f32 v103, v103, v107
    v_accvgpr_write_b32 a28, v103
    v_accvgpr_read_b32 v104, a29
    v_mul_f32 v104, v104, v107
    v_accvgpr_write_b32 a29, v104
    v_accvgpr_read_b32 v103, a30
    v_mul_f32 v103, v103, v107
    v_accvgpr_write_b32 a30, v103
    v_accvgpr_read_b32 v104, a31
    v_mul_f32 v104, v104, v107
    v_accvgpr_write_b32 a31, v104
    v_accvgpr_read_b32 v103, a32
    v_mul_f32 v103, v103, v107
    v_accvgpr_write_b32 a32, v103
    v_accvgpr_read_b32 v104, a33
    v_mul_f32 v104, v104, v107
    v_accvgpr_write_b32 a33, v104
    v_accvgpr_read_b32 v103, a34
    v_mul_f32 v103, v103, v107
    v_accvgpr_write_b32 a34, v103
    v_accvgpr_read_b32 v104, a35
    v_mul_f32 v104, v104, v107
    v_accvgpr_write_b32 a35, v104
    v_accvgpr_read_b32 v103, a36
    v_mul_f32 v103, v103, v107
    v_accvgpr_write_b32 a36, v103
    v_accvgpr_read_b32 v104, a37
    v_mul_f32 v104, v104, v107
    v_accvgpr_write_b32 a37, v104
    v_accvgpr_read_b32 v103, a38
    v_mul_f32 v103, v103, v107
    v_accvgpr_write_b32 a38, v103
    v_accvgpr_read_b32 v104, a39
    v_mul_f32 v104, v104, v107
    v_accvgpr_write_b32 a39, v104
    v_accvgpr_read_b32 v103, a40
    v_mul_f32 v103, v103, v107
    v_accvgpr_write_b32 a40, v103
    v_accvgpr_read_b32 v104, a41
    v_mul_f32 v104, v104, v107
    v_accvgpr_write_b32 a41, v104
    v_accvgpr_read_b32 v103, a42
    v_mul_f32 v103, v103, v107
    v_accvgpr_write_b32 a42, v103
    v_accvgpr_read_b32 v104, a43
    v_mul_f32 v104, v104, v107
    v_accvgpr_write_b32 a43, v104
    v_accvgpr_read_b32 v103, a44
    v_mul_f32 v103, v103, v107
    v_accvgpr_write_b32 a44, v103
    v_accvgpr_read_b32 v104, a45
    v_mul_f32 v104, v104, v107
    v_accvgpr_write_b32 a45, v104
    v_accvgpr_read_b32 v103, a46
    v_mul_f32 v103, v103, v107
    v_accvgpr_write_b32 a46, v103
    v_accvgpr_read_b32 v104, a47
    v_mul_f32 v104, v104, v107
    v_accvgpr_write_b32 a47, v104
    v_accvgpr_read_b32 v103, a48
    v_mul_f32 v103, v103, v107
    v_accvgpr_write_b32 a48, v103
    v_accvgpr_read_b32 v104, a49
    v_mul_f32 v104, v104, v107
    v_accvgpr_write_b32 a49, v104
    v_accvgpr_read_b32 v103, a50
    v_mul_f32 v103, v103, v107
    v_accvgpr_write_b32 a50, v103
    v_accvgpr_read_b32 v104, a51
    v_mul_f32 v104, v104, v107
    v_accvgpr_write_b32 a51, v104
    v_accvgpr_read_b32 v103, a52
    v_mul_f32 v103, v103, v107
    v_accvgpr_write_b32 a52, v103
    v_accvgpr_read_b32 v104, a53
    v_mul_f32 v104, v104, v107
    v_accvgpr_write_b32 a53, v104
    v_accvgpr_read_b32 v103, a54
    v_mul_f32 v103, v103, v107
    v_accvgpr_write_b32 a54, v103
    v_accvgpr_read_b32 v104, a55
    v_mul_f32 v104, v104, v107
    v_accvgpr_write_b32 a55, v104
    v_accvgpr_read_b32 v103, a56
    v_mul_f32 v103, v103, v107
    v_accvgpr_write_b32 a56, v103
    v_accvgpr_read_b32 v104, a57
    v_mul_f32 v104, v104, v107
    v_accvgpr_write_b32 a57, v104
    v_accvgpr_read_b32 v103, a58
    v_mul_f32 v103, v103, v107
    v_accvgpr_write_b32 a58, v103
    v_accvgpr_read_b32 v104, a59
    v_mul_f32 v104, v104, v107
    v_accvgpr_write_b32 a59, v104
    v_accvgpr_read_b32 v103, a60
    v_mul_f32 v103, v103, v107
    v_accvgpr_write_b32 a60, v103
    v_accvgpr_read_b32 v104, a61
    v_mul_f32 v104, v104, v107
    v_accvgpr_write_b32 a61, v104
    v_accvgpr_read_b32 v103, a62
    v_mul_f32 v103, v103, v107
    v_accvgpr_write_b32 a62, v103
    v_accvgpr_read_b32 v104, a63
    v_mul_f32 v104, v104, v107
    v_accvgpr_write_b32 a63, v104
    v_accvgpr_read_b32 v103, a64
    v_mul_f32 v103, v103, v107
    v_accvgpr_write_b32 a64, v103
    v_accvgpr_read_b32 v104, a65
    v_mul_f32 v104, v104, v107
    v_accvgpr_write_b32 a65, v104
    v_accvgpr_read_b32 v103, a66
    v_mul_f32 v103, v103, v107
    v_accvgpr_write_b32 a66, v103
    v_accvgpr_read_b32 v104, a67
    v_mul_f32 v104, v104, v107
    v_accvgpr_write_b32 a67, v104
    v_accvgpr_read_b32 v103, a68
    v_mul_f32 v103, v103, v107
    v_accvgpr_write_b32 a68, v103
    v_accvgpr_read_b32 v104, a69
    v_mul_f32 v104, v104, v107
    v_accvgpr_write_b32 a69, v104
    v_accvgpr_read_b32 v103, a70
    v_mul_f32 v103, v103, v107
    v_accvgpr_write_b32 a70, v103
    v_accvgpr_read_b32 v104, a71
    v_mul_f32 v104, v104, v107
    v_accvgpr_write_b32 a71, v104
    v_accvgpr_read_b32 v103, a72
    v_mul_f32 v103, v103, v107
    v_accvgpr_write_b32 a72, v103
    v_accvgpr_read_b32 v104, a73
    v_mul_f32 v104, v104, v107
    v_accvgpr_write_b32 a73, v104
    v_accvgpr_read_b32 v103, a74
    v_mul_f32 v103, v103, v107
    v_accvgpr_write_b32 a74, v103
    v_accvgpr_read_b32 v104, a75
    v_mul_f32 v104, v104, v107
    v_accvgpr_write_b32 a75, v104
    v_accvgpr_read_b32 v103, a76
    v_mul_f32 v103, v103, v107
    v_accvgpr_write_b32 a76, v103
    v_accvgpr_read_b32 v104, a77
    v_mul_f32 v104, v104, v107
    v_accvgpr_write_b32 a77, v104
    v_accvgpr_read_b32 v103, a78
    v_mul_f32 v103, v103, v107
    v_accvgpr_write_b32 a78, v103
    v_accvgpr_read_b32 v104, a79
    v_mul_f32 v104, v104, v107
    v_accvgpr_write_b32 a79, v104
    v_accvgpr_read_b32 v103, a80
    v_mul_f32 v103, v103, v107
    v_accvgpr_write_b32 a80, v103
    v_accvgpr_read_b32 v104, a81
    v_mul_f32 v104, v104, v107
    v_accvgpr_write_b32 a81, v104
    v_accvgpr_read_b32 v103, a82
    v_mul_f32 v103, v103, v107
    v_accvgpr_write_b32 a82, v103
    v_accvgpr_read_b32 v104, a83
    v_mul_f32 v104, v104, v107
    v_accvgpr_write_b32 a83, v104
    v_accvgpr_read_b32 v103, a84
    v_mul_f32 v103, v103, v107
    v_accvgpr_write_b32 a84, v103
    v_accvgpr_read_b32 v104, a85
    v_mul_f32 v104, v104, v107
    v_accvgpr_write_b32 a85, v104
    v_accvgpr_read_b32 v103, a86
    v_mul_f32 v103, v103, v107
    v_accvgpr_write_b32 a86, v103
    v_accvgpr_read_b32 v104, a87
    v_mul_f32 v104, v104, v107
    v_accvgpr_write_b32 a87, v104
    v_accvgpr_read_b32 v103, a88
    v_mul_f32 v103, v103, v107
    v_accvgpr_write_b32 a88, v103
    v_accvgpr_read_b32 v104, a89
    v_mul_f32 v104, v104, v107
    v_accvgpr_write_b32 a89, v104
    v_accvgpr_read_b32 v103, a90
    v_mul_f32 v103, v103, v107
    v_accvgpr_write_b32 a90, v103
    v_accvgpr_read_b32 v104, a91
    v_mul_f32 v104, v104, v107
    v_accvgpr_write_b32 a91, v104
    v_accvgpr_read_b32 v103, a92
    v_mul_f32 v103, v103, v107
    v_accvgpr_write_b32 a92, v103
    v_accvgpr_read_b32 v104, a93
    v_mul_f32 v104, v104, v107
    v_accvgpr_write_b32 a93, v104
    v_accvgpr_read_b32 v103, a94
    v_mul_f32 v103, v103, v107
    v_accvgpr_write_b32 a94, v103
    v_accvgpr_read_b32 v104, a95
    v_mul_f32 v104, v104, v107
    v_accvgpr_write_b32 a95, v104
    v_accvgpr_read_b32 v103, a96
    v_mul_f32 v103, v103, v107
    v_accvgpr_write_b32 a96, v103
    v_accvgpr_read_b32 v104, a97
    v_mul_f32 v104, v104, v107
    v_accvgpr_write_b32 a97, v104
    v_accvgpr_read_b32 v103, a98
    v_mul_f32 v103, v103, v107
    v_accvgpr_write_b32 a98, v103
    v_accvgpr_read_b32 v104, a99
    v_mul_f32 v104, v104, v107
    v_accvgpr_write_b32 a99, v104
    v_accvgpr_read_b32 v103, a100
    v_mul_f32 v103, v103, v107
    v_accvgpr_write_b32 a100, v103
    v_accvgpr_read_b32 v104, a101
    v_mul_f32 v104, v104, v107
    v_accvgpr_write_b32 a101, v104
    v_accvgpr_read_b32 v103, a102
    v_mul_f32 v103, v103, v107
    v_accvgpr_write_b32 a102, v103
    v_accvgpr_read_b32 v104, a103
    v_mul_f32 v104, v104, v107
    v_accvgpr_write_b32 a103, v104
    v_accvgpr_read_b32 v103, a104
    v_mul_f32 v103, v103, v107
    v_accvgpr_write_b32 a104, v103
    v_accvgpr_read_b32 v104, a105
    v_mul_f32 v104, v104, v107
    v_accvgpr_write_b32 a105, v104
    v_accvgpr_read_b32 v103, a106
    v_mul_f32 v103, v103, v107
    v_accvgpr_write_b32 a106, v103
    v_accvgpr_read_b32 v104, a107
    v_mul_f32 v104, v104, v107
    v_accvgpr_write_b32 a107, v104
    v_accvgpr_read_b32 v103, a108
    v_mul_f32 v103, v103, v107
    v_accvgpr_write_b32 a108, v103
    v_accvgpr_read_b32 v104, a109
    v_mul_f32 v104, v104, v107
    v_accvgpr_write_b32 a109, v104
    v_accvgpr_read_b32 v103, a110
    v_mul_f32 v103, v103, v107
    v_accvgpr_write_b32 a110, v103
    v_accvgpr_read_b32 v104, a111
    v_mul_f32 v104, v104, v107
    v_accvgpr_write_b32 a111, v104
    v_accvgpr_read_b32 v103, a112
    v_mul_f32 v103, v103, v107
    v_accvgpr_write_b32 a112, v103
    v_accvgpr_read_b32 v104, a113
    v_mul_f32 v104, v104, v107
    v_accvgpr_write_b32 a113, v104
    v_accvgpr_read_b32 v103, a114
    v_mul_f32 v103, v103, v107
    v_accvgpr_write_b32 a114, v103
    v_accvgpr_read_b32 v104, a115
    v_mul_f32 v104, v104, v107
    v_accvgpr_write_b32 a115, v104
    v_accvgpr_read_b32 v103, a116
    v_mul_f32 v103, v103, v107
    v_accvgpr_write_b32 a116, v103
    v_accvgpr_read_b32 v104, a117
    v_mul_f32 v104, v104, v107
    v_accvgpr_write_b32 a117, v104
    v_accvgpr_read_b32 v103, a118
    v_mul_f32 v103, v103, v107
    v_accvgpr_write_b32 a118, v103
    v_accvgpr_read_b32 v104, a119
    v_mul_f32 v104, v104, v107
    v_accvgpr_write_b32 a119, v104
    v_accvgpr_read_b32 v103, a120
    v_mul_f32 v103, v103, v107
    v_accvgpr_write_b32 a120, v103
    v_accvgpr_read_b32 v104, a121
    v_mul_f32 v104, v104, v107
    v_accvgpr_write_b32 a121, v104
    v_accvgpr_read_b32 v103, a122
    v_mul_f32 v103, v103, v107
    v_accvgpr_write_b32 a122, v103
    v_accvgpr_read_b32 v104, a123
    v_mul_f32 v104, v104, v107
    v_accvgpr_write_b32 a123, v104
    v_accvgpr_read_b32 v103, a124
    v_mul_f32 v103, v103, v107
    v_accvgpr_write_b32 a124, v103
    v_accvgpr_read_b32 v104, a125
    v_mul_f32 v104, v104, v107
    v_accvgpr_write_b32 a125, v104
    v_accvgpr_read_b32 v103, a126
    v_mul_f32 v103, v103, v107
    v_accvgpr_write_b32 a126, v103
    v_accvgpr_read_b32 v104, a127
    v_mul_f32 v104, v104, v107
    v_accvgpr_write_b32 a127, v104
    s_nop 3
    s_cmp_eq_u32 s67, 2
    s_cbranch_scc1 L1_bk2
    s_cmp_eq_u32 s67, 4
    s_cbranch_scc1 L1_bk4
    s_cmp_eq_u32 s67, 6
    s_cbranch_scc1 L1_bk6
    s_cmp_eq_u32 s67, 8
    s_cbranch_scc1 L1_bk8
    s_cmp_eq_u32 s67, 10
    s_cbranch_scc1 L1_bk10
    s_cmp_eq_u32 s67, 12
    s_cbranch_scc1 L1_bk12
    s_branch L1_bk14
L1_rare1:
    s_nop 15
    v_mov_b32 v107, v108
    s_nop 1
    v_permlane32_swap_b32 v108, v107
    v_max3_f32 v108, v108, v107, 0
    v_exp_f32 v107, -v108
    v_sub_f32 v208, v208, v108
    v_sub_f32 v112, v112, v108
    v_sub_f32 v209, v209, v108
    v_sub_f32 v113, v113, v108
    v_sub_f32 v210, v210, v108
    v_sub_f32 v114, v114, v108
    v_sub_f32 v211, v211, v108
    v_sub_f32 v115, v115, v108
    v_sub_f32 v212, v212, v108
    v_sub_f32 v116, v116, v108
    v_sub_f32 v213, v213, v108
    v_sub_f32 v117, v117, v108
    v_sub_f32 v214, v214, v108
    v_sub_f32 v118, v118, v108
    v_sub_f32 v215, v215, v108
    v_sub_f32 v119, v119, v108
    v_sub_f32 v216, v216, v108
    v_sub_f32 v120, v120, v108
    v_sub_f32 v217, v217, v108
    v_sub_f32 v121, v121, v108
    v_sub_f32 v218, v218, v108
    v_sub_f32 v122, v122, v108
    v_sub_f32 v219, v219, v108
    v_sub_f32 v123, v123, v108
    v_sub_f32 v220, v220, v108
    v_sub_f32 v124, v124, v108
    v_sub_f32 v221, v221, v108
    v_sub_f32 v125, v125, v108
    v_sub_f32 v222, v222, v108
    v_sub_f32 v126, v126, v108
    v_sub_f32 v223, v223, v108
    v_sub_f32 v127, v127, v108
    v_mul_f32 v98, v98, v107
    v_accvgpr_read_b32 v103, a0
    v_mul_f32 v103, v103, v107
    v_accvgpr_write_b32 a0, v103
    v_accvgpr_read_b32 v104, a1
    v_mul_f32 v104, v104, v107
    v_accvgpr_write_b32 a1, v104
    v_accvgpr_read_b32 v103, a2
    v_mul_f32 v103, v103, v107
    v_accvgpr_write_b32 a2, v103
    v_accvgpr_read_b32 v104, a3
    v_mul_f32 v104, v104, v107
    v_accvgpr_write_b32 a3, v104
    v_accvgpr_read_b32 v103, a4
    v_mul_f32 v103, v103, v107
    v_accvgpr_write_b32 a4, v103
    v_accvgpr_read_b32 v104, a5
    v_mul_f32 v104, v104, v107
    v_accvgpr_write_b32 a5, v104
    v_accvgpr_read_b32 v103, a6
    v_mul_f32 v103, v103, v107
    v_accvgpr_write_b32 a6, v103
    v_accvgpr_read_b32 v104, a7
    v_mul_f32 v104, v104, v107
    v_accvgpr_write_b32 a7, v104
    v_accvgpr_read_b32 v103, a8
    v_mul_f32 v103, v103, v107
    v_accvgpr_write_b32 a8, v103
    v_accvgpr_read_b32 v104, a9
    v_mul_f32 v104, v104, v107
    v_accvgpr_write_b32 a9, v104
    v_accvgpr_read_b32 v103, a10
    v_mul_f32 v103, v103, v107
    v_accvgpr_write_b32 a10, v103
    v_accvgpr_read_b32 v104, a11
    v_mul_f32 v104, v104, v107
    v_accvgpr_write_b32 a11, v104
    v_accvgpr_read_b32 v103, a12
    v_mul_f32 v103, v103, v107
    v_accvgpr_write_b32 a12, v103
    v_accvgpr_read_b32 v104, a13
    v_mul_f32 v104, v104, v107
    v_accvgpr_write_b32 a13, v104
    v_accvgpr_read_b32 v103, a14
    v_mul_f32 v103, v103, v107
    v_accvgpr_write_b32 a14, v103
    v_accvgpr_read_b32 v104, a15
    v_mul_f32 v104, v104, v107
    v_accvgpr_write_b32 a15, v104
    v_accvgpr_read_b32 v103, a16
    v_mul_f32 v103, v103, v107
    v_accvgpr_write_b32 a16, v103
    v_accvgpr_read_b32 v104, a17
    v_mul_f32 v104, v104, v107
    v_accvgpr_write_b32 a17, v104
    v_accvgpr_read_b32 v103, a18
    v_mul_f32 v103, v103, v107
    v_accvgpr_write_b32 a18, v103
    v_accvgpr_read_b32 v104, a19
    v_mul_f32 v104, v104, v107
    v_accvgpr_write_b32 a19, v104
    v_accvgpr_read_b32 v103, a20
    v_mul_f32 v103, v103, v107
    v_accvgpr_write_b32 a20, v103
    v_accvgpr_read_b32 v104, a21
    v_mul_f32 v104, v104, v107
    v_accvgpr_write_b32 a21, v104
    v_accvgpr_read_b32 v103, a22
    v_mul_f32 v103, v103, v107
    v_accvgpr_write_b32 a22, v103
    v_accvgpr_read_b32 v104, a23
    v_mul_f32 v104, v104, v107
    v_accvgpr_write_b32 a23, v104
    v_accvgpr_read_b32 v103, a24
    v_mul_f32 v103, v103, v107
    v_accvgpr_write_b32 a24, v103
    v_accvgpr_read_b32 v104, a25
    v_mul_f32 v104, v104, v107
    v_accvgpr_write_b32 a25, v104
    v_accvgpr_read_b32 v103, a26
    v_mul_f32 v103, v103, v107
    v_accvgpr_write_b32 a26, v103
    v_accvgpr_read_b32 v104, a27
    v_mul_f32 v104, v104, v107
    v_accvgpr_write_b32 a27, v104
    v_accvgpr_read_b32 v103, a28
    v_mul_f32 v103, v103, v107
    v_accvgpr_write_b32 a28, v103
    v_accvgpr_read_b32 v104, a29
    v_mul_f32 v104, v104, v107
    v_accvgpr_write_b32 a29, v104
    v_accvgpr_read_b32 v103, a30
    v_mul_f32 v103, v103, v107
    v_accvgpr_write_b32 a30, v103
    v_accvgpr_read_b32 v104, a31
    v_mul_f32 v104, v104, v107
    v_accvgpr_write_b32 a31, v104
    v_accvgpr_read_b32 v103, a32
    v_mul_f32 v103, v103, v107
    v_accvgpr_write_b32 a32, v103
    v_accvgpr_read_b32 v104, a33
    v_mul_f32 v104, v104, v107
    v_accvgpr_write_b32 a33, v104
    v_accvgpr_read_b32 v103, a34
    v_mul_f32 v103, v103, v107
    v_accvgpr_write_b32 a34, v103
    v_accvgpr_read_b32 v104, a35
    v_mul_f32 v104, v104, v107
    v_accvgpr_write_b32 a35, v104
    v_accvgpr_read_b32 v103, a36
    v_mul_f32 v103, v103, v107
    v_accvgpr_write_b32 a36, v103
    v_accvgpr_read_b32 v104, a37
    v_mul_f32 v104, v104, v107
    v_accvgpr_write_b32 a37, v104
    v_accvgpr_read_b32 v103, a38
    v_mul_f32 v103, v103, v107
    v_accvgpr_write_b32 a38, v103
    v_accvgpr_read_b32 v104, a39
    v_mul_f32 v104, v104, v107
    v_accvgpr_write_b32 a39, v104
    v_accvgpr_read_b32 v103, a40
    v_mul_f32 v103, v103, v107
    v_accvgpr_write_b32 a40, v103
    v_accvgpr_read_b32 v104, a41
    v_mul_f32 v104, v104, v107
    v_accvgpr_write_b32 a41, v104
    v_accvgpr_read_b32 v103, a42
    v_mul_f32 v103, v103, v107
    v_accvgpr_write_b32 a42, v103
    v_accvgpr_read_b32 v104, a43
    v_mul_f32 v104, v104, v107
    v_accvgpr_write_b32 a43, v104
    v_accvgpr_read_b32 v103, a44
    v_mul_f32 v103, v103, v107
    v_accvgpr_write_b32 a44, v103
    v_accvgpr_read_b32 v104, a45
    v_mul_f32 v104, v104, v107
    v_accvgpr_write_b32 a45, v104
    v_accvgpr_read_b32 v103, a46
    v_mul_f32 v103, v103, v107
    v_accvgpr_write_b32 a46, v103
    v_accvgpr_read_b32 v104, a47
    v_mul_f32 v104, v104, v107
    v_accvgpr_write_b32 a47, v104
    v_accvgpr_read_b32 v103, a48
    v_mul_f32 v103, v103, v107
    v_accvgpr_write_b32 a48, v103
    v_accvgpr_read_b32 v104, a49
    v_mul_f32 v104, v104, v107
    v_accvgpr_write_b32 a49, v104
    v_accvgpr_read_b32 v103, a50
    v_mul_f32 v103, v103, v107
    v_accvgpr_write_b32 a50, v103
    v_accvgpr_read_b32 v104, a51
    v_mul_f32 v104, v104, v107
    v_accvgpr_write_b32 a51, v104
    v_accvgpr_read_b32 v103, a52
    v_mul_f32 v103, v103, v107
    v_accvgpr_write_b32 a52, v103
    v_accvgpr_read_b32 v104, a53
    v_mul_f32 v104, v104, v107
    v_accvgpr_write_b32 a53, v104
    v_accvgpr_read_b32 v103, a54
    v_mul_f32 v103, v103, v107
    v_accvgpr_write_b32 a54, v103
    v_accvgpr_read_b32 v104, a55
    v_mul_f32 v104, v104, v107
    v_accvgpr_write_b32 a55, v104
    v_accvgpr_read_b32 v103, a56
    v_mul_f32 v103, v103, v107
    v_accvgpr_write_b32 a56, v103
    v_accvgpr_read_b32 v104, a57
    v_mul_f32 v104, v104, v107
    v_accvgpr_write_b32 a57, v104
    v_accvgpr_read_b32 v103, a58
    v_mul_f32 v103, v103, v107
    v_accvgpr_write_b32 a58, v103
    v_accvgpr_read_b32 v104, a59
    v_mul_f32 v104, v104, v107
    v_accvgpr_write_b32 a59, v104
    v_accvgpr_read_b32 v103, a60
    v_mul_f32 v103, v103, v107
    v_accvgpr_write_b32 a60, v103
    v_accvgpr_read_b32 v104, a61
    v_mul_f32 v104, v104, v107
    v_accvgpr_write_b32 a61, v104
    v_accvgpr_read_b32 v103, a62
    v_mul_f32 v103, v103, v107
    v_accvgpr_write_b32 a62, v103
    v_accvgpr_read_b32 v104, a63
    v_mul_f32 v104, v104, v107
    v_accvgpr_write_b32 a63, v104
    v_accvgpr_read_b32 v103, a64
    v_mul_f32 v103, v103, v107
    v_accvgpr_write_b32 a64, v103
    v_accvgpr_read_b32 v104, a65
    v_mul_f32 v104, v104, v107
    v_accvgpr_write_b32 a65, v104
    v_accvgpr_read_b32 v103, a66
    v_mul_f32 v103, v103, v107
    v_accvgpr_write_b32 a66, v103
    v_accvgpr_read_b32 v104, a67
    v_mul_f32 v104, v104, v107
    v_accvgpr_write_b32 a67, v104
    v_accvgpr_read_b32 v103, a68
    v_mul_f32 v103, v103, v107
    v_accvgpr_write_b32 a68, v103
    v_accvgpr_read_b32 v104, a69
    v_mul_f32 v104, v104, v107
    v_accvgpr_write_b32 a69, v104
    v_accvgpr_read_b32 v103, a70
    v_mul_f32 v103, v103, v107
    v_accvgpr_write_b32 a70, v103
    v_accvgpr_read_b32 v104, a71
    v_mul_f32 v104, v104, v107
    v_accvgpr_write_b32 a71, v104
    v_accvgpr_read_b32 v103, a72
    v_mul_f32 v103, v103, v107
    v_accvgpr_write_b32 a72, v103
    v_accvgpr_read_b32 v104, a73
    v_mul_f32 v104, v104, v107
    v_accvgpr_write_b32 a73, v104
    v_accvgpr_read_b32 v103, a74
    v_mul_f32 v103, v103, v107
    v_accvgpr_write_b32 a74, v103
    v_accvgpr_read_b32 v104, a75
    v_mul_f32 v104, v104, v107
    v_accvgpr_write_b32 a75, v104
    v_accvgpr_read_b32 v103, a76
    v_mul_f32 v103, v103, v107
    v_accvgpr_write_b32 a76, v103
    v_accvgpr_read_b32 v104, a77
    v_mul_f32 v104, v104, v107
    v_accvgpr_write_b32 a77, v104
    v_accvgpr_read_b32 v103, a78
    v_mul_f32 v103, v103, v107
    v_accvgpr_write_b32 a78, v103
    v_accvgpr_read_b32 v104, a79
    v_mul_f32 v104, v104, v107
    v_accvgpr_write_b32 a79, v104
    v_accvgpr_read_b32 v103, a80
    v_mul_f32 v103, v103, v107
    v_accvgpr_write_b32 a80, v103
    v_accvgpr_read_b32 v104, a81
    v_mul_f32 v104, v104, v107
    v_accvgpr_write_b32 a81, v104
    v_accvgpr_read_b32 v103, a82
    v_mul_f32 v103, v103, v107
    v_accvgpr_write_b32 a82, v103
    v_accvgpr_read_b32 v104, a83
    v_mul_f32 v104, v104, v107
    v_accvgpr_write_b32 a83, v104
    v_accvgpr_read_b32 v103, a84
    v_mul_f32 v103, v103, v107
    v_accvgpr_write_b32 a84, v103
    v_accvgpr_read_b32 v104, a85
    v_mul_f32 v104, v104, v107
    v_accvgpr_write_b32 a85, v104
    v_accvgpr_read_b32 v103, a86
    v_mul_f32 v103, v103, v107
    v_accvgpr_write_b32 a86, v103
    v_accvgpr_read_b32 v104, a87
    v_mul_f32 v104, v104, v107
    v_accvgpr_write_b32 a87, v104
    v_accvgpr_read_b32 v103, a88
    v_mul_f32 v103, v103, v107
    v_accvgpr_write_b32 a88, v103
    v_accvgpr_read_b32 v104, a89
    v_mul_f32 v104, v104, v107
    v_accvgpr_write_b32 a89, v104
    v_accvgpr_read_b32 v103, a90
    v_mul_f32 v103, v103, v107
    v_accvgpr_write_b32 a90, v103
    v_accvgpr_read_b32 v104, a91
    v_mul_f32 v104, v104, v107
    v_accvgpr_write_b32 a91, v104
    v_accvgpr_read_b32 v103, a92
    v_mul_f32 v103, v103, v107
    v_accvgpr_write_b32 a92, v103
    v_accvgpr_read_b32 v104, a93
    v_mul_f32 v104, v104, v107
    v_accvgpr_write_b32 a93, v104
    v_accvgpr_read_b32 v103, a94
    v_mul_f32 v103, v103, v107
    v_accvgpr_write_b32 a94, v103
    v_accvgpr_read_b32 v104, a95
    v_mul_f32 v104, v104, v107
    v_accvgpr_write_b32 a95, v104
    v_accvgpr_read_b32 v103, a96
    v_mul_f32 v103, v103, v107
    v_accvgpr_write_b32 a96, v103
    v_accvgpr_read_b32 v104, a97
    v_mul_f32 v104, v104, v107
    v_accvgpr_write_b32 a97, v104
    v_accvgpr_read_b32 v103, a98
    v_mul_f32 v103, v103, v107
    v_accvgpr_write_b32 a98, v103
    v_accvgpr_read_b32 v104, a99
    v_mul_f32 v104, v104, v107
    v_accvgpr_write_b32 a99, v104
    v_accvgpr_read_b32 v103, a100
    v_mul_f32 v103, v103, v107
    v_accvgpr_write_b32 a100, v103
    v_accvgpr_read_b32 v104, a101
    v_mul_f32 v104, v104, v107
    v_accvgpr_write_b32 a101, v104
    v_accvgpr_read_b32 v103, a102
    v_mul_f32 v103, v103, v107
    v_accvgpr_write_b32 a102, v103
    v_accvgpr_read_b32 v104, a103
    v_mul_f32 v104, v104, v107
    v_accvgpr_write_b32 a103, v104
    v_accvgpr_read_b32 v103, a104
    v_mul_f32 v103, v103, v107
    v_accvgpr_write_b32 a104, v103
    v_accvgpr_read_b32 v104, a105
    v_mul_f32 v104, v104, v107
    v_accvgpr_write_b32 a105, v104
    v_accvgpr_read_b32 v103, a106
    v_mul_f32 v103, v103, v107
    v_accvgpr_write_b32 a106, v103
    v_accvgpr_read_b32 v104, a107
    v_mul_f32 v104, v104, v107
    v_accvgpr_write_b32 a107, v104
    v_accvgpr_read_b32 v103, a108
    v_mul_f32 v103, v103, v107
    v_accvgpr_write_b32 a108, v103
    v_accvgpr_read_b32 v104, a109
    v_mul_f32 v104, v104, v107
    v_accvgpr_write_b32 a109, v104
    v_accvgpr_read_b32 v103, a110
    v_mul_f32 v103, v103, v107
    v_accvgpr_write_b32 a110, v103
    v_accvgpr_read_b32 v104, a111
    v_mul_f32 v104, v104, v107
    v_accvgpr_write_b32 a111, v104
    v_accvgpr_read_b32 v103, a112
    v_mul_f32 v103, v103, v107
    v_accvgpr_write_b32 a112, v103
    v_accvgpr_read_b32 v104, a113
    v_mul_f32 v104, v104, v107
    v_accvgpr_write_b32 a113, v104
    v_accvgpr_read_b32 v103, a114
    v_mul_f32 v103, v103, v107
    v_accvgpr_write_b32 a114, v103
    v_accvgpr_read_b32 v104, a115
    v_mul_f32 v104, v104, v107
    v_accvgpr_write_b32 a115, v104
    v_accvgpr_read_b32 v103, a116
    v_mul_f32 v103, v103, v107
    v_accvgpr_write_b32 a116, v103
    v_accvgpr_read_b32 v104, a117
    v_mul_f32 v104, v104, v107
    v_accvgpr_write_b32 a117, v104
    v_accvgpr_read_b32 v103, a118
    v_mul_f32 v103, v103, v107
    v_accvgpr_write_b32 a118, v103
    v_accvgpr_read_b32 v104, a119
    v_mul_f32 v104, v104, v107
    v_accvgpr_write_b32 a119, v104
    v_accvgpr_read_b32 v103, a120
    v_mul_f32 v103, v103, v107
    v_accvgpr_write_b32 a120, v103
    v_accvgpr_read_b32 v104, a121
    v_mul_f32 v104, v104, v107
    v_accvgpr_write_b32 a121, v104
    v_accvgpr_read_b32 v103, a122
    v_mul_f32 v103, v103, v107
    v_accvgpr_write_b32 a122, v103
    v_accvgpr_read_b32 v104, a123
    v_mul_f32 v104, v104, v107
    v_accvgpr_write_b32 a123, v104
    v_accvgpr_read_b32 v103, a124
    v_mul_f32 v103, v103, v107
    v_accvgpr_write_b32 a124, v103
    v_accvgpr_read_b32 v104, a125
    v_mul_f32 v104, v104, v107
    v_accvgpr_write_b32 a125, v104
    v_accvgpr_read_b32 v103, a126
    v_mul_f32 v103, v103, v107
    v_accvgpr_write_b32 a126, v103
    v_accvgpr_read_b32 v104, a127
    v_mul_f32 v104, v104, v107
    v_accvgpr_write_b32 a127, v104
    s_nop 3
    s_cmp_eq_u32 s67, 1
    s_cbranch_scc1 L1_bk1
    s_cmp_eq_u32 s67, 3
    s_cbranch_scc1 L1_bk3
    s_cmp_eq_u32 s67, 5
    s_cbranch_scc1 L1_bk5
    s_cmp_eq_u32 s67, 7
    s_cbranch_scc1 L1_bk7
    s_cmp_eq_u32 s67, 9
    s_cbranch_scc1 L1_bk9
    s_cmp_eq_u32 s67, 11
    s_cbranch_scc1 L1_bk11
    s_cmp_eq_u32 s67, 13
    s_cbranch_scc1 L1_bk13
L1_last:
    s_branch L1_bk15
.section .rodata,"a"
.p2align 6
.amdhsa_kernel recurrent_scan__sliding_block_cached__glu_gated_bilinear__prompt_kernel
  .amdhsa_next_free_vgpr 512
  .amdhsa_next_free_sgpr 102
  .amdhsa_accum_offset 256
  .amdhsa_group_segment_fixed_size 0
  .amdhsa_kernarg_size 96
  .amdhsa_user_sgpr_count 2
  .amdhsa_user_sgpr_kernarg_segment_ptr 1
  .amdhsa_system_sgpr_workgroup_id_x 1
.end_amdhsa_kernel
```
